```python
import torch

def _softmax(x, axis=-1):
    return torch.softmax(x, dim=axis)

def _gelu(x):
    return torch.nn.functional.gelu(x, approximate='tanh')

def _silu(x):
    return torch.nn.functional.silu(x)

def _sigmoid(x):
    return torch.sigmoid(x)

def _layernorm(x, axis=-1, eps=1e-05):
    m = x.mean(dim=axis, keepdim=True)
    v = x.var(dim=axis, keepdim=True, unbiased=False)
    return (x - m) / torch.sqrt(v + eps)

def _scatter_add(tgt, idx, src, axis=0):
    return tgt.clone().index_add_(axis, idx, src)

def _segment_sum(src, seg, n):
    out = torch.zeros((n,) + src.shape[1:], dtype=src.dtype)
    return out.index_add_(0, seg, src)

def _pad(x, pw):
    flat = tuple((v for pair in reversed(pw) for v in pair))
    return torch.nn.functional.pad(x, flat)
kernel_name = 'gated_mix__memory_aug_recurrent_mem_tr__memory_aug_recurrent_mem_tr__prompt'

def setup_inputs():

    _w = lambda a: (lambda t: t.to(torch.bfloat16) if t.is_floating_point() else t)(torch.as_tensor(a))

    def _A_setup():
        B, S, Dm = (1, 2048, 576)
        H, Dh = (32, 128)
        M, seg = (8, 32)
        seg = min(seg, S)
        S = S // seg * seg
        return {'x': _w((lambda *s: torch.randn(*s, dtype=torch.bfloat16) * 0.05)(B, S, Dm)), 'mem0': _w((lambda *s: torch.randn(*s, dtype=torch.bfloat16) * 0.4)(B, M, Dm)), 'Wq': _w((lambda *s: torch.randn(*s, dtype=torch.bfloat16) * 6.4)(Dm, H, Dh) * Dm ** (-0.5)), 'Wk': _w((lambda *s: torch.randn(*s, dtype=torch.bfloat16) * 6.4)(Dm, H, Dh) * Dm ** (-0.5)), 'Wv': _w((lambda *s: torch.randn(*s, dtype=torch.bfloat16) * 0.4)(Dm, H, Dh) * Dm ** (-0.5)), 'Wo': _w((lambda *s: torch.randn(*s, dtype=torch.bfloat16) * 0.4)(H, Dh, Dm) * (H * Dh) ** (-0.5)), 'seg_len': seg}
    _A_in = _A_setup()

    def _B_setup():
        B, S, Dm = (1, 2048, 576)
        H, Dh = (32, 128)
        M, seg = (8, 32)
        seg = min(seg, S)
        S = S // seg * seg
        return {'x': _w((lambda *s: torch.randn(*s, dtype=torch.bfloat16) * 0.05)(B, S, Dm)), 'mem0': _w((lambda *s: torch.randn(*s, dtype=torch.bfloat16) * 0.4)(B, M, Dm)), 'Wq': _w((lambda *s: torch.randn(*s, dtype=torch.bfloat16) * 6.4)(Dm, H, Dh) * Dm ** (-0.5)), 'Wk': _w((lambda *s: torch.randn(*s, dtype=torch.bfloat16) * 6.4)(Dm, H, Dh) * Dm ** (-0.5)), 'Wv': _w((lambda *s: torch.randn(*s, dtype=torch.bfloat16) * 0.4)(Dm, H, Dh) * Dm ** (-0.5)), 'Wo': _w((lambda *s: torch.randn(*s, dtype=torch.bfloat16) * 0.4)(H, Dh, Dm) * (H * Dh) ** (-0.5)), 'seg_len': seg}
    _B_in = _B_setup()
    return {'A_x': _A_in['x'], 'A_mem0': _A_in['mem0'], 'A_Wq': _A_in['Wq'], 'A_Wk': _A_in['Wk'], 'A_Wv': _A_in['Wv'], 'A_Wo': _A_in['Wo'], 'A_seg_len': _A_in['seg_len'], 'B_x': _B_in['x'], 'B_mem0': _B_in['mem0'], 'B_Wq': _B_in['Wq'], 'B_Wk': _B_in['Wk'], 'B_Wv': _B_in['Wv'], 'B_Wo': _B_in['Wo'], 'B_seg_len': _B_in['seg_len'], 'gate_w': _w((lambda *s: torch.randn(*s, dtype=torch.bfloat16) * 0.05)(576) * 16.0)}

def reference(A_x, A_mem0, A_Wq, A_Wk, A_Wv, A_Wo, A_seg_len, B_x, B_mem0, B_Wq, B_Wk, B_Wv, B_Wo, B_seg_len, gate_w):

    def _A_ref(x, mem0, Wq, Wk, Wv, Wo, seg_len):
        B, S, Dm = x.shape
        H, Dh = (Wq.shape[1], Wq.shape[2])
        M = mem0.shape[1]
        scale = Dh ** (-0.5)
        n_seg = S // seg_len
        L = M + seg_len
        idx = torch.arange(L)
        mask = (idx[:, None] < M) | (idx[:, None] >= idx[None, :])
        mem = mem0
        outs = []
        for s in range(n_seg):
            xs = x[:, s * seg_len:(s + 1) * seg_len, :].clone()
            h = torch.concatenate([mem, xs], axis=1)
            q = torch.einsum('btd,dhe->bhte', h, Wq)
            k = torch.einsum('btd,dhe->bhte', h, Wk)
            v = torch.einsum('btd,dhe->bhte', h, Wv)
            scores = torch.einsum('bhqe,bhke->bhqk', q, k) * scale
            scores = torch.where(mask[None, None], scores, -1000000000.0)
            p = _softmax(scores, axis=-1)
            o = torch.einsum('bhqk,bhke->bhqe', p, v)
            o = torch.einsum('bhte,hed->btd', o, Wo)
            mem = o[:, :M, :].clone()
            outs.append(o[:, M:, :])
        return torch.concatenate(outs, axis=1)

    def _B_ref(x, mem0, Wq, Wk, Wv, Wo, seg_len):
        B, S, Dm = x.shape
        H, Dh = (Wq.shape[1], Wq.shape[2])
        M = mem0.shape[1]
        scale = Dh ** (-0.5)
        n_seg = S // seg_len
        L = M + seg_len
        idx = torch.arange(L)
        mask = (idx[:, None] < M) | (idx[:, None] >= idx[None, :])
        mem = mem0
        outs = []
        for s in range(n_seg):
            xs = x[:, s * seg_len:(s + 1) * seg_len, :].clone()
            h = torch.concatenate([mem, xs], axis=1)
            q = torch.einsum('btd,dhe->bhte', h, Wq)
            k = torch.einsum('btd,dhe->bhte', h, Wk)
            v = torch.einsum('btd,dhe->bhte', h, Wv)
            scores = torch.einsum('bhqe,bhke->bhqk', q, k) * scale
            scores = torch.where(mask[None, None], scores, -1000000000.0)
            p = _softmax(scores, axis=-1)
            o = torch.einsum('bhqk,bhke->bhqe', p, v)
            o = torch.einsum('bhte,hed->btd', o, Wo)
            mem = o[:, :M, :].clone()
            outs.append(o[:, M:, :])
        return torch.concatenate(outs, axis=1)
    x = A_x
    g = _sigmoid((x * gate_w).sum(-1, keepdims=True))
    a = _A_ref(x, A_mem0, A_Wq, A_Wk, A_Wv, A_Wo, A_seg_len)
    b = _B_ref(x, B_mem0, B_Wq, B_Wk, B_Wv, B_Wo, B_seg_len)
    return g * a + (1 - g) * b
```

```asm
; @launch grid=(256,1,1) block=(256,1,1) lds=163840
.amdgcn_target "amdgcn-amd-amdhsa--gfx950"
.text
.globl gated_mix__memory_aug_recurrent_mem_tr__memory_aug_recurrent_mem_tr__prompt_kernel
.p2align 8
.type gated_mix__memory_aug_recurrent_mem_tr__memory_aug_recurrent_mem_tr__prompt_kernel,@function
gated_mix__memory_aug_recurrent_mem_tr__memory_aug_recurrent_mem_tr__prompt_kernel:

    s_cmp_ge_u32 s2, 256
    s_cbranch_scc1 L_exit
    s_load_dwordx16 s[60:75], s[0:1], 0
    s_load_dwordx16 s[76:91], s[0:1], 64
    s_load_dwordx4 s[92:95], s[0:1], 128
    s_waitcnt lgkmcnt(0)
    s_mov_b32 s8, s60
    s_mov_b32 s9, s61
    s_mov_b32 s10, 0x240000
    s_mov_b32 s11, 0x20000
    s_mov_b32 s28, s94
    s_mov_b32 s29, s95
    s_mov_b32 s30, 0x10000000
    s_mov_b32 s31, 0x20000
    s_mov_b32 s32, s90
    s_mov_b32 s33, s91
    s_mov_b32 s34, 0x240000
    s_mov_b32 s35, 0x20000
    s_mov_b32 s40, s88
    s_mov_b32 s41, s89
    s_mov_b32 s42, 0x480
    s_mov_b32 s43, 0x20000
    s_mov_b32 s44, s92
    s_mov_b32 s45, s93
    s_getreg_b32 s46, hwreg(HW_REG_XCC_ID)
    s_and_b32 s46, s46, 15
    s_min_u32 s46, s46, 8
    s_lshl_b32 s47, s46, 2
    s_lshr_b32 s47, 0x76543210, s47
    s_and_b32 s47, s47, 15
    s_cmp_lt_u32 s46, 8
    s_cselect_b32 s46, s47, s46
    s_lshl_b32 s47, s46, 4
    s_add_u32 s48, s46, 30
    s_cmp_ge_u32 s46, 2
    s_cselect_b32 s47, s48, s47
    s_add_u32 s48, s46, 43
    s_cmp_ge_u32 s46, 5
    s_cselect_b32 s47, s48, s47
    s_lshl_b32 s47, s47, 2
    v_mov_b32 v1, s47
    v_mov_b32 v2, 1
    v_mov_b32 v4, 0
    v_cmp_eq_u32 vcc, 0, v0
    s_and_saveexec_b64 s[48:49], vcc
    s_cbranch_execz L_tk_w_1
    global_atomic_add v3, v1, v2, s[44:45] sc0
    s_waitcnt vmcnt(0)
    ds_write_b32 v4, v3
    s_waitcnt lgkmcnt(0)
L_tk_w_1:
    s_mov_b64 exec, s[48:49]
    s_barrier
    ds_read_b32 v3, v4
    s_waitcnt lgkmcnt(0)
    v_readfirstlane_b32 s47, v3
    s_barrier
    s_cmp_ge_u32 s46, 8
    s_cbranch_scc1 L_tk_ov_3
    s_cmp_lt_u32 s47, 32
    s_cbranch_scc1 L_tk_home_2
L_tk_ov_3:
    v_mov_b32 v1, 140
    v_cmp_eq_u32 vcc, 0, v0
    s_and_saveexec_b64 s[48:49], vcc
    s_cbranch_execz L_tk_w2_6
    global_atomic_add v3, v1, v2, s[44:45] sc0
    s_waitcnt vmcnt(0)
    ds_write_b32 v4, v3
    s_waitcnt lgkmcnt(0)
L_tk_w2_6:
    s_mov_b64 exec, s[48:49]
    s_barrier
    ds_read_b32 v3, v4
    s_waitcnt lgkmcnt(0)
    v_readfirstlane_b32 s47, v3
    s_barrier
    s_mov_b32 s46, 0x100000
L_tk_ovp_4:
    s_sub_u32 s46, s46, 1
    s_cmp_eq_u32 s46, 0
    s_cbranch_scc1 L_exit
    v_and_b32 v1, 63, v0
    v_lshlrev_b32 v1, 2, v1
    global_load_dword v2, v1, s[44:45] sc1
    s_waitcnt vmcnt(0)
    v_readlane_b32 s50, v2, 0
    v_readlane_b32 s51, v2, 16
    v_readlane_b32 s52, v2, 32
    v_readlane_b32 s53, v2, 33
    v_readlane_b32 s54, v2, 34
    v_readlane_b32 s55, v2, 48
    v_readlane_b32 s56, v2, 49
    v_readlane_b32 s57, v2, 50
    v_readlane_b32 s58, v2, 51
    s_nop 3
    s_add_u32 s59, s50, s51
    s_add_u32 s59, s59, s52
    s_add_u32 s59, s59, s53
    s_add_u32 s59, s59, s54
    s_add_u32 s59, s59, s55
    s_add_u32 s59, s59, s56
    s_add_u32 s59, s59, s57
    s_add_u32 s59, s59, s58
    s_cmp_lt_u32 s59, 256
    s_cbranch_scc1 L_tk_ovp_4
    s_mov_b32 s3, 0
    s_min_u32 s48, s50, 32
    s_sub_u32 s49, 32, s48
    s_cmp_lt_u32 s47, s49
    s_cbranch_scc0 L_tk_n_7
    s_add_u32 s3, s48, s47
    s_add_u32 s3, s3, 0
    s_branch L_tk_done_5
L_tk_n_7:
    s_sub_u32 s47, s47, s49
    s_min_u32 s48, s51, 32
    s_sub_u32 s49, 32, s48
    s_cmp_lt_u32 s47, s49
    s_cbranch_scc0 L_tk_n_8
    s_add_u32 s3, s48, s47
    s_add_u32 s3, s3, 32
    s_branch L_tk_done_5
L_tk_n_8:
    s_sub_u32 s47, s47, s49
    s_min_u32 s48, s52, 32
    s_sub_u32 s49, 32, s48
    s_cmp_lt_u32 s47, s49
    s_cbranch_scc0 L_tk_n_9
    s_add_u32 s3, s48, s47
    s_add_u32 s3, s3, 64
    s_branch L_tk_done_5
L_tk_n_9:
    s_sub_u32 s47, s47, s49
    s_min_u32 s48, s53, 32
    s_sub_u32 s49, 32, s48
    s_cmp_lt_u32 s47, s49
    s_cbranch_scc0 L_tk_n_10
    s_add_u32 s3, s48, s47
    s_add_u32 s3, s3, 96
    s_branch L_tk_done_5
L_tk_n_10:
    s_sub_u32 s47, s47, s49
    s_min_u32 s48, s54, 32
    s_sub_u32 s49, 32, s48
    s_cmp_lt_u32 s47, s49
    s_cbranch_scc0 L_tk_n_11
    s_add_u32 s3, s48, s47
    s_add_u32 s3, s3, 128
    s_branch L_tk_done_5
L_tk_n_11:
    s_sub_u32 s47, s47, s49
    s_min_u32 s48, s55, 32
    s_sub_u32 s49, 32, s48
    s_cmp_lt_u32 s47, s49
    s_cbranch_scc0 L_tk_n_12
    s_add_u32 s3, s48, s47
    s_add_u32 s3, s3, 160
    s_branch L_tk_done_5
L_tk_n_12:
    s_sub_u32 s47, s47, s49
    s_min_u32 s48, s56, 32
    s_sub_u32 s49, 32, s48
    s_cmp_lt_u32 s47, s49
    s_cbranch_scc0 L_tk_n_13
    s_add_u32 s3, s48, s47
    s_add_u32 s3, s3, 192
    s_branch L_tk_done_5
L_tk_n_13:
    s_sub_u32 s47, s47, s49
    s_min_u32 s48, s57, 32
    s_sub_u32 s49, 32, s48
    s_cmp_lt_u32 s47, s49
    s_cbranch_scc0 L_tk_n_14
    s_add_u32 s3, s48, s47
    s_add_u32 s3, s3, 224
    s_branch L_tk_done_5
L_tk_n_14:
    s_sub_u32 s47, s47, s49
    s_branch L_exit
L_tk_home_2:
    s_lshl_b32 s3, s46, 5
    s_add_u32 s3, s3, s47
L_tk_done_5:
    s_cmp_ge_u32 s3, 64
    s_cbranch_scc1 L_worker
    s_lshr_b32 s49, s3, 5
    s_and_b32 s50, s3, 31
    v_lshrrev_b32 v1, 6, v0
    s_nop 0
    v_readfirstlane_b32 s51, v1
    v_and_b32 v11, 63, v0
    s_cmp_eq_u32 s49, 0
    s_cselect_b32 s36, s62, s76
    s_cselect_b32 s37, s63, s77
    s_mov_b32 s38, 0x2400
    s_mov_b32 s39, 0x20000
    s_cselect_b32 s12, s64, s78
    s_cselect_b32 s13, s65, s79
    s_mov_b32 s14, 0x480000
    s_mov_b32 s15, 0x20000
    s_cselect_b32 s16, s66, s80
    s_cselect_b32 s17, s67, s81
    s_mov_b32 s18, 0x480000
    s_mov_b32 s19, 0x20000
    s_cselect_b32 s20, s68, s82
    s_cselect_b32 s21, s69, s83
    s_mov_b32 s22, 0x480000
    s_mov_b32 s23, 0x20000
    s_cselect_b32 s24, s70, s84
    s_cselect_b32 s25, s71, s85
    s_mov_b32 s26, 0x480000
    s_mov_b32 s27, 0x20000
    s_lshl_b32 s101, s49, 5
    s_add_u32 s101, s101, s50
    s_mov_b32 s4, 0x33333333
    s_mov_b32 s5, 0x33333333
    s_mov_b32 s6, 0xf0f0f0f0
    s_mov_b32 s7, 0xf0f0f0f0
    s_mov_b32 s76, 0x110011
    s_mov_b32 s77, 0x110011
    s_mov_b32 s78, 0x220022
    s_mov_b32 s79, 0x220022
    s_mov_b32 s80, 0x11001100
    s_mov_b32 s81, 0x11001100
    s_mov_b32 s82, 0x22002200
    s_mov_b32 s83, 0x22002200
    s_mov_b32 s100, 0x3e0293ee
    s_mov_b32 s57, 0x100000
    s_mov_b32 s74, 0x3f803f80
    s_mov_b32 s75, 0x3f803f80
    s_lshl_b32 s69, s51, 8
    v_lshlrev_b32 v2, 4, v11
    v_bfe_u32 v12, v11, 1, 1
    v_mul_u32_u24 v0, 0xaaaa, v12
    v_add_u32 v0, 0x4444, v0
    s_mul_i32 s53, s51, 36864
    s_add_u32 s53, s53, 16384
    v_add_u32 v3, s53, v2
    v_and_b32 v12, 1, v11
    v_lshlrev_b32 v12, 4, v12
    v_mov_b32 v13, 0x3f80
    v_lshlrev_b32 v12, v12, v13
    v_bfe_u32 v13, v11, 1, 3
    v_lshrrev_b32 v14, 4, v11
    v_lshlrev_b32 v14, 1, v14
    v_sub_u32 v13, v13, v14
    v_cmp_eq_u32 vcc, 0, v13
    s_nop 1
    v_cndmask_b32 v4, 0, v12, vcc
    v_cmp_eq_u32 vcc, 1, v13
    s_nop 1
    v_cndmask_b32 v5, 0, v12, vcc
    s_lshl_b32 s54, s51, 10
    v_add_u32 v6, s54, v2
    s_bfe_u32 s55, s51, 0x10001
    s_lshl_b32 s55, s55, 10
    s_mov_b32 s54, s55
    s_bfe_u32 s55, s51, 0x10000
    s_lshl_b32 s55, s55, 5
    s_add_u32 s54, s54, s55
    v_add_u32 v7, s54, v2
    s_bfe_u32 s55, s51, 0x10001
    s_lshl_b32 s55, s55, 5
    s_mov_b32 s99, s55
    s_bfe_u32 s55, s51, 0x10000
    s_lshl_b32 s55, s55, 3
    s_add_u32 s99, s99, s55
    v_bfe_u32 v12, v11, 3, 3
    v_lshlrev_b32 v8, 11, v12
    v_bfe_u32 v12, v11, 0, 3
    v_lshl_add_u32 v8, v12, 3, v8
    v_bfe_u32 v12, v11, 4, 2
    v_lshlrev_b32 v1, 11, v12
    v_bfe_u32 v12, v11, 0, 4
    v_lshl_add_u32 v1, v12, 2, v1
    v_bfe_u32 v21, v11, 4, 2
    v_lshlrev_b32 v20, 1, v21
    v_bfe_u32 v21, v11, 2, 1
    v_lshl_add_u32 v20, v21, 0, v20
    v_mul_u32_u24 v20, 1152, v20
    v_mov_b32 v22, v20
    v_bfe_u32 v21, v11, 0, 2
    v_lshl_add_u32 v20, v21, 2, v20
    v_bfe_u32 v21, v11, 3, 1
    v_lshl_add_u32 v20, v21, 1, v20
    v_bfe_u32 v21, v11, 0, 2
    v_lshl_add_u32 v22, v21, 3, v22
    v_bfe_u32 v21, v11, 3, 1
    v_lshl_add_u32 v22, v21, 2, v22
    s_bfe_u32 s54, s51, 0x10001
    s_lshl_b32 s54, s54, 6
    s_mov_b32 s52, s54
    s_bfe_u32 s54, s51, 0x10000
    s_lshl_b32 s54, s54, 4
    s_add_u32 s52, s52, s54
    s_lshl_b32 s53, s51, 5
    buffer_load_ushort v24, v22, s[36:39], s53 offen offset:1024
    buffer_load_ushort v25, v22, s[36:39], s53 offen offset:1026
    buffer_load_ushort v26, v20, s[36:39], s52 offen offset:0
    buffer_load_ushort v27, v20, s[36:39], s52 offen offset:32
    buffer_load_ushort v28, v20, s[36:39], s52 offen offset:128
    buffer_load_ushort v29, v20, s[36:39], s52 offen offset:160
    buffer_load_ushort v30, v20, s[36:39], s52 offen offset:256
    buffer_load_ushort v31, v20, s[36:39], s52 offen offset:288
    buffer_load_ushort v32, v20, s[36:39], s52 offen offset:384
    buffer_load_ushort v33, v20, s[36:39], s52 offen offset:416
    buffer_load_ushort v34, v20, s[36:39], s52 offen offset:512
    buffer_load_ushort v35, v20, s[36:39], s52 offen offset:544
    buffer_load_ushort v36, v20, s[36:39], s52 offen offset:640
    buffer_load_ushort v37, v20, s[36:39], s52 offen offset:672
    buffer_load_ushort v38, v20, s[36:39], s52 offen offset:768
    buffer_load_ushort v39, v20, s[36:39], s52 offen offset:800
    buffer_load_ushort v40, v20, s[36:39], s52 offen offset:896
    buffer_load_ushort v41, v20, s[36:39], s52 offen offset:928
    v_lshlrev_b32 v21, 2, v11
    v_add_u32 v21, s69, v21
    s_lshl_b32 s58, s101, 20
    s_lshl_b32 s52, s51, 11
    s_add_u32 s58, s58, s52
    s_lshl_b32 s53, s101, 19
    s_add_u32 s53, s53, 67108864
    s_lshl_b32 s52, s51, 9
    s_add_u32 s59, s53, s52
    s_add_u32 s60, s53, 4096
    s_add_u32 s60, s60, s52
    s_lshl_b32 s52, s49, 20
    s_add_u32 s52, s52, 134217728
    s_lshl_b32 s53, s50, 6
    s_add_u32 s53, s53, s52
    s_lshl_b32 s54, s51, 14
    s_add_u32 s61, s53, s54
    s_lshl_b32 s54, s51, 13
    s_add_u32 s62, s53, s54
    s_add_u32 s62, s62, 262144
    s_lshl_b32 s53, s50, 11
    s_add_u32 s53, s53, s52
    s_lshl_b32 s54, s51, 16
    s_add_u32 s63, s53, s54
    s_add_u32 s46, s53, 262144
    s_cmp_lt_u32 s50, 16
    s_cselect_b32 s33, 1, 0
    s_cmp_eq_u32 s51, 3
    s_cselect_b32 s33, s33, 0
    s_cselect_b32 s32, s46, s63
    s_cmp_eq_u32 s51, 0
    s_cselect_b32 s33, 1, s33
    s_cselect_b32 s43, 3072, 0
    s_lshl_b32 s52, s49, 16
    s_add_u32 s52, s52, 138412032
    s_lshl_b32 s54, s51, 11
    s_add_u32 s55, s54, 1024
    s_cmp_eq_u32 s51, 0
    s_cselect_b32 s53, 0, s55
    s_add_u32 s65, s52, s53
    s_add_u32 s70, s53, 7168
    s_mov_b32 s34, 496
    s_cmp_eq_u32 s51, 0
    s_cselect_b32 s34, 752, s34
    s_bfe_u32 s53, s50, 0x10004
    s_lshl_b32 s53, s53, 10
    s_mov_b32 s66, s53
    s_bfe_u32 s53, s50, 0x10003
    s_lshl_b32 s53, s53, 9
    s_add_u32 s66, s66, s53
    s_bfe_u32 s53, s50, 0x10000
    s_lshl_b32 s53, s53, 8
    s_add_u32 s66, s66, s53
    s_bfe_u32 s53, s50, 0x20001
    s_lshl_b32 s53, s53, 6
    s_add_u32 s66, s66, s53
    s_add_u32 s66, s66, s55
    s_add_u32 s66, s66, s52
    s_lshl_b32 s47, s50, 6
    s_add_u32 s47, s47, s52
    s_lshl_b32 s54, s50, 2
    s_add_u32 s40, s52, s54
    s_add_u32 s40, s40, 12288
    s_and_b32 s54, s50, 7
    s_lshl_b32 s54, s54, 7
    s_add_u32 s42, s52, s54
    s_add_u32 s42, s42, 12288
    s_lshl_b32 s54, s51, 10
    s_add_u32 s42, s42, s54
    s_add_u32 s40, s40, s54
    s_mov_b32 s72, 0x01010101
    s_mov_b32 s73, 0x01010101
    s_mov_b32 s67, 0x4000
    s_mov_b32 s36, 0
    s_mov_b32 s38, 0xcccccccc
    s_mov_b32 s39, 0xcccccccc
    s_mov_b32 s68, 0x8000
    s_mov_b32 s56, 0
    s_mov_b32 s48, 1
    s_mov_b32 s35, 0
    v_mov_b32 v64, -1
    v_mov_b32 v65, -1
    v_mov_b32 v66, -1
    v_mov_b32 v67, -1
    buffer_store_dwordx4 v[64:67], v2, s[28:31], s63 offen offset:0 sc1
    buffer_store_dwordx4 v[64:67], v2, s[28:31], s63 offen offset:1024 sc1
    s_mov_b64 exec, 0xf
    s_add_u32 s52, s66, 0x0
    buffer_store_dwordx4 v[64:67], v2, s[28:31], s52 offen sc1
    s_add_u32 s52, s66, 0x4000
    buffer_store_dwordx4 v[64:67], v2, s[28:31], s52 offen sc1
    s_add_u32 s52, s66, 0x8000
    buffer_store_dwordx4 v[64:67], v2, s[28:31], s52 offen sc1
    s_add_u32 s52, s66, 0xc000
    buffer_store_dwordx4 v[64:67], v2, s[28:31], s52 offen sc1
    s_mov_b64 exec, -1
    s_mov_b64 exec, 0xff
    buffer_store_dwordx4 v[64:67], v2, s[28:31], s42 offen sc1
    s_mov_b64 exec, -1
    s_lshl_b32 s53, s51, 5
    s_add_u32 s53, s53, s50
    s_cmp_ge_u32 s53, 16
    s_cbranch_scc1 L_r_noinit_15
    buffer_store_dwordx4 v[64:67], v2, s[28:31], s46 offen offset:0 sc1
    buffer_store_dwordx4 v[64:67], v2, s[28:31], s46 offen offset:1024 sc1
    s_mov_b64 exec, 0xf
    s_add_u32 s52, s47, 0x0
    buffer_store_dwordx4 v[64:67], v2, s[28:31], s52 offen sc1
    s_add_u32 s52, s47, 0x4000
    buffer_store_dwordx4 v[64:67], v2, s[28:31], s52 offen sc1
    s_add_u32 s52, s47, 0x8000
    buffer_store_dwordx4 v[64:67], v2, s[28:31], s52 offen sc1
    s_add_u32 s52, s47, 0xc000
    buffer_store_dwordx4 v[64:67], v2, s[28:31], s52 offen sc1
    s_mov_b64 exec, -1
L_r_noinit_15:
    s_nop 0
    v_lshrrev_b32 v12, 4, v11
    v_lshlrev_b32 v12, 1, v12
    v_xor_b32 v12, 0, v12
    v_and_b32 v13, 15, v11
    v_xor_b32 v13, v12, v13
    v_bfe_u32 v12, v11, 4, 1
    v_lshlrev_b32 v48, 17, v12
    v_bfe_u32 v12, v11, 5, 1
    v_lshl_add_u32 v48, v12, 13, v48
    v_bfe_u32 v12, v11, 4, 2
    v_lshlrev_b32 v50, 13, v12
    v_bfe_u32 v12, v11, 4, 1
    v_lshlrev_b32 v52, 0, v12
    v_bfe_u32 v12, v11, 5, 1
    v_lshl_add_u32 v52, v12, 5, v52
    v_mul_u32_u24 v52, 1152, v52
    v_lshrrev_b32 v12, 3, v13
    v_mul_u32_u24 v54, 73600, v12
    v_add_u32 v54, v54, v52
    v_lshl_add_u32 v48, v13, 4, v48
    v_lshl_add_u32 v50, v13, 4, v50
    v_lshl_add_u32 v52, v13, 4, v52
    v_lshl_add_u32 v54, v13, 4, v54
    v_lshrrev_b32 v12, 4, v11
    v_lshlrev_b32 v12, 1, v12
    v_xor_b32 v12, 8, v12
    v_and_b32 v13, 15, v11
    v_xor_b32 v13, v12, v13
    v_bfe_u32 v12, v11, 4, 1
    v_lshlrev_b32 v49, 17, v12
    v_bfe_u32 v12, v11, 5, 1
    v_lshl_add_u32 v49, v12, 13, v49
    v_bfe_u32 v12, v11, 4, 2
    v_lshlrev_b32 v51, 13, v12
    v_bfe_u32 v12, v11, 4, 1
    v_lshlrev_b32 v53, 0, v12
    v_bfe_u32 v12, v11, 5, 1
    v_lshl_add_u32 v53, v12, 5, v53
    v_mul_u32_u24 v53, 1152, v53
    v_lshrrev_b32 v12, 3, v13
    v_mul_u32_u24 v55, 73600, v12
    v_add_u32 v55, v55, v53
    v_lshl_add_u32 v49, v13, 4, v49
    v_lshl_add_u32 v51, v13, 4, v51
    v_lshl_add_u32 v53, v13, 4, v53
    v_lshl_add_u32 v55, v13, 4, v55
    s_lshl_b32 s52, s50, 8
    s_bfe_u32 s53, s51, 0x10001
    s_lshl_b32 s53, s53, 18
    s_mov_b32 s84, s53
    s_bfe_u32 s53, s51, 0x10000
    s_lshl_b32 s53, s53, 14
    s_add_u32 s84, s84, s53
    s_add_u32 s84, s84, s52
    s_bfe_u32 s53, s51, 0x10001
    s_lshl_b32 s53, s53, 18
    s_mov_b32 s85, s53
    s_bfe_u32 s53, s51, 0x10000
    s_lshl_b32 s53, s53, 15
    s_add_u32 s85, s85, s53
    s_add_u32 s85, s85, s52
    s_bfe_u32 s53, s51, 0x10001
    s_lshl_b32 s53, s53, 3
    s_mov_b32 s86, s53
    s_bfe_u32 s53, s51, 0x10000
    s_lshl_b32 s53, s53, 1
    s_add_u32 s86, s86, s53
    s_mul_i32 s86, s86, 1152
    s_mul_i32 s52, s50, 147456
    s_add_u32 s86, s86, s52
    s_mul_i32 s87, s51, 36864
    s_add_u32 s87, s87, 16384
    v_bfe_u32 v12, v11, 2, 3
    v_lshlrev_b32 v12, 1, v12
    v_bfe_u32 v14, v11, 2, 4
    v_lshlrev_b32 v13, 8, v14
    v_bfe_u32 v14, v11, 0, 1
    v_lshl_add_u32 v13, v14, 3, v13
    v_bfe_u32 v14, v11, 1, 1
    s_lshl_b32 s52, s51, 2
    s_lshl_b32 s53, s51, 1
    v_lshlrev_b32 v15, 1, v14
    v_add_u32 v15, s52, v15
    v_add_u32 v15, 0, v15
    v_xor_b32 v15, v15, v12
    v_lshl_add_u32 v56, v15, 4, v13
    v_lshlrev_b32 v15, 0, v14
    v_add_u32 v15, s52, v15
    v_add_u32 v15, 0, v15
    v_xor_b32 v15, v15, v12
    v_lshl_add_u32 v57, v15, 4, v13
    v_lshlrev_b32 v15, 0, v14
    v_add_u32 v15, s53, v15
    v_add_u32 v15, 0, v15
    v_xor_b32 v15, v15, v12
    v_lshl_add_u32 v59, v15, 4, v13
    v_lshlrev_b32 v15, 0, v14
    v_add_u32 v15, s52, v15
    v_add_u32 v15, 2, v15
    v_xor_b32 v15, v15, v12
    v_lshl_add_u32 v58, v15, 4, v13
    v_lshlrev_b32 v15, 0, v14
    v_add_u32 v15, s53, v15
    v_add_u32 v15, 8, v15
    v_xor_b32 v15, v15, v12
    v_lshl_add_u32 v60, v15, 4, v13
    s_add_u32 m0, s87, 0
    s_add_u32 s54, s84, 0
    buffer_load_dwordx4 v48, s[12:15], s54 offen lds
    s_add_u32 m0, s87, 1024
    s_add_u32 s54, s84, 32768
    buffer_load_dwordx4 v49, s[12:15], s54 offen lds
    s_add_u32 m0, s87, 2048
    s_add_u32 s54, s84, 65536
    buffer_load_dwordx4 v48, s[12:15], s54 offen lds
    s_add_u32 m0, s87, 3072
    s_add_u32 s54, s84, 98304
    buffer_load_dwordx4 v49, s[12:15], s54 offen lds
    s_add_u32 m0, s87, 4096
    s_add_u32 s54, s84, 524288
    buffer_load_dwordx4 v48, s[12:15], s54 offen lds
    s_add_u32 m0, s87, 5120
    s_add_u32 s54, s84, 557056
    buffer_load_dwordx4 v49, s[12:15], s54 offen lds
    s_add_u32 m0, s87, 6144
    s_add_u32 s54, s84, 589824
    buffer_load_dwordx4 v48, s[12:15], s54 offen lds
    s_add_u32 m0, s87, 7168
    s_add_u32 s54, s84, 622592
    buffer_load_dwordx4 v49, s[12:15], s54 offen lds
    s_add_u32 m0, s87, 8192
    s_add_u32 s54, s84, 1048576
    buffer_load_dwordx4 v48, s[12:15], s54 offen lds
    s_add_u32 m0, s87, 9216
    s_add_u32 s54, s84, 1081344
    buffer_load_dwordx4 v49, s[12:15], s54 offen lds
    s_add_u32 m0, s87, 10240
    s_add_u32 s54, s84, 1114112
    buffer_load_dwordx4 v48, s[12:15], s54 offen lds
    s_add_u32 m0, s87, 11264
    s_add_u32 s54, s84, 1146880
    buffer_load_dwordx4 v49, s[12:15], s54 offen lds
    s_add_u32 m0, s87, 12288
    s_add_u32 s54, s84, 2097152
    buffer_load_dwordx4 v48, s[12:15], s54 offen lds
    s_add_u32 m0, s87, 13312
    s_add_u32 s54, s84, 2129920
    buffer_load_dwordx4 v49, s[12:15], s54 offen lds
    s_add_u32 m0, s87, 14336
    s_add_u32 s54, s84, 2162688
    buffer_load_dwordx4 v48, s[12:15], s54 offen lds
    s_add_u32 m0, s87, 15360
    s_add_u32 s54, s84, 2195456
    buffer_load_dwordx4 v49, s[12:15], s54 offen lds
    s_add_u32 m0, s87, 16384
    s_add_u32 s54, s84, 2621440
    buffer_load_dwordx4 v48, s[12:15], s54 offen lds
    s_add_u32 m0, s87, 17408
    s_add_u32 s54, s84, 2654208
    buffer_load_dwordx4 v49, s[12:15], s54 offen lds
    s_add_u32 m0, s87, 18432
    s_add_u32 s54, s84, 2686976
    buffer_load_dwordx4 v48, s[12:15], s54 offen lds
    s_add_u32 m0, s87, 19456
    s_add_u32 s54, s84, 2719744
    buffer_load_dwordx4 v49, s[12:15], s54 offen lds
    s_add_u32 m0, s87, 20480
    s_add_u32 s54, s84, 3145728
    buffer_load_dwordx4 v48, s[12:15], s54 offen lds
    s_add_u32 m0, s87, 21504
    s_add_u32 s54, s84, 3178496
    buffer_load_dwordx4 v49, s[12:15], s54 offen lds
    s_add_u32 m0, s87, 22528
    s_add_u32 s54, s84, 3211264
    buffer_load_dwordx4 v48, s[12:15], s54 offen lds
    s_add_u32 m0, s87, 23552
    s_add_u32 s54, s84, 3244032
    buffer_load_dwordx4 v49, s[12:15], s54 offen lds
    s_add_u32 m0, s87, 24576
    s_add_u32 s54, s85, 4194304
    buffer_load_dwordx4 v50, s[16:19], s54 offen lds
    s_add_u32 m0, s87, 25600
    s_add_u32 s54, s85, 4259840
    buffer_load_dwordx4 v51, s[16:19], s54 offen lds
    s_add_u32 m0, s87, 26624
    s_add_u32 s54, s85, 4325376
    buffer_load_dwordx4 v50, s[16:19], s54 offen lds
    s_add_u32 m0, s87, 27648
    s_add_u32 s54, s85, 4390912
    buffer_load_dwordx4 v51, s[16:19], s54 offen lds
    s_add_u32 m0, s87, 28672
    s_add_u32 s54, s84, 0
    buffer_load_dwordx4 v48, s[16:19], s54 offen lds
    s_add_u32 m0, s87, 29696
    s_add_u32 s54, s84, 32768
    buffer_load_dwordx4 v49, s[16:19], s54 offen lds
    s_add_u32 m0, s87, 30720
    s_add_u32 s54, s84, 65536
    buffer_load_dwordx4 v48, s[16:19], s54 offen lds
    s_add_u32 m0, s87, 31744
    s_add_u32 s54, s84, 98304
    buffer_load_dwordx4 v49, s[16:19], s54 offen lds
    s_add_u32 m0, s87, 32768
    s_add_u32 s54, s84, 1048576
    buffer_load_dwordx4 v48, s[16:19], s54 offen lds
    s_add_u32 m0, s87, 33792
    s_add_u32 s54, s84, 1081344
    buffer_load_dwordx4 v49, s[16:19], s54 offen lds
    s_add_u32 m0, s87, 34816
    s_add_u32 s54, s84, 1114112
    buffer_load_dwordx4 v48, s[16:19], s54 offen lds
    s_add_u32 m0, s87, 35840
    s_add_u32 s54, s84, 1146880
    buffer_load_dwordx4 v49, s[16:19], s54 offen lds
    s_waitcnt vmcnt(32)
    v_lshl_or_b32 v24, v25, 16, v24
    v_min_u32 v24, -2, v24
    ds_write_b32 v21, v24 offset:7168
    v_lshl_or_b32 v26, v27, 16, v26
    v_min_u32 v26, -2, v26
    ds_write_b32 v21, v26 offset:8192
    v_lshl_or_b32 v28, v29, 16, v28
    v_min_u32 v28, -2, v28
    ds_write_b32 v21, v28 offset:9216
    v_lshl_or_b32 v30, v31, 16, v30
    v_min_u32 v30, -2, v30
    ds_write_b32 v21, v30 offset:10240
    v_lshl_or_b32 v32, v33, 16, v32
    v_min_u32 v32, -2, v32
    ds_write_b32 v21, v32 offset:11264
    v_lshl_or_b32 v34, v35, 16, v34
    v_min_u32 v34, -2, v34
    ds_write_b32 v21, v34 offset:12288
    v_lshl_or_b32 v36, v37, 16, v36
    v_min_u32 v36, -2, v36
    ds_write_b32 v21, v36 offset:13312
    v_lshl_or_b32 v38, v39, 16, v38
    v_min_u32 v38, -2, v38
    ds_write_b32 v21, v38 offset:14336
    v_lshl_or_b32 v40, v41, 16, v40
    v_min_u32 v40, -2, v40
    ds_write_b32 v21, v40 offset:15360
    s_waitcnt lgkmcnt(0)
    s_barrier
    s_lshl_b32 s52, s49, 6
    s_add_u32 s52, s52, 4
    v_mov_b32 v12, s52
    v_mov_b32 v13, 1
    s_cmp_lg_u32 s51, 0
    s_cbranch_scc1 L_tb_w_16
    s_mov_b64 exec, 1
    global_atomic_add v12, v13, s[44:45]
    s_mov_b64 exec, -1
L_tb_w_16:
    v_add_u32 v16, 16384, v56
    v_add_u32 v17, 53248, v56
    v_add_u32 v18, 90112, v56
    v_add_u32 v19, 126976, v56
    ds_read_b64_tr_b16 v[80:81], v16 offset:0
    ds_read_b64_tr_b16 v[82:83], v17 offset:0
    ds_read_b64_tr_b16 v[84:85], v18 offset:0
    ds_read_b64_tr_b16 v[86:87], v19 offset:0
    ds_read_b64_tr_b16 v[88:89], v16 offset:16
    ds_read_b64_tr_b16 v[90:91], v17 offset:16
    ds_read_b64_tr_b16 v[92:93], v18 offset:16
    ds_read_b64_tr_b16 v[94:95], v19 offset:16
    s_waitcnt vmcnt(28)
    s_waitcnt lgkmcnt(0)
    s_barrier
    s_add_u32 m0, s87, 0
    s_add_u32 s54, s84, 1572864
    buffer_load_dwordx4 v48, s[16:19], s54 offen lds
    s_add_u32 m0, s87, 1024
    s_add_u32 s54, s84, 1605632
    buffer_load_dwordx4 v49, s[16:19], s54 offen lds
    s_add_u32 m0, s87, 2048
    s_add_u32 s54, s84, 1638400
    buffer_load_dwordx4 v48, s[16:19], s54 offen lds
    s_add_u32 m0, s87, 3072
    s_add_u32 s54, s84, 1671168
    buffer_load_dwordx4 v49, s[16:19], s54 offen lds
    v_add_u32 v16, 16384, v56
    v_add_u32 v17, 53248, v56
    v_add_u32 v18, 90112, v56
    v_add_u32 v19, 126976, v56
    ds_read_b64_tr_b16 v[96:97], v16 offset:4096
    ds_read_b64_tr_b16 v[98:99], v17 offset:4096
    ds_read_b64_tr_b16 v[100:101], v18 offset:4096
    ds_read_b64_tr_b16 v[102:103], v19 offset:4096
    ds_read_b64_tr_b16 v[104:105], v16 offset:4112
    ds_read_b64_tr_b16 v[106:107], v17 offset:4112
    ds_read_b64_tr_b16 v[108:109], v18 offset:4112
    ds_read_b64_tr_b16 v[110:111], v19 offset:4112
    s_waitcnt vmcnt(28)
    s_waitcnt lgkmcnt(0)
    s_barrier
    s_add_u32 m0, s87, 4096
    s_add_u32 s54, s84, 2097152
    buffer_load_dwordx4 v48, s[16:19], s54 offen lds
    s_add_u32 m0, s87, 5120
    s_add_u32 s54, s84, 2129920
    buffer_load_dwordx4 v49, s[16:19], s54 offen lds
    s_add_u32 m0, s87, 6144
    s_add_u32 s54, s84, 2162688
    buffer_load_dwordx4 v48, s[16:19], s54 offen lds
    s_add_u32 m0, s87, 7168
    s_add_u32 s54, s84, 2195456
    buffer_load_dwordx4 v49, s[16:19], s54 offen lds
    v_add_u32 v16, 16384, v56
    v_add_u32 v17, 53248, v56
    v_add_u32 v18, 90112, v56
    v_add_u32 v19, 126976, v56
    ds_read_b64_tr_b16 v[112:113], v16 offset:8192
    ds_read_b64_tr_b16 v[114:115], v17 offset:8192
    ds_read_b64_tr_b16 v[116:117], v18 offset:8192
    ds_read_b64_tr_b16 v[118:119], v19 offset:8192
    ds_read_b64_tr_b16 v[120:121], v16 offset:8208
    ds_read_b64_tr_b16 v[122:123], v17 offset:8208
    ds_read_b64_tr_b16 v[124:125], v18 offset:8208
    ds_read_b64_tr_b16 v[126:127], v19 offset:8208
    s_waitcnt vmcnt(28)
    s_waitcnt lgkmcnt(0)
    s_barrier
    s_add_u32 m0, s87, 8192
    s_add_u32 s54, s84, 3145728
    buffer_load_dwordx4 v48, s[16:19], s54 offen lds
    s_add_u32 m0, s87, 9216
    s_add_u32 s54, s84, 3178496
    buffer_load_dwordx4 v49, s[16:19], s54 offen lds
    s_add_u32 m0, s87, 10240
    s_add_u32 s54, s84, 3211264
    buffer_load_dwordx4 v48, s[16:19], s54 offen lds
    s_add_u32 m0, s87, 11264
    s_add_u32 s54, s84, 3244032
    buffer_load_dwordx4 v49, s[16:19], s54 offen lds
    v_add_u32 v16, 16384, v56
    v_add_u32 v17, 53248, v56
    v_add_u32 v18, 90112, v56
    v_add_u32 v19, 126976, v56
    ds_read_b64_tr_b16 v[128:129], v16 offset:12288
    ds_read_b64_tr_b16 v[130:131], v17 offset:12288
    ds_read_b64_tr_b16 v[132:133], v18 offset:12288
    ds_read_b64_tr_b16 v[134:135], v19 offset:12288
    ds_read_b64_tr_b16 v[136:137], v16 offset:12304
    ds_read_b64_tr_b16 v[138:139], v17 offset:12304
    ds_read_b64_tr_b16 v[140:141], v18 offset:12304
    ds_read_b64_tr_b16 v[142:143], v19 offset:12304
    s_waitcnt vmcnt(28)
    s_waitcnt lgkmcnt(0)
    s_barrier
    s_add_u32 m0, s87, 12288
    s_add_u32 s54, s84, 3670016
    buffer_load_dwordx4 v48, s[16:19], s54 offen lds
    s_add_u32 m0, s87, 13312
    s_add_u32 s54, s84, 3702784
    buffer_load_dwordx4 v49, s[16:19], s54 offen lds
    s_add_u32 m0, s87, 14336
    s_add_u32 s54, s84, 3735552
    buffer_load_dwordx4 v48, s[16:19], s54 offen lds
    s_add_u32 m0, s87, 15360
    s_add_u32 s54, s84, 3768320
    buffer_load_dwordx4 v49, s[16:19], s54 offen lds
    v_add_u32 v16, 16384, v56
    v_add_u32 v17, 53248, v56
    v_add_u32 v18, 90112, v56
    v_add_u32 v19, 126976, v56
    ds_read_b64_tr_b16 v[144:145], v16 offset:16384
    ds_read_b64_tr_b16 v[146:147], v17 offset:16384
    ds_read_b64_tr_b16 v[148:149], v18 offset:16384
    ds_read_b64_tr_b16 v[150:151], v19 offset:16384
    ds_read_b64_tr_b16 v[152:153], v16 offset:16400
    ds_read_b64_tr_b16 v[154:155], v17 offset:16400
    ds_read_b64_tr_b16 v[156:157], v18 offset:16400
    ds_read_b64_tr_b16 v[158:159], v19 offset:16400
    s_waitcnt vmcnt(28)
    s_waitcnt lgkmcnt(0)
    s_barrier
    s_add_u32 m0, s87, 16384
    s_add_u32 s54, s85, 4194304
    buffer_load_dwordx4 v50, s[20:23], s54 offen lds
    s_add_u32 m0, s87, 17408
    s_add_u32 s54, s85, 4259840
    buffer_load_dwordx4 v51, s[20:23], s54 offen lds
    s_add_u32 m0, s87, 18432
    s_add_u32 s54, s85, 4325376
    buffer_load_dwordx4 v50, s[20:23], s54 offen lds
    s_add_u32 m0, s87, 19456
    s_add_u32 s54, s85, 4390912
    buffer_load_dwordx4 v51, s[20:23], s54 offen lds
    v_add_u32 v16, 16384, v56
    v_add_u32 v17, 53248, v56
    v_add_u32 v18, 90112, v56
    v_add_u32 v19, 126976, v56
    ds_read_b64_tr_b16 v[160:161], v16 offset:20480
    ds_read_b64_tr_b16 v[162:163], v17 offset:20480
    ds_read_b64_tr_b16 v[164:165], v18 offset:20480
    ds_read_b64_tr_b16 v[166:167], v19 offset:20480
    ds_read_b64_tr_b16 v[168:169], v16 offset:20496
    ds_read_b64_tr_b16 v[170:171], v17 offset:20496
    ds_read_b64_tr_b16 v[172:173], v18 offset:20496
    ds_read_b64_tr_b16 v[174:175], v19 offset:20496
    s_waitcnt vmcnt(28)
    s_waitcnt lgkmcnt(0)
    s_barrier
    s_add_u32 m0, s87, 20480
    s_add_u32 s54, s84, 0
    buffer_load_dwordx4 v48, s[20:23], s54 offen lds
    s_add_u32 m0, s87, 21504
    s_add_u32 s54, s84, 32768
    buffer_load_dwordx4 v49, s[20:23], s54 offen lds
    s_add_u32 m0, s87, 22528
    s_add_u32 s54, s84, 65536
    buffer_load_dwordx4 v48, s[20:23], s54 offen lds
    s_add_u32 m0, s87, 23552
    s_add_u32 s54, s84, 98304
    buffer_load_dwordx4 v49, s[20:23], s54 offen lds
    v_add_u32 v16, 16384, v56
    v_add_u32 v17, 53248, v56
    v_add_u32 v18, 90112, v56
    v_add_u32 v19, 126976, v56
    ds_read_b64_tr_b16 v[176:177], v16 offset:24576
    ds_read_b64_tr_b16 v[178:179], v17 offset:24576
    ds_read_b64_tr_b16 v[180:181], v18 offset:24576
    ds_read_b64_tr_b16 v[182:183], v19 offset:24576
    ds_read_b64_tr_b16 v[184:185], v16 offset:24592
    ds_read_b64_tr_b16 v[186:187], v17 offset:24592
    ds_read_b64_tr_b16 v[188:189], v18 offset:24592
    ds_read_b64_tr_b16 v[190:191], v19 offset:24592
    s_waitcnt vmcnt(28)
    s_waitcnt lgkmcnt(0)
    s_barrier
    s_add_u32 m0, s87, 24576
    s_add_u32 s54, s84, 524288
    buffer_load_dwordx4 v48, s[20:23], s54 offen lds
    s_add_u32 m0, s87, 25600
    s_add_u32 s54, s84, 557056
    buffer_load_dwordx4 v49, s[20:23], s54 offen lds
    s_add_u32 m0, s87, 26624
    s_add_u32 s54, s84, 589824
    buffer_load_dwordx4 v48, s[20:23], s54 offen lds
    s_add_u32 m0, s87, 27648
    s_add_u32 s54, s84, 622592
    buffer_load_dwordx4 v49, s[20:23], s54 offen lds
    v_add_u32 v16, 16384, v56
    v_add_u32 v17, 53248, v56
    v_add_u32 v18, 90112, v56
    v_add_u32 v19, 126976, v56
    ds_read_b64_tr_b16 v[192:193], v16 offset:28672
    ds_read_b64_tr_b16 v[194:195], v17 offset:28672
    ds_read_b64_tr_b16 v[196:197], v18 offset:28672
    ds_read_b64_tr_b16 v[198:199], v19 offset:28672
    ds_read_b64_tr_b16 v[200:201], v16 offset:28688
    ds_read_b64_tr_b16 v[202:203], v17 offset:28688
    ds_read_b64_tr_b16 v[204:205], v18 offset:28688
    ds_read_b64_tr_b16 v[206:207], v19 offset:28688
    s_waitcnt vmcnt(28)
    s_waitcnt lgkmcnt(0)
    s_barrier
    s_add_u32 m0, s87, 28672
    s_add_u32 s54, s84, 1048576
    buffer_load_dwordx4 v48, s[20:23], s54 offen lds
    s_add_u32 m0, s87, 29696
    s_add_u32 s54, s84, 1081344
    buffer_load_dwordx4 v49, s[20:23], s54 offen lds
    s_add_u32 m0, s87, 30720
    s_add_u32 s54, s84, 1114112
    buffer_load_dwordx4 v48, s[20:23], s54 offen lds
    s_add_u32 m0, s87, 31744
    s_add_u32 s54, s84, 1146880
    buffer_load_dwordx4 v49, s[20:23], s54 offen lds
    v_add_u32 v16, 16384, v56
    v_add_u32 v17, 53248, v56
    v_add_u32 v18, 90112, v56
    v_add_u32 v19, 126976, v56
    ds_read_b64_tr_b16 v[208:209], v16 offset:32768
    ds_read_b64_tr_b16 v[210:211], v17 offset:32768
    ds_read_b64_tr_b16 v[212:213], v18 offset:32768
    ds_read_b64_tr_b16 v[214:215], v19 offset:32768
    ds_read_b64_tr_b16 v[216:217], v16 offset:32784
    ds_read_b64_tr_b16 v[218:219], v17 offset:32784
    ds_read_b64_tr_b16 v[220:221], v18 offset:32784
    ds_read_b64_tr_b16 v[222:223], v19 offset:32784
    s_waitcnt vmcnt(28)
    s_waitcnt lgkmcnt(0)
    s_barrier
    s_add_u32 m0, s87, 32768
    s_add_u32 s54, s84, 1572864
    buffer_load_dwordx4 v48, s[20:23], s54 offen lds
    s_add_u32 m0, s87, 33792
    s_add_u32 s54, s84, 1605632
    buffer_load_dwordx4 v49, s[20:23], s54 offen lds
    s_add_u32 m0, s87, 34816
    s_add_u32 s54, s84, 1638400
    buffer_load_dwordx4 v48, s[20:23], s54 offen lds
    s_add_u32 m0, s87, 35840
    s_add_u32 s54, s84, 1671168
    buffer_load_dwordx4 v49, s[20:23], s54 offen lds
    v_add_u32 v16, 16384, v56
    v_add_u32 v17, 53248, v56
    v_add_u32 v18, 90112, v56
    v_add_u32 v19, 126976, v56
    ds_read_b64_tr_b16 v[224:225], v16 offset:0
    ds_read_b64_tr_b16 v[226:227], v17 offset:0
    ds_read_b64_tr_b16 v[228:229], v18 offset:0
    ds_read_b64_tr_b16 v[230:231], v19 offset:0
    ds_read_b64_tr_b16 v[232:233], v16 offset:16
    ds_read_b64_tr_b16 v[234:235], v17 offset:16
    ds_read_b64_tr_b16 v[236:237], v18 offset:16
    ds_read_b64_tr_b16 v[238:239], v19 offset:16
    s_waitcnt vmcnt(28)
    s_waitcnt lgkmcnt(0)
    s_barrier
    s_add_u32 m0, s87, 0
    s_add_u32 s54, s84, 2097152
    buffer_load_dwordx4 v48, s[20:23], s54 offen lds
    s_add_u32 m0, s87, 1024
    s_add_u32 s54, s84, 2129920
    buffer_load_dwordx4 v49, s[20:23], s54 offen lds
    s_add_u32 m0, s87, 2048
    s_add_u32 s54, s84, 2162688
    buffer_load_dwordx4 v48, s[20:23], s54 offen lds
    s_add_u32 m0, s87, 3072
    s_add_u32 s54, s84, 2195456
    buffer_load_dwordx4 v49, s[20:23], s54 offen lds
    v_add_u32 v16, 16384, v56
    v_add_u32 v17, 53248, v56
    v_add_u32 v18, 90112, v56
    v_add_u32 v19, 126976, v56
    ds_read_b64_tr_b16 v[240:241], v16 offset:4096
    ds_read_b64_tr_b16 v[242:243], v17 offset:4096
    ds_read_b64_tr_b16 v[244:245], v18 offset:4096
    ds_read_b64_tr_b16 v[246:247], v19 offset:4096
    ds_read_b64_tr_b16 v[248:249], v16 offset:4112
    ds_read_b64_tr_b16 v[250:251], v17 offset:4112
    ds_read_b64_tr_b16 v[252:253], v18 offset:4112
    ds_read_b64_tr_b16 v[254:255], v19 offset:4112
    s_waitcnt vmcnt(28)
    s_waitcnt lgkmcnt(0)
    s_barrier
    s_add_u32 m0, s87, 4096
    s_add_u32 s54, s84, 2621440
    buffer_load_dwordx4 v48, s[20:23], s54 offen lds
    s_add_u32 m0, s87, 5120
    s_add_u32 s54, s84, 2654208
    buffer_load_dwordx4 v49, s[20:23], s54 offen lds
    s_add_u32 m0, s87, 6144
    s_add_u32 s54, s84, 2686976
    buffer_load_dwordx4 v48, s[20:23], s54 offen lds
    s_add_u32 m0, s87, 7168
    s_add_u32 s54, s84, 2719744
    buffer_load_dwordx4 v49, s[20:23], s54 offen lds
    v_add_u32 v16, 16384, v56
    v_add_u32 v17, 53248, v56
    v_add_u32 v18, 90112, v56
    v_add_u32 v19, 126976, v56
    ds_read_b64_tr_b16 a[0:1], v16 offset:8192
    ds_read_b64_tr_b16 a[2:3], v17 offset:8192
    ds_read_b64_tr_b16 a[4:5], v18 offset:8192
    ds_read_b64_tr_b16 a[6:7], v19 offset:8192
    ds_read_b64_tr_b16 a[8:9], v16 offset:8208
    ds_read_b64_tr_b16 a[10:11], v17 offset:8208
    ds_read_b64_tr_b16 a[12:13], v18 offset:8208
    ds_read_b64_tr_b16 a[14:15], v19 offset:8208
    s_waitcnt vmcnt(28)
    s_waitcnt lgkmcnt(0)
    s_barrier
    s_add_u32 m0, s87, 8192
    s_add_u32 s54, s84, 3145728
    buffer_load_dwordx4 v48, s[20:23], s54 offen lds
    s_add_u32 m0, s87, 9216
    s_add_u32 s54, s84, 3178496
    buffer_load_dwordx4 v49, s[20:23], s54 offen lds
    s_add_u32 m0, s87, 10240
    s_add_u32 s54, s84, 3211264
    buffer_load_dwordx4 v48, s[20:23], s54 offen lds
    s_add_u32 m0, s87, 11264
    s_add_u32 s54, s84, 3244032
    buffer_load_dwordx4 v49, s[20:23], s54 offen lds
    v_add_u32 v16, 16384, v56
    v_add_u32 v17, 53248, v56
    v_add_u32 v18, 90112, v56
    v_add_u32 v19, 126976, v56
    ds_read_b64_tr_b16 a[16:17], v16 offset:12288
    ds_read_b64_tr_b16 a[18:19], v17 offset:12288
    ds_read_b64_tr_b16 a[20:21], v18 offset:12288
    ds_read_b64_tr_b16 a[22:23], v19 offset:12288
    ds_read_b64_tr_b16 a[24:25], v16 offset:12304
    ds_read_b64_tr_b16 a[26:27], v17 offset:12304
    ds_read_b64_tr_b16 a[28:29], v18 offset:12304
    ds_read_b64_tr_b16 a[30:31], v19 offset:12304
    s_waitcnt vmcnt(28)
    s_waitcnt lgkmcnt(0)
    s_barrier
    s_add_u32 m0, s87, 12288
    s_add_u32 s54, s84, 3670016
    buffer_load_dwordx4 v48, s[20:23], s54 offen lds
    s_add_u32 m0, s87, 13312
    s_add_u32 s54, s84, 3702784
    buffer_load_dwordx4 v49, s[20:23], s54 offen lds
    s_add_u32 m0, s87, 14336
    s_add_u32 s54, s84, 3735552
    buffer_load_dwordx4 v48, s[20:23], s54 offen lds
    s_add_u32 m0, s87, 15360
    s_add_u32 s54, s84, 3768320
    buffer_load_dwordx4 v49, s[20:23], s54 offen lds
    v_add_u32 v16, 16384, v57
    v_add_u32 v17, 53248, v57
    v_add_u32 v18, 90112, v57
    v_add_u32 v19, 126976, v57
    ds_read_b64_tr_b16 a[32:33], v16 offset:16384
    ds_read_b64_tr_b16 a[34:35], v17 offset:16384
    ds_read_b64_tr_b16 a[36:37], v18 offset:16384
    ds_read_b64_tr_b16 a[38:39], v19 offset:16384
    v_add_u32 v16, 16384, v58
    v_add_u32 v17, 53248, v58
    v_add_u32 v18, 90112, v58
    v_add_u32 v19, 126976, v58
    ds_read_b64_tr_b16 a[40:41], v16 offset:16384
    ds_read_b64_tr_b16 a[42:43], v17 offset:16384
    ds_read_b64_tr_b16 a[44:45], v18 offset:16384
    ds_read_b64_tr_b16 a[46:47], v19 offset:16384
    s_waitcnt vmcnt(28)
    s_waitcnt lgkmcnt(0)
    s_barrier
    s_add_u32 m0, s87, 16384
    s_add_u32 s54, s86, 73728
    buffer_load_dwordx4 v52, s[24:27], s54 offen lds
    s_add_u32 m0, s87, 17408
    s_add_u32 s54, s86, 92160
    buffer_load_dwordx4 v53, s[24:27], s54 offen lds
    s_add_u32 m0, s87, 18432
    s_add_u32 s54, s86, 78336
    buffer_load_dwordx4 v52, s[24:27], s54 offen lds
    s_add_u32 m0, s87, 19456
    s_add_u32 s54, s86, 96768
    buffer_load_dwordx4 v53, s[24:27], s54 offen lds
    v_add_u32 v16, 16384, v57
    v_add_u32 v17, 53248, v57
    v_add_u32 v18, 90112, v57
    v_add_u32 v19, 126976, v57
    ds_read_b64_tr_b16 a[48:49], v16 offset:20480
    ds_read_b64_tr_b16 a[50:51], v17 offset:20480
    ds_read_b64_tr_b16 a[52:53], v18 offset:20480
    ds_read_b64_tr_b16 a[54:55], v19 offset:20480
    v_add_u32 v16, 16384, v58
    v_add_u32 v17, 53248, v58
    v_add_u32 v18, 90112, v58
    v_add_u32 v19, 126976, v58
    ds_read_b64_tr_b16 a[56:57], v16 offset:20480
    ds_read_b64_tr_b16 a[58:59], v17 offset:20480
    ds_read_b64_tr_b16 a[60:61], v18 offset:20480
    ds_read_b64_tr_b16 a[62:63], v19 offset:20480
    s_waitcnt vmcnt(28)
    s_waitcnt lgkmcnt(0)
    s_barrier
    s_add_u32 m0, s87, 20480
    s_add_u32 s54, s86, 256
    buffer_load_dwordx4 v52, s[24:27], s54 offen lds
    s_add_u32 m0, s87, 21504
    s_add_u32 s54, s86, 18688
    buffer_load_dwordx4 v53, s[24:27], s54 offen lds
    s_add_u32 m0, s87, 22528
    s_add_u32 s54, s86, 4864
    buffer_load_dwordx4 v52, s[24:27], s54 offen lds
    s_add_u32 m0, s87, 23552
    s_add_u32 s54, s86, 23296
    buffer_load_dwordx4 v53, s[24:27], s54 offen lds
    v_add_u32 v16, 16384, v57
    v_add_u32 v17, 53248, v57
    v_add_u32 v18, 90112, v57
    v_add_u32 v19, 126976, v57
    ds_read_b64_tr_b16 a[64:65], v16 offset:24576
    ds_read_b64_tr_b16 a[66:67], v17 offset:24576
    ds_read_b64_tr_b16 a[68:69], v18 offset:24576
    ds_read_b64_tr_b16 a[70:71], v19 offset:24576
    v_add_u32 v16, 16384, v58
    v_add_u32 v17, 53248, v58
    v_add_u32 v18, 90112, v58
    v_add_u32 v19, 126976, v58
    ds_read_b64_tr_b16 a[72:73], v16 offset:24576
    ds_read_b64_tr_b16 a[74:75], v17 offset:24576
    ds_read_b64_tr_b16 a[76:77], v18 offset:24576
    ds_read_b64_tr_b16 a[78:79], v19 offset:24576
    s_waitcnt vmcnt(28)
    s_waitcnt lgkmcnt(0)
    s_barrier
    s_add_u32 m0, s87, 24576
    s_add_u32 s54, s86, 73984
    buffer_load_dwordx4 v52, s[24:27], s54 offen lds
    s_add_u32 m0, s87, 25600
    s_add_u32 s54, s86, 92416
    buffer_load_dwordx4 v53, s[24:27], s54 offen lds
    s_add_u32 m0, s87, 26624
    s_add_u32 s54, s86, 78592
    buffer_load_dwordx4 v52, s[24:27], s54 offen lds
    s_add_u32 m0, s87, 27648
    s_add_u32 s54, s86, 97024
    buffer_load_dwordx4 v53, s[24:27], s54 offen lds
    v_add_u32 v16, 16384, v57
    v_add_u32 v17, 53248, v57
    v_add_u32 v18, 90112, v57
    v_add_u32 v19, 126976, v57
    ds_read_b64_tr_b16 a[80:81], v16 offset:28672
    ds_read_b64_tr_b16 a[82:83], v17 offset:28672
    ds_read_b64_tr_b16 a[84:85], v18 offset:28672
    ds_read_b64_tr_b16 a[86:87], v19 offset:28672
    v_add_u32 v16, 16384, v58
    v_add_u32 v17, 53248, v58
    v_add_u32 v18, 90112, v58
    v_add_u32 v19, 126976, v58
    ds_read_b64_tr_b16 a[88:89], v16 offset:28672
    ds_read_b64_tr_b16 a[90:91], v17 offset:28672
    ds_read_b64_tr_b16 a[92:93], v18 offset:28672
    ds_read_b64_tr_b16 a[94:95], v19 offset:28672
    s_waitcnt vmcnt(28)
    s_waitcnt lgkmcnt(0)
    s_barrier
    s_add_u32 m0, s87, 28672
    s_add_u32 s54, s86, 512
    buffer_load_dwordx4 v52, s[24:27], s54 offen lds
    s_add_u32 m0, s87, 29696
    s_add_u32 s54, s86, 18944
    buffer_load_dwordx4 v53, s[24:27], s54 offen lds
    s_add_u32 m0, s87, 30720
    s_add_u32 s54, s86, 5120
    buffer_load_dwordx4 v52, s[24:27], s54 offen lds
    s_add_u32 m0, s87, 31744
    s_add_u32 s54, s86, 23552
    buffer_load_dwordx4 v53, s[24:27], s54 offen lds
    v_add_u32 v16, 16384, v57
    v_add_u32 v17, 53248, v57
    v_add_u32 v18, 90112, v57
    v_add_u32 v19, 126976, v57
    ds_read_b64_tr_b16 a[96:97], v16 offset:32768
    ds_read_b64_tr_b16 a[98:99], v17 offset:32768
    ds_read_b64_tr_b16 a[100:101], v18 offset:32768
    ds_read_b64_tr_b16 a[102:103], v19 offset:32768
    v_add_u32 v16, 16384, v58
    v_add_u32 v17, 53248, v58
    v_add_u32 v18, 90112, v58
    v_add_u32 v19, 126976, v58
    ds_read_b64_tr_b16 a[104:105], v16 offset:32768
    ds_read_b64_tr_b16 a[106:107], v17 offset:32768
    ds_read_b64_tr_b16 a[108:109], v18 offset:32768
    ds_read_b64_tr_b16 a[110:111], v19 offset:32768
    s_waitcnt vmcnt(28)
    s_waitcnt lgkmcnt(0)
    s_barrier
    v_lshrrev_b32 v12, 2, v2
    global_load_dword v13, v12, s[44:45] sc1
    s_add_u32 m0, s87, 32768
    s_add_u32 s54, s86, 768
    buffer_load_dwordx4 v52, s[24:27], s54 offen lds
    s_add_u32 m0, s87, 33792
    s_add_u32 s54, s86, 19200
    buffer_load_dwordx4 v53, s[24:27], s54 offen lds
    s_add_u32 m0, s87, 34816
    s_add_u32 s54, s86, 5376
    buffer_load_dwordx4 v52, s[24:27], s54 offen lds
    s_add_u32 m0, s87, 35840
    s_add_u32 s54, s86, 23808
    buffer_load_dwordx4 v53, s[24:27], s54 offen lds
    v_add_u32 v16, 16384, v57
    v_add_u32 v17, 53248, v57
    v_add_u32 v18, 90112, v57
    v_add_u32 v19, 126976, v57
    ds_read_b64_tr_b16 a[112:113], v16 offset:0
    ds_read_b64_tr_b16 a[114:115], v17 offset:0
    ds_read_b64_tr_b16 a[116:117], v18 offset:0
    ds_read_b64_tr_b16 a[118:119], v19 offset:0
    v_add_u32 v16, 16384, v58
    v_add_u32 v17, 53248, v58
    v_add_u32 v18, 90112, v58
    v_add_u32 v19, 126976, v58
    ds_read_b64_tr_b16 a[120:121], v16 offset:0
    ds_read_b64_tr_b16 a[122:123], v17 offset:0
    ds_read_b64_tr_b16 a[124:125], v18 offset:0
    ds_read_b64_tr_b16 a[126:127], v19 offset:0
    s_waitcnt vmcnt(28)
    s_waitcnt lgkmcnt(0)
    s_barrier
    s_add_u32 m0, s87, 0
    s_add_u32 s54, s85, 4194304
    buffer_load_dwordx4 v50, s[12:15], s54 offen lds
    s_add_u32 m0, s87, 1024
    s_add_u32 s54, s85, 4259840
    buffer_load_dwordx4 v51, s[12:15], s54 offen lds
    s_add_u32 m0, s87, 2048
    s_add_u32 s54, s85, 4325376
    buffer_load_dwordx4 v50, s[12:15], s54 offen lds
    s_add_u32 m0, s87, 3072
    s_add_u32 s54, s85, 4390912
    buffer_load_dwordx4 v51, s[12:15], s54 offen lds
    v_add_u32 v16, 16384, v57
    v_add_u32 v17, 53248, v57
    v_add_u32 v18, 90112, v57
    v_add_u32 v19, 126976, v57
    ds_read_b64_tr_b16 a[128:129], v16 offset:4096
    ds_read_b64_tr_b16 a[130:131], v17 offset:4096
    ds_read_b64_tr_b16 a[132:133], v18 offset:4096
    ds_read_b64_tr_b16 a[134:135], v19 offset:4096
    v_add_u32 v16, 16384, v58
    v_add_u32 v17, 53248, v58
    v_add_u32 v18, 90112, v58
    v_add_u32 v19, 126976, v58
    ds_read_b64_tr_b16 a[136:137], v16 offset:4096
    ds_read_b64_tr_b16 a[138:139], v17 offset:4096
    ds_read_b64_tr_b16 a[140:141], v18 offset:4096
    ds_read_b64_tr_b16 a[142:143], v19 offset:4096
    s_waitcnt vmcnt(28)
    s_waitcnt lgkmcnt(0)
    s_barrier
    s_add_u32 m0, s87, 4096
    s_add_u32 s54, s84, 524288
    buffer_load_dwordx4 v48, s[16:19], s54 offen lds
    s_add_u32 m0, s87, 5120
    s_add_u32 s54, s84, 557056
    buffer_load_dwordx4 v49, s[16:19], s54 offen lds
    s_add_u32 m0, s87, 6144
    s_add_u32 s54, s84, 589824
    buffer_load_dwordx4 v48, s[16:19], s54 offen lds
    s_add_u32 m0, s87, 7168
    s_add_u32 s54, s84, 622592
    buffer_load_dwordx4 v49, s[16:19], s54 offen lds
    v_add_u32 v16, 16384, v57
    v_add_u32 v17, 53248, v57
    v_add_u32 v18, 90112, v57
    v_add_u32 v19, 126976, v57
    ds_read_b64_tr_b16 a[144:145], v16 offset:8192
    ds_read_b64_tr_b16 a[146:147], v17 offset:8192
    ds_read_b64_tr_b16 a[148:149], v18 offset:8192
    ds_read_b64_tr_b16 a[150:151], v19 offset:8192
    v_add_u32 v16, 16384, v58
    v_add_u32 v17, 53248, v58
    v_add_u32 v18, 90112, v58
    v_add_u32 v19, 126976, v58
    ds_read_b64_tr_b16 a[152:153], v16 offset:8192
    ds_read_b64_tr_b16 a[154:155], v17 offset:8192
    ds_read_b64_tr_b16 a[156:157], v18 offset:8192
    ds_read_b64_tr_b16 a[158:159], v19 offset:8192
    s_waitcnt vmcnt(28)
    s_waitcnt lgkmcnt(0)
    s_barrier
    s_add_u32 m0, s87, 8192
    s_add_u32 s54, s84, 1572864
    buffer_load_dwordx4 v48, s[12:15], s54 offen lds
    s_add_u32 m0, s87, 9216
    s_add_u32 s54, s84, 1605632
    buffer_load_dwordx4 v49, s[12:15], s54 offen lds
    s_add_u32 m0, s87, 10240
    s_add_u32 s54, s84, 1638400
    buffer_load_dwordx4 v48, s[12:15], s54 offen lds
    s_add_u32 m0, s87, 11264
    s_add_u32 s54, s84, 1671168
    buffer_load_dwordx4 v49, s[12:15], s54 offen lds
    v_add_u32 v16, 16384, v57
    v_add_u32 v17, 53248, v57
    v_add_u32 v18, 90112, v57
    v_add_u32 v19, 126976, v57
    ds_read_b64_tr_b16 a[160:161], v16 offset:12288
    ds_read_b64_tr_b16 a[162:163], v17 offset:12288
    ds_read_b64_tr_b16 a[164:165], v18 offset:12288
    ds_read_b64_tr_b16 a[166:167], v19 offset:12288
    v_add_u32 v16, 16384, v58
    v_add_u32 v17, 53248, v58
    v_add_u32 v18, 90112, v58
    v_add_u32 v19, 126976, v58
    ds_read_b64_tr_b16 a[168:169], v16 offset:12288
    ds_read_b64_tr_b16 a[170:171], v17 offset:12288
    ds_read_b64_tr_b16 a[172:173], v18 offset:12288
    ds_read_b64_tr_b16 a[174:175], v19 offset:12288
    s_waitcnt vmcnt(28)
    s_waitcnt lgkmcnt(0)
    s_barrier
    s_add_u32 m0, s87, 12288
    s_add_u32 s54, s84, 2621440
    buffer_load_dwordx4 v48, s[16:19], s54 offen lds
    s_add_u32 m0, s87, 13312
    s_add_u32 s54, s84, 2654208
    buffer_load_dwordx4 v49, s[16:19], s54 offen lds
    s_add_u32 m0, s87, 14336
    s_add_u32 s54, s84, 2686976
    buffer_load_dwordx4 v48, s[16:19], s54 offen lds
    s_add_u32 m0, s87, 15360
    s_add_u32 s54, s84, 2719744
    buffer_load_dwordx4 v49, s[16:19], s54 offen lds
    v_add_u32 v16, 16384, v57
    v_add_u32 v17, 53248, v57
    v_add_u32 v18, 90112, v57
    v_add_u32 v19, 126976, v57
    ds_read_b64_tr_b16 a[176:177], v16 offset:16384
    ds_read_b64_tr_b16 a[178:179], v17 offset:16384
    ds_read_b64_tr_b16 a[180:181], v18 offset:16384
    ds_read_b64_tr_b16 a[182:183], v19 offset:16384
    v_add_u32 v16, 16384, v58
    v_add_u32 v17, 53248, v58
    v_add_u32 v18, 90112, v58
    v_add_u32 v19, 126976, v58
    ds_read_b64_tr_b16 a[184:185], v16 offset:16384
    ds_read_b64_tr_b16 a[186:187], v17 offset:16384
    ds_read_b64_tr_b16 a[188:189], v18 offset:16384
    ds_read_b64_tr_b16 a[190:191], v19 offset:16384
    s_waitcnt vmcnt(28)
    s_waitcnt lgkmcnt(0)
    s_barrier
    s_add_u32 m0, s87, 16384
    s_add_u32 s54, s84, 3670016
    buffer_load_dwordx4 v48, s[12:15], s54 offen lds
    s_add_u32 m0, s87, 17408
    s_add_u32 s54, s84, 3702784
    buffer_load_dwordx4 v49, s[12:15], s54 offen lds
    s_add_u32 m0, s87, 18432
    s_add_u32 s54, s84, 3735552
    buffer_load_dwordx4 v48, s[12:15], s54 offen lds
    s_add_u32 m0, s87, 19456
    s_add_u32 s54, s84, 3768320
    buffer_load_dwordx4 v49, s[12:15], s54 offen lds
    v_add_u32 v16, 16384, v57
    v_add_u32 v17, 53248, v57
    v_add_u32 v18, 90112, v57
    v_add_u32 v19, 126976, v57
    ds_read_b64_tr_b16 a[192:193], v16 offset:20480
    ds_read_b64_tr_b16 a[194:195], v17 offset:20480
    ds_read_b64_tr_b16 a[196:197], v18 offset:20480
    ds_read_b64_tr_b16 a[198:199], v19 offset:20480
    v_add_u32 v16, 16384, v58
    v_add_u32 v17, 53248, v58
    v_add_u32 v18, 90112, v58
    v_add_u32 v19, 126976, v58
    ds_read_b64_tr_b16 a[200:201], v16 offset:20480
    ds_read_b64_tr_b16 a[202:203], v17 offset:20480
    ds_read_b64_tr_b16 a[204:205], v18 offset:20480
    ds_read_b64_tr_b16 a[206:207], v19 offset:20480
    s_waitcnt vmcnt(28)
    s_waitcnt lgkmcnt(0)
    s_barrier
    s_add_u32 m0, s87, 20480
    s_add_u32 s54, s86, 1024
    buffer_load_dwordx4 v54, s[24:27], s54 offen lds
    s_add_u32 m0, s87, 21504
    s_add_u32 s54, s86, 19456
    buffer_load_dwordx4 v55, s[24:27], s54 offen lds
    s_add_u32 m0, s87, 22528
    s_add_u32 s54, s86, 5632
    buffer_load_dwordx4 v54, s[24:27], s54 offen lds
    s_add_u32 m0, s87, 23552
    s_add_u32 s54, s86, 24064
    buffer_load_dwordx4 v55, s[24:27], s54 offen lds
    v_add_u32 v16, 16384, v57
    v_add_u32 v17, 53248, v57
    v_add_u32 v18, 90112, v57
    v_add_u32 v19, 126976, v57
    ds_read_b64_tr_b16 a[208:209], v16 offset:24576
    ds_read_b64_tr_b16 a[210:211], v17 offset:24576
    ds_read_b64_tr_b16 a[212:213], v18 offset:24576
    ds_read_b64_tr_b16 a[214:215], v19 offset:24576
    v_add_u32 v16, 16384, v58
    v_add_u32 v17, 53248, v58
    v_add_u32 v18, 90112, v58
    v_add_u32 v19, 126976, v58
    ds_read_b64_tr_b16 a[216:217], v16 offset:24576
    ds_read_b64_tr_b16 a[218:219], v17 offset:24576
    ds_read_b64_tr_b16 a[220:221], v18 offset:24576
    ds_read_b64_tr_b16 a[222:223], v19 offset:24576
    s_waitcnt vmcnt(28)
    s_waitcnt lgkmcnt(0)
    s_barrier
    s_add_u32 m0, s87, 24576
    s_add_u32 s54, s86, 0
    buffer_load_dwordx4 v52, s[24:27], s54 offen lds
    s_add_u32 m0, s87, 25600
    s_add_u32 s54, s86, 18432
    buffer_load_dwordx4 v53, s[24:27], s54 offen lds
    s_add_u32 m0, s87, 26624
    s_add_u32 s54, s86, 4608
    buffer_load_dwordx4 v52, s[24:27], s54 offen lds
    s_add_u32 m0, s87, 27648
    s_add_u32 s54, s86, 23040
    buffer_load_dwordx4 v53, s[24:27], s54 offen lds
    v_add_u32 v16, 16384, v57
    v_add_u32 v17, 53248, v57
    v_add_u32 v18, 90112, v57
    v_add_u32 v19, 126976, v57
    ds_read_b64_tr_b16 a[224:225], v16 offset:28672
    ds_read_b64_tr_b16 a[226:227], v17 offset:28672
    ds_read_b64_tr_b16 a[228:229], v18 offset:28672
    ds_read_b64_tr_b16 a[230:231], v19 offset:28672
    v_add_u32 v16, 16384, v58
    v_add_u32 v17, 53248, v58
    v_add_u32 v18, 90112, v58
    v_add_u32 v19, 126976, v58
    ds_read_b64_tr_b16 a[232:233], v16 offset:28672
    ds_read_b64_tr_b16 a[234:235], v17 offset:28672
    ds_read_b64_tr_b16 a[236:237], v18 offset:28672
    ds_read_b64_tr_b16 a[238:239], v19 offset:28672
    s_waitcnt vmcnt(28)
    s_waitcnt lgkmcnt(0)
    s_barrier
    s_add_u32 m0, s87, 28672
    s_add_u32 s54, s86, 74240
    buffer_load_dwordx4 v52, s[24:27], s54 offen lds
    s_add_u32 m0, s87, 29696
    s_add_u32 s54, s86, 92672
    buffer_load_dwordx4 v53, s[24:27], s54 offen lds
    s_add_u32 m0, s87, 30720
    s_add_u32 s54, s86, 78848
    buffer_load_dwordx4 v52, s[24:27], s54 offen lds
    s_add_u32 m0, s87, 31744
    s_add_u32 s54, s86, 97280
    buffer_load_dwordx4 v53, s[24:27], s54 offen lds
    v_add_u32 v16, 16384, v57
    v_add_u32 v17, 53248, v57
    v_add_u32 v18, 90112, v57
    v_add_u32 v19, 126976, v57
    ds_read_b64_tr_b16 a[240:241], v16 offset:32768
    ds_read_b64_tr_b16 a[242:243], v17 offset:32768
    ds_read_b64_tr_b16 a[244:245], v18 offset:32768
    ds_read_b64_tr_b16 a[246:247], v19 offset:32768
    v_add_u32 v16, 16384, v58
    v_add_u32 v17, 53248, v58
    v_add_u32 v18, 90112, v58
    v_add_u32 v19, 126976, v58
    ds_read_b64_tr_b16 a[248:249], v16 offset:32768
    ds_read_b64_tr_b16 a[250:251], v17 offset:32768
    ds_read_b64_tr_b16 a[252:253], v18 offset:32768
    ds_read_b64_tr_b16 a[254:255], v19 offset:32768
    s_waitcnt vmcnt(28)
    s_waitcnt lgkmcnt(0)
    s_barrier
    s_add_u32 m0, s87, 32768
    s_add_u32 s54, s86, 74496
    buffer_load_dwordx4 v52, s[24:27], s54 offen lds
    s_add_u32 m0, s87, 33792
    s_add_u32 s54, s86, 92928
    buffer_load_dwordx4 v53, s[24:27], s54 offen lds
    s_add_u32 m0, s87, 34816
    s_add_u32 s54, s86, 79104
    buffer_load_dwordx4 v52, s[24:27], s54 offen lds
    s_add_u32 m0, s87, 35840
    s_add_u32 s54, s86, 97536
    buffer_load_dwordx4 v53, s[24:27], s54 offen lds
    v_add_u32 v16, 16384, v56
    v_add_u32 v17, 53248, v56
    v_add_u32 v18, 90112, v56
    v_add_u32 v19, 126976, v56
    ds_read_b64_tr_b16 v[24:25], v16 offset:0
    ds_read_b64_tr_b16 v[26:27], v17 offset:0
    ds_read_b64_tr_b16 v[28:29], v18 offset:0
    ds_read_b64_tr_b16 v[30:31], v19 offset:0
    ds_read_b64_tr_b16 v[32:33], v16 offset:16
    ds_read_b64_tr_b16 v[34:35], v17 offset:16
    ds_read_b64_tr_b16 v[36:37], v18 offset:16
    ds_read_b64_tr_b16 v[38:39], v19 offset:16
    s_waitcnt vmcnt(28)
    s_waitcnt lgkmcnt(0)
    s_barrier
    ds_write_b128 v3, v[24:27] offset:0
    ds_write_b128 v3, v[28:31] offset:1024
    ds_write_b128 v3, v[32:35] offset:2048
    ds_write_b128 v3, v[36:39] offset:3072
    v_add_u32 v16, 16384, v56
    v_add_u32 v17, 53248, v56
    v_add_u32 v18, 90112, v56
    v_add_u32 v19, 126976, v56
    ds_read_b64_tr_b16 v[64:65], v16 offset:4096
    ds_read_b64_tr_b16 v[66:67], v17 offset:4096
    ds_read_b64_tr_b16 v[68:69], v18 offset:4096
    ds_read_b64_tr_b16 v[70:71], v19 offset:4096
    ds_read_b64_tr_b16 v[72:73], v16 offset:4112
    ds_read_b64_tr_b16 v[74:75], v17 offset:4112
    ds_read_b64_tr_b16 v[76:77], v18 offset:4112
    ds_read_b64_tr_b16 v[78:79], v19 offset:4112
    s_waitcnt vmcnt(24)
    s_waitcnt lgkmcnt(0)
    s_barrier
    ds_write_b128 v3, v[64:67] offset:4096
    ds_write_b128 v3, v[68:71] offset:5120
    ds_write_b128 v3, v[72:75] offset:6144
    ds_write_b128 v3, v[76:79] offset:7168
    v_add_u32 v16, 16384, v56
    v_add_u32 v17, 53248, v56
    v_add_u32 v18, 90112, v56
    v_add_u32 v19, 126976, v56
    ds_read_b64_tr_b16 v[24:25], v16 offset:8192
    ds_read_b64_tr_b16 v[26:27], v17 offset:8192
    ds_read_b64_tr_b16 v[28:29], v18 offset:8192
    ds_read_b64_tr_b16 v[30:31], v19 offset:8192
    ds_read_b64_tr_b16 v[32:33], v16 offset:8208
    ds_read_b64_tr_b16 v[34:35], v17 offset:8208
    ds_read_b64_tr_b16 v[36:37], v18 offset:8208
    ds_read_b64_tr_b16 v[38:39], v19 offset:8208
    s_waitcnt vmcnt(20)
    s_waitcnt lgkmcnt(0)
    s_barrier
    ds_write_b128 v3, v[24:27] offset:8192
    ds_write_b128 v3, v[28:31] offset:9216
    ds_write_b128 v3, v[32:35] offset:10240
    ds_write_b128 v3, v[36:39] offset:11264
    v_add_u32 v16, 16384, v56
    v_add_u32 v17, 53248, v56
    v_add_u32 v18, 90112, v56
    v_add_u32 v19, 126976, v56
    ds_read_b64_tr_b16 v[64:65], v16 offset:12288
    ds_read_b64_tr_b16 v[66:67], v17 offset:12288
    ds_read_b64_tr_b16 v[68:69], v18 offset:12288
    ds_read_b64_tr_b16 v[70:71], v19 offset:12288
    ds_read_b64_tr_b16 v[72:73], v16 offset:12304
    ds_read_b64_tr_b16 v[74:75], v17 offset:12304
    ds_read_b64_tr_b16 v[76:77], v18 offset:12304
    ds_read_b64_tr_b16 v[78:79], v19 offset:12304
    s_waitcnt vmcnt(16)
    s_waitcnt lgkmcnt(0)
    s_barrier
    s_lshl_b32 s98, s101, 7
    s_add_u32 s98, s98, 140705792
    buffer_load_dword v9, off, s[28:31], s98 sc1
    ds_write_b128 v3, v[64:67] offset:12288
    ds_write_b128 v3, v[68:71] offset:13312
    ds_write_b128 v3, v[72:75] offset:14336
    ds_write_b128 v3, v[76:79] offset:15360
    v_add_u32 v16, 16384, v56
    v_add_u32 v17, 53248, v56
    v_add_u32 v18, 90112, v56
    v_add_u32 v19, 126976, v56
    ds_read_b64_tr_b16 v[24:25], v16 offset:16384
    ds_read_b64_tr_b16 v[26:27], v17 offset:16384
    ds_read_b64_tr_b16 v[28:29], v18 offset:16384
    ds_read_b64_tr_b16 v[30:31], v19 offset:16384
    ds_read_b64_tr_b16 v[32:33], v16 offset:16400
    ds_read_b64_tr_b16 v[34:35], v17 offset:16400
    ds_read_b64_tr_b16 v[36:37], v18 offset:16400
    ds_read_b64_tr_b16 v[38:39], v19 offset:16400
    s_waitcnt vmcnt(12)
    s_waitcnt lgkmcnt(0)
    s_barrier
    ds_write_b128 v3, v[24:27] offset:16384
    ds_write_b128 v3, v[28:31] offset:17408
    ds_write_b128 v3, v[32:35] offset:18432
    ds_write_b128 v3, v[36:39] offset:19456
    v_add_u32 v16, 16384, v59
    v_add_u32 v17, 53248, v59
    v_add_u32 v18, 90112, v59
    v_add_u32 v19, 126976, v59
    ds_read_b64_tr_b16 v[64:65], v16 offset:20480
    ds_read_b64_tr_b16 v[66:67], v17 offset:20480
    ds_read_b64_tr_b16 v[68:69], v18 offset:20480
    ds_read_b64_tr_b16 v[70:71], v19 offset:20480
    v_add_u32 v16, 16384, v60
    v_add_u32 v17, 53248, v60
    v_add_u32 v18, 90112, v60
    v_add_u32 v19, 126976, v60
    ds_read_b64_tr_b16 v[72:73], v16 offset:20480
    ds_read_b64_tr_b16 v[74:75], v17 offset:20480
    ds_read_b64_tr_b16 v[76:77], v18 offset:20480
    ds_read_b64_tr_b16 v[78:79], v19 offset:20480
    s_waitcnt vmcnt(8)
    s_waitcnt lgkmcnt(0)
    s_barrier
    ds_write_b128 v3, v[64:67] offset:20480
    ds_write_b128 v3, v[68:71] offset:21504
    ds_write_b128 v3, v[72:75] offset:22528
    ds_write_b128 v3, v[76:79] offset:23552
    v_add_u32 v16, 16384, v57
    v_add_u32 v17, 53248, v57
    v_add_u32 v18, 90112, v57
    v_add_u32 v19, 126976, v57
    ds_read_b64_tr_b16 v[24:25], v16 offset:24576
    ds_read_b64_tr_b16 v[26:27], v17 offset:24576
    ds_read_b64_tr_b16 v[28:29], v18 offset:24576
    ds_read_b64_tr_b16 v[30:31], v19 offset:24576
    v_add_u32 v16, 16384, v58
    v_add_u32 v17, 53248, v58
    v_add_u32 v18, 90112, v58
    v_add_u32 v19, 126976, v58
    ds_read_b64_tr_b16 v[32:33], v16 offset:24576
    ds_read_b64_tr_b16 v[34:35], v17 offset:24576
    ds_read_b64_tr_b16 v[36:37], v18 offset:24576
    ds_read_b64_tr_b16 v[38:39], v19 offset:24576
    s_waitcnt vmcnt(4)
    s_waitcnt lgkmcnt(0)
    s_barrier
    ds_write_b128 v3, v[24:27] offset:24576
    ds_write_b128 v3, v[28:31] offset:25600
    ds_write_b128 v3, v[32:35] offset:26624
    ds_write_b128 v3, v[36:39] offset:27648
    v_add_u32 v16, 16384, v57
    v_add_u32 v17, 53248, v57
    v_add_u32 v18, 90112, v57
    v_add_u32 v19, 126976, v57
    ds_read_b64_tr_b16 v[64:65], v16 offset:28672
    ds_read_b64_tr_b16 v[66:67], v17 offset:28672
    ds_read_b64_tr_b16 v[68:69], v18 offset:28672
    ds_read_b64_tr_b16 v[70:71], v19 offset:28672
    v_add_u32 v16, 16384, v58
    v_add_u32 v17, 53248, v58
    v_add_u32 v18, 90112, v58
    v_add_u32 v19, 126976, v58
    ds_read_b64_tr_b16 v[72:73], v16 offset:28672
    ds_read_b64_tr_b16 v[74:75], v17 offset:28672
    ds_read_b64_tr_b16 v[76:77], v18 offset:28672
    ds_read_b64_tr_b16 v[78:79], v19 offset:28672
    s_waitcnt vmcnt(0)
    s_waitcnt lgkmcnt(0)
    s_barrier
    ds_write_b128 v3, v[64:67] offset:28672
    ds_write_b128 v3, v[68:71] offset:29696
    ds_write_b128 v3, v[72:75] offset:30720
    ds_write_b128 v3, v[76:79] offset:31744
    v_add_u32 v16, 16384, v57
    v_add_u32 v17, 53248, v57
    v_add_u32 v18, 90112, v57
    v_add_u32 v19, 126976, v57
    ds_read_b64_tr_b16 v[24:25], v16 offset:32768
    ds_read_b64_tr_b16 v[26:27], v17 offset:32768
    ds_read_b64_tr_b16 v[28:29], v18 offset:32768
    ds_read_b64_tr_b16 v[30:31], v19 offset:32768
    v_add_u32 v16, 16384, v58
    v_add_u32 v17, 53248, v58
    v_add_u32 v18, 90112, v58
    v_add_u32 v19, 126976, v58
    ds_read_b64_tr_b16 v[32:33], v16 offset:32768
    ds_read_b64_tr_b16 v[34:35], v17 offset:32768
    ds_read_b64_tr_b16 v[36:37], v18 offset:32768
    ds_read_b64_tr_b16 v[38:39], v19 offset:32768
    s_waitcnt lgkmcnt(0)
    s_barrier
    ds_write_b128 v3, v[24:27] offset:32768
    ds_write_b128 v3, v[28:31] offset:33792
    ds_write_b128 v3, v[32:35] offset:34816
    ds_write_b128 v3, v[36:39] offset:35840
    s_waitcnt lgkmcnt(0)
L_tm_p_19:
    v_readlane_b32 s84, v13, 0
    v_readlane_b32 s85, v13, 16
    v_readlane_b32 s86, v13, 32
    v_readlane_b32 s87, v13, 33
    v_readlane_b32 s88, v13, 34
    v_readlane_b32 s89, v13, 48
    v_readlane_b32 s90, v13, 49
    v_readlane_b32 s91, v13, 50
    v_readlane_b32 s92, v13, 51
    v_readlane_b32 s95, v13, 1
    v_readlane_b32 s96, v13, 17
    v_readlane_b32 s97, v13, 36
    s_nop 3
    s_add_u32 s93, s84, s85
    s_add_u32 s93, s93, s86
    s_add_u32 s93, s93, s87
    s_add_u32 s93, s93, s88
    s_add_u32 s93, s93, s89
    s_add_u32 s93, s93, s90
    s_add_u32 s93, s93, s91
    s_add_u32 s93, s93, s92
    s_cmp_eq_u32 s49, 0
    s_cselect_b32 s94, s84, s85
    s_cselect_b32 s95, s95, s96
    s_cmp_lt_u32 s95, 32
    s_cbranch_scc1 L_tm_a_20
    s_cmp_lt_u32 s97, 192
    s_cbranch_scc1 L_tm_a_20
    s_cmp_ge_u32 s94, 32
    s_cbranch_scc1 L_r_fast_17
    s_cmp_ge_u32 s93, 256
    s_cbranch_scc1 L_r_slow_18
L_tm_a_20:
    v_mov_b32 v9, 0
    s_sub_u32 s57, s57, 1
    s_cmp_eq_u32 s57, 0
    s_cbranch_scc1 L_exit
    v_lshrrev_b32 v12, 2, v2
    global_load_dword v13, v12, s[44:45] sc1
    s_waitcnt vmcnt(0)
    s_branch L_tm_p_19
L_r_fast_17:
    s_mov_b32 s37, 0
    s_lshl_b32 s64, s101, 2
    s_add_u32 s64, s64, s51
    s_lshl_b32 s64, s64, 7
    s_add_u32 s64, s64, 140673024
    s_cmp_gt_i32 s37, s56
    s_cbranch_scc1 L_kv_ok_27
    s_branch L_kv_u_29
L_kv_p_28:
    s_sub_u32 s57, s57, 1
    s_cmp_eq_u32 s57, 0
    s_cbranch_scc1 L_exit
    v_bfe_u32 v9, v2, 2, 4
    buffer_load_dword v9, v9, s[28:31], s98 offen sc1
    s_waitcnt vmcnt(0)
L_kv_u_29:
    v_readlane_b32 s37, v9, 0
    s_nop 3
    s_cmp_ge_u32 s37, 64
    s_cselect_b32 s37, 65, s37
    s_sub_u32 s37, s37, 1
    s_cmp_gt_i32 s37, s56
    s_cbranch_scc0 L_kv_p_28
L_kv_ok_27:
    ds_read_b128 v[64:67], v3 offset:0
    ds_read_b128 v[68:71], v3 offset:1024
    ds_read_b128 v[72:75], v3 offset:2048
    ds_read_b128 v[76:79], v3 offset:3072
    v_mov_b64 v[24:25], 0
    v_mov_b64 v[26:27], 0
    v_mov_b64 v[28:29], 0
    v_mov_b64 v[30:31], 0
    v_mov_b64 v[32:33], 0
    v_mov_b64 v[34:35], 0
    v_mov_b64 v[36:37], 0
    v_mov_b64 v[38:39], 0
    v_mov_b64 v[40:41], 0
    v_mov_b64 v[42:43], 0
    v_mov_b64 v[44:45], 0
    v_mov_b64 v[46:47], 0
    v_and_b32 v10, 0x300, v2
    v_add_u32 v60, v10, v2
    v_and_b32 v10, 0x80, v2
    v_add_u32 v52, v10, v60
    v_min_u32 v10, s34, v2
    v_bfe_u32 v11, v10, 5, 4
    v_add_lshl_u32 v10, v10, v11, 2
    v_add_u32 v11, s70, v10
.p2align 6
    s_nop 0
    s_nop 0
    s_nop 0
    s_nop 0
    s_nop 0
    s_nop 0
    s_nop 0
L_r_bar0_30:
    s_waitcnt vmcnt(0)
L_r_bar_31:
    s_waitcnt lgkmcnt(0)
    s_barrier
L_r_top_21:
    ds_read_b128 v[12:15], v2 offset:7168
    ds_read_b128 v[16:19], v2 offset:8192
    s_cmp_eq_u32 s35, 0
    s_cbranch_scc1 L_r_ng_32
    buffer_load_dwordx4 v2, s[28:31], s65 offen sc1 lds
    buffer_load_dwordx4 v2, s[28:31], s65 offen offset:1024 sc1 lds
L_r_ng_32:
    s_waitcnt lgkmcnt(1)
    v_smfmac_f32_16x16x64_bf16 v[24:27], v[12:15], v[64:71], v0
    s_add_u32 s52, s58, 8192
    ds_read_b128 v[20:23], v2 offset:9216
    v_and_b32 v10, 0x1f0, v2
    v_smfmac_f32_16x16x64_bf16 v[32:35], v[12:15], v[72:79], v0
    s_add_u32 s54, s58, 16384
    buffer_load_dwordx4 v[48:51], v52, s[28:31], s58 offen sc1
    v_lshlrev_b32 v10, 2, v10
    v_smfmac_f32_16x16x64_bf16 v[28:31], v[12:15], v[176:183], v0
    ds_read_b128 v[64:67], v3 offset:4096
    v_and_b32 v9, 0x200, v2
    v_smfmac_f32_16x16x64_bf16 v[36:39], v[12:15], v[184:191], v0
    ds_read_b128 v[68:71], v3 offset:5120
    v_lshl_add_u32 v9, v9, 4, v10
    v_smfmac_f32_16x16x64_bf16 v[40:43], v[12:15], a[32:39], v0
    ds_read_b128 v[72:75], v3 offset:6144
    v_smfmac_f32_16x16x64_bf16 v[44:47], v[12:15], a[40:47], v0
    s_waitcnt lgkmcnt(4)
    buffer_load_dwordx4 v[52:55], v52, s[28:31], s58 offen offset:128 sc1
    v_smfmac_f32_16x16x64_bf16 v[40:43], v[16:19], a[48:55], v0
    ds_read_b128 v[76:79], v3 offset:7168
    v_smfmac_f32_16x16x64_bf16 v[44:47], v[16:19], a[56:63], v0
    v_smfmac_f32_16x16x64_bf16 v[24:27], v[16:19], v[80:87], v0
    s_cmp_lg_u32 s51, 1
    s_cbranch_scc1 L_r_sk_35
    s_waitcnt vmcnt(2)
L_r_sk_35:
    v_smfmac_f32_16x16x64_bf16 v[32:35], v[16:19], v[88:95], v0
    s_barrier
    ds_read_b128 v[12:15], v2 offset:10240
    v_smfmac_f32_16x16x64_bf16 v[28:31], v[16:19], v[192:199], v0
    buffer_load_dwordx4 v[56:59], v60, s[28:31], s52 offen sc1
    v_smfmac_f32_16x16x64_bf16 v[36:39], v[16:19], v[200:207], v0
    s_waitcnt lgkmcnt(5)
    v_smfmac_f32_16x16x64_bf16 v[40:43], v[20:23], a[64:71], v0
    ds_read_b128 v[16:19], v2 offset:11264
    v_smfmac_f32_16x16x64_bf16 v[44:47], v[20:23], a[72:79], v0
    buffer_load_dwordx4 v[60:63], v60, s[28:31], s52 offen offset:256 sc1
    v_smfmac_f32_16x16x64_bf16 v[24:27], v[20:23], v[96:103], v0
    v_smfmac_f32_16x16x64_bf16 v[32:35], v[20:23], v[104:111], v0
    s_waitcnt lgkmcnt(4)
    v_smfmac_f32_16x16x64_bf16 v[28:31], v[20:23], v[64:71], v0
    ds_read_b128 v[64:67], v3 offset:8192
    s_waitcnt lgkmcnt(3)
    v_smfmac_f32_16x16x64_bf16 v[36:39], v[20:23], v[72:79], v0
    s_waitcnt lgkmcnt(2)
    ds_read_b128 v[68:71], v3 offset:9216
    v_smfmac_f32_16x16x64_bf16 v[40:43], v[12:15], a[80:87], v0
    s_waitcnt vmcnt(4)
    ds_read_b32 v10, v11
    v_smfmac_f32_16x16x64_bf16 v[44:47], v[12:15], a[88:95], v0
    buffer_load_dword v9, v9, s[28:31], s54 offen sc1
    v_smfmac_f32_16x16x64_bf16 v[24:27], v[12:15], v[112:119], v0
    ds_read_b128 v[72:75], v3 offset:10240
    v_smfmac_f32_16x16x64_bf16 v[32:35], v[12:15], v[120:127], v0
    s_waitcnt lgkmcnt(1)
    ds_read_b128 v[76:79], v3 offset:11264
    v_cmp_eq_u32 vcc, -1, v10
    v_smfmac_f32_16x16x64_bf16 v[28:31], v[12:15], v[208:215], v0
    v_smfmac_f32_16x16x64_bf16 v[36:39], v[12:15], v[216:223], v0
    s_cbranch_vccnz L_r_again_25
L_r_back_26:
    s_barrier
    ds_read_b128 v[20:23], v2 offset:12288
    v_smfmac_f32_16x16x64_bf16 v[40:43], v[16:19], a[96:103], v0
    s_xor_b32 s53, s68, 0xc000
    ds_read_b128 v[12:15], v2 offset:13312
    v_add_u32 v11, s99, v2
    v_smfmac_f32_16x16x64_bf16 v[44:47], v[16:19], a[104:111], v0
    s_xor_b32 s65, s65, s53
    v_mov_b32 v10, s56
    v_smfmac_f32_16x16x64_bf16 v[28:31], v[16:19], v[224:231], v0
    s_mov_b64 exec, 1
    buffer_store_dword v10, off, s[28:31], s64 sc1
    s_mov_b64 exec, -1
    v_smfmac_f32_16x16x64_bf16 v[36:39], v[16:19], v[232:239], v0
    v_smfmac_f32_16x16x64_bf16 v[24:27], v[16:19], v[64:71], v0
    ds_read_b128 v[64:67], v3 offset:12288
    s_waitcnt lgkmcnt(3)
    v_smfmac_f32_16x16x64_bf16 v[32:35], v[16:19], v[72:79], v0
    s_waitcnt lgkmcnt(2)
    ds_read_b128 v[68:71], v3 offset:13312
    v_smfmac_f32_16x16x64_bf16 v[40:43], v[20:23], a[112:119], v0
    ds_read_b128 v[16:19], v2 offset:14336
    v_smfmac_f32_16x16x64_bf16 v[44:47], v[20:23], a[120:127], v0
    ds_read_b128 v[72:75], v3 offset:14336
    v_smfmac_f32_16x16x64_bf16 v[24:27], v[20:23], v[128:135], v0
    ds_read_b128 v[76:79], v3 offset:15360
    v_bfe_u32 v10, v2, 2, 4
    v_smfmac_f32_16x16x64_bf16 v[32:35], v[20:23], v[136:143], v0
    buffer_load_dword v9, v10, s[28:31], s98 offen sc1
    v_smfmac_f32_16x16x64_bf16 v[28:31], v[20:23], v[240:247], v0
    v_smfmac_f32_16x16x64_bf16 v[36:39], v[20:23], v[248:255], v0
    s_waitcnt lgkmcnt(5)
    v_smfmac_f32_16x16x64_bf16 v[24:27], v[12:15], v[144:151], v0
    ds_read_b128 v[20:23], v2 offset:15360
    v_smfmac_f32_16x16x64_bf16 v[32:35], v[12:15], v[152:159], v0
    v_lshrrev_b32 v10, 1, v2
    s_waitcnt lgkmcnt(4)
    v_smfmac_f32_16x16x64_bf16 v[28:31], v[12:15], v[64:71], v0
    ds_read_b128 v[64:67], v3 offset:16384
    v_bfi_b32 v10, 31, v2, v10
    s_waitcnt lgkmcnt(2)
    v_smfmac_f32_16x16x64_bf16 v[36:39], v[12:15], v[72:79], v0
    ds_read_b128 v[68:71], v3 offset:17408
    v_smfmac_f32_16x16x64_bf16 v[24:27], v[16:19], v[160:167], v0
    ds_read_b128 v[12:15], v2 offset:13312
    v_smfmac_f32_16x16x64_bf16 v[32:35], v[16:19], v[168:175], v0
    ds_read_b128 v[72:75], v3 offset:18432
    v_smfmac_f32_16x16x64_bf16 v[28:31], v[16:19], a[0:7], v0
    ds_read_b128 v[76:79], v3 offset:19456
    v_smfmac_f32_16x16x64_bf16 v[36:39], v[16:19], a[8:15], v0
    s_waitcnt lgkmcnt(5)
    v_smfmac_f32_16x16x64_bf16 v[28:31], v[20:23], a[16:23], v0
    ds_read_b128 v[16:19], v2 offset:14336
    v_smfmac_f32_16x16x64_bf16 v[36:39], v[20:23], a[24:31], v0
    s_waitcnt lgkmcnt(4)
    v_smfmac_f32_16x16x64_bf16 v[24:27], v[20:23], v[64:71], v0
    ds_read_b128 v[64:67], v3 offset:20480
    s_waitcnt lgkmcnt(2)
    v_smfmac_f32_16x16x64_bf16 v[32:35], v[20:23], v[72:79], v0
    ds_read_b128 v[68:71], v3 offset:21504
    v_add_f32 v28, v28, v30
    v_add_f32 v29, v29, v31
    v_cvt_pk_bf16_f32 v31, v28, v29
    v_add_f32 v36, v36, v38
    v_add_f32 v37, v37, v39
    v_cvt_pk_bf16_f32 v39, v36, v37
    v_add_f32 v24, v24, v26
    v_add_f32 v25, v25, v27
    v_cvt_pk_bf16_f32 v30, v24, v25
    v_cmp_u_f32 vcc, v24, v25
    v_add_f32 v32, v32, v34
    v_add_f32 v33, v33, v35
    v_mfma_f32_16x16x16_bf16 v[24:27], v[30:31], v[4:5], 0
    v_cvt_pk_bf16_f32 v38, v32, v33
    s_cbranch_vccnz L_r_redo_23
L_r_go_24:
    s_nop 0
    v_mfma_f32_16x16x16_bf16 v[32:35], v[38:39], v[4:5], 0
    v_smfmac_f32_16x16x64_bf16 v[40:43], v[12:15], a[128:135], v0
    ds_read_b128 v[20:23], v2 offset:15360
    v_cvt_pk_bf16_f32 v28, v24, v25
    v_cvt_pk_bf16_f32 v29, v26, v27
    s_waitcnt vmcnt(5)
    v_cvt_pk_bf16_f32 v30, v32, v33
    v_cvt_pk_bf16_f32 v31, v34, v35
    s_nop 1
    v_mfma_f32_16x16x32_bf16 v[24:27], v[48:51], v[28:31], 0
    v_mfma_f32_16x16x32_bf16 v[32:35], v[52:55], v[28:31], 0
    v_mfma_f32_16x16x32_bf16 v[36:39], v[28:31], v[28:31], 0
    s_mov_b64 vcc, s[4:5]
    s_mov_b64 exec, s[38:39]
    buffer_store_dwordx4 v[28:31], v10, s[28:31], s59 offen sc1
    s_mov_b64 exec, -1
    v_cndmask_b32_dpp v24, v32, v24, vcc quad_perm:[0,1,0,1] row_mask:0xf bank_mask:0xf
    v_cndmask_b32_dpp v25, v33, v25, vcc quad_perm:[0,1,0,1] row_mask:0xf bank_mask:0xf
    v_cndmask_b32_dpp v26, v34, v26, vcc quad_perm:[0,1,0,1] row_mask:0xf bank_mask:0xf
    v_cndmask_b32_dpp v27, v35, v27, vcc quad_perm:[0,1,0,1] row_mask:0xf bank_mask:0xf
    ds_write_b128 v6, v[24:27] offset:1024
    s_mov_b64 exec, s[4:5]
    ds_write_b64 v11, v[38:39] offset:0
    s_mov_b64 exec, -1
    v_smfmac_f32_16x16x64_bf16 v[44:47], v[12:15], a[136:143], v0
    ds_read_b128 v[72:75], v3 offset:22528
    s_waitcnt lgkmcnt(6)
    v_smfmac_f32_16x16x64_bf16 v[40:43], v[16:19], a[144:151], v0
    ds_read_b128 v[76:79], v3 offset:23552
    v_smfmac_f32_16x16x64_bf16 v[44:47], v[16:19], a[152:159], v0
    s_waitcnt lgkmcnt(4)
    v_smfmac_f32_16x16x64_bf16 v[40:43], v[20:23], a[160:167], v0
    v_smfmac_f32_16x16x64_bf16 v[44:47], v[20:23], a[168:175], v0
    s_waitcnt lgkmcnt(2)
    s_barrier
    ds_read_b128 v[24:27], v2 offset:1024
    ds_read_b128 v[32:35], v2 offset:2048
    ds_read_b128 v[36:39], v2 offset:3072
    ds_read_b128 v[52:55], v2 offset:4096
    ds_read_b128 v[48:51], v2 offset:0
    v_lshrrev_b32 v11, 1, v2
    v_add_f32 v44, v44, v46
    v_add_f32 v45, v45, v47
    v_cvt_pk_bf16_f32 v47, v44, v45
    v_add_f32 v40, v40, v42
    v_add_f32 v41, v41, v43
    v_cvt_pk_bf16_f32 v46, v40, v41
    buffer_store_dwordx2 v[46:47], v11, s[28:31], s60 offen sc1
    s_cmp_eq_u32 s56, 63
    s_cbranch_scc1 L_r_last_22
    s_waitcnt lgkmcnt(3)
    v_pk_add_f32 v[24:25], v[24:25], v[32:33]
    v_pk_add_f32 v[26:27], v[26:27], v[34:35]
    s_waitcnt lgkmcnt(1)
    v_pk_add_f32 v[36:37], v[36:37], v[52:53]
    v_pk_add_f32 v[38:39], v[38:39], v[54:55]
    s_waitcnt lgkmcnt(0)
    v_pk_add_f32 v[48:49], v[48:49], v[50:51]
    v_pk_add_f32 v[24:25], v[24:25], v[36:37]
    v_pk_add_f32 v[26:27], v[26:27], v[38:39]
    v_add_f32_dpp v50, v48, v48 quad_perm:[2,3,0,1] row_mask:0xf bank_mask:0xf
    v_add_f32_dpp v51, v49, v49 quad_perm:[2,3,0,1] row_mask:0xf bank_mask:0xf
    v_max3_f32 v28, v24, v25, v26
    v_max3_f32 v29, v27, v50, v51
    v_max_f32 v28, v28, v29
    v_mov_b64 v[52:53], s[74:75]
    v_mov_b64 v[54:55], s[74:75]
    v_max_f32_dpp v29, v28, v28 quad_perm:[2,3,0,1] row_mask:0xf bank_mask:0xf
    v_mov_b32 v28, v29
    v_mov_b32 v37, 0
    v_mov_b32 v40, v47
    v_permlane16_swap_b32 v28, v29
    v_max_f32 v28, v28, v29
    v_mov_b32 v29, v28
    v_mov_b32 v41, v47
    s_nop 0
    v_permlane32_swap_b32 v28, v29
    v_max_f32 v28, v28, v29
    v_mul_f32 v28, s100, v28
    v_fma_f32 v24, v24, s100, -v28
    v_fma_f32 v25, v25, s100, -v28
    v_fma_f32 v26, v26, s100, -v28
    v_fma_f32 v27, v27, s100, -v28
    v_fma_f32 v50, v50, s100, -v28
    v_fma_f32 v51, v51, s100, -v28
    v_exp_f32 v50, v50
    v_exp_f32 v51, v51
    v_exp_f32 v24, v24
    v_exp_f32 v25, v25
    v_exp_f32 v26, v26
    v_exp_f32 v27, v27
    v_cvt_pk_bf16_f32 v36, v50, v51
    v_cvt_pk_bf16_f32 v32, v24, v25
    v_cvt_pk_bf16_f32 v33, v26, v27
    v_mfma_f32_16x16x16_bf16 v[24:27], v[52:53], v[36:37], 0
    v_mov_b32_dpp v34, v32 quad_perm:[2,3,0,1] row_mask:0xf bank_mask:0xf
    v_mov_b32_dpp v35, v33 quad_perm:[2,3,0,1] row_mask:0xf bank_mask:0xf
    v_mfma_f32_16x16x16_bf16 v[12:15], v[46:47], v[36:37], 0
    s_waitcnt vmcnt(5)
    v_mfma_f32_16x16x32_bf16 v[24:27], v[52:55], v[32:35], v[24:27]
    v_mfma_f32_16x16x16_bf16 v[16:19], v[40:41], v[36:37], 0
    v_mfma_f32_16x16x32_bf16 v[12:15], v[56:59], v[32:35], v[12:15]
    v_rcp_f32 v24, v24
    v_mfma_f32_16x16x32_bf16 v[16:19], v[60:63], v[32:35], v[16:19]
    v_mov_b64 v[40:41], 0
    v_mov_b64 v[42:43], 0
    v_mov_b64 v[44:45], 0
    v_mov_b64 v[46:47], 0
    v_mov_b64 v[28:29], 0
    v_mov_b64 v[30:31], 0
    v_pk_mul_f32 v[12:13], v[12:13], v[24:25] op_sel_hi:[1,0]
    v_pk_mul_f32 v[14:15], v[14:15], v[24:25] op_sel_hi:[1,0]
    v_pk_mul_f32 v[16:17], v[16:17], v[24:25] op_sel_hi:[1,0]
    v_pk_mul_f32 v[18:19], v[18:19], v[24:25] op_sel_hi:[1,0]
    v_cvt_pk_bf16_f32 v12, v12, v13
    v_cvt_pk_bf16_f32 v13, v14, v15
    v_cvt_pk_bf16_f32 v14, v16, v17
    v_cvt_pk_bf16_f32 v15, v18, v19
    s_mov_b64 exec, s[4:5]
    ds_write_b128 v7, v[12:15] offset:5120
    s_mov_b64 exec, -1
    ds_read_b128 v[48:51], v3 offset:24576
    ds_read_b128 v[52:55], v3 offset:25600
    ds_read_b128 v[56:59], v3 offset:26624
    ds_read_b128 v[60:63], v3 offset:27648
    s_waitcnt lgkmcnt(4)
    s_barrier
    ds_read_b128 v[16:19], v2 offset:5120
    ds_read_b128 v[20:23], v2 offset:6144
    v_mov_b64 v[24:25], 0
    v_mov_b64 v[26:27], 0
    v_mov_b64 v[32:33], 0
    v_mov_b64 v[34:35], 0
    v_mov_b64 v[36:37], 0
    v_mov_b64 v[38:39], 0
    s_waitcnt lgkmcnt(1)
    v_smfmac_f32_16x16x64_bf16 v[24:27], v[16:19], v[64:71], v0
    s_add_u32 s52, s61, 65536
    s_add_u32 s53, s61, 131072
    s_waitcnt lgkmcnt(0)
    v_smfmac_f32_16x16x64_bf16 v[24:27], v[20:23], v[72:79], v0
    s_add_u32 s54, s61, 196608
    ds_read_b128 v[64:67], v3 offset:32768
    v_smfmac_f32_16x16x64_bf16 v[28:31], v[16:19], v[48:55], v0
    ds_read_b128 v[68:71], v3 offset:33792
    v_smfmac_f32_16x16x64_bf16 v[28:31], v[20:23], a[176:183], v0
    ds_read_b128 v[48:51], v3 offset:28672
    v_add_f32 v24, v24, v26
    v_add_f32 v25, v25, v27
    v_smfmac_f32_16x16x64_bf16 v[32:35], v[16:19], v[56:63], v0
    ds_read_b128 v[52:55], v3 offset:29696
    v_cvt_pk_bf16_f32 v10, v24, v25
    v_and_or_b32 v10, v10, -2, s36
    v_smfmac_f32_16x16x64_bf16 v[32:35], v[20:23], a[184:191], v0
    buffer_store_dword v10, v1, s[28:31], s62 offen
    v_add_f32 v28, v28, v30
    v_add_f32 v29, v29, v31
    v_smfmac_f32_16x16x64_bf16 v[36:39], v[16:19], a[192:199], v0
    ds_read_b128 v[56:59], v3 offset:30720
    v_cvt_pk_bf16_f32 v12, v28, v29
    v_and_or_b32 v12, v12, -2, s36
    v_smfmac_f32_16x16x64_bf16 v[36:39], v[20:23], a[208:215], v0
    ds_read_b128 v[60:63], v3 offset:31744
    v_add_f32 v32, v32, v34
    v_add_f32 v33, v33, v35
    v_cvt_pk_bf16_f32 v13, v32, v33
    v_smfmac_f32_16x16x64_bf16 v[40:43], v[16:19], a[200:207], v0
    buffer_store_dwordx2 v[12:13], v8, s[28:31], s61 offen
    v_mov_b64 v[24:25], 0
    v_mov_b64 v[26:27], 0
    v_smfmac_f32_16x16x64_bf16 v[40:43], v[20:23], a[216:223], v0
    ds_read_b128 v[72:75], v3 offset:34816
    v_add_f32 v36, v36, v38
    v_add_f32 v37, v37, v39
    v_smfmac_f32_16x16x64_bf16 v[44:47], v[16:19], a[224:231], v0
    ds_read_b128 v[76:79], v3 offset:35840
    v_cvt_pk_bf16_f32 v14, v36, v37
    v_and_or_b32 v14, v14, -2, s36
    s_waitcnt lgkmcnt(4)
    v_smfmac_f32_16x16x64_bf16 v[44:47], v[20:23], v[48:55], v0
    v_add_f32 v40, v40, v42
    v_add_f32 v41, v41, v43
    v_cvt_pk_bf16_f32 v15, v40, v41
    v_smfmac_f32_16x16x64_bf16 v[24:27], v[16:19], a[232:239], v0
    v_mov_b64 v[28:29], 0
    v_mov_b64 v[30:31], 0
    s_waitcnt lgkmcnt(2)
    v_smfmac_f32_16x16x64_bf16 v[24:27], v[20:23], v[56:63], v0
    buffer_store_dwordx2 v[14:15], v8, s[28:31], s52 offen
    v_mov_b64 v[32:33], 0
    v_add_f32 v44, v44, v46
    v_add_f32 v45, v45, v47
    v_smfmac_f32_16x16x64_bf16 v[28:31], v[16:19], a[240:247], v0
    s_cmp_eq_u32 s33, 0
    v_cvt_pk_bf16_f32 v12, v44, v45
    v_mov_b64 v[34:35], 0
    v_smfmac_f32_16x16x64_bf16 v[28:31], v[20:23], v[64:71], v0
    v_and_or_b32 v12, v12, -2, s36
    v_add_f32 v24, v24, v26
    v_smfmac_f32_16x16x64_bf16 v[32:35], v[16:19], a[248:255], v0
    v_add_f32 v25, v25, v27
    v_cvt_pk_bf16_f32 v13, v24, v25
    s_waitcnt lgkmcnt(0)
    v_smfmac_f32_16x16x64_bf16 v[32:35], v[20:23], v[72:79], v0
    buffer_store_dwordx2 v[12:13], v8, s[28:31], s53 offen
    v_add_f32 v28, v28, v30
    v_add_f32 v29, v29, v31
    v_cvt_pk_bf16_f32 v14, v28, v29
    v_and_or_b32 v14, v14, -2, s36
    s_cbranch_scc1 L_r_ne_36
    buffer_load_dwordx4 v[48:51], v2, s[28:31], s32 offen offset:0 sc1
    buffer_load_dwordx4 v[52:55], v2, s[28:31], s32 offen offset:1024 sc1
L_r_ne_36:
    s_nop 1
    v_add_f32 v32, v32, v34
    v_add_f32 v33, v33, v35
    v_cvt_pk_bf16_f32 v15, v32, v33
    buffer_store_dwordx2 v[14:15], v8, s[28:31], s54 offen
    s_cmp_ge_u32 s51, 2
    s_cbranch_scc1 L_r_late_37
    s_cmp_eq_u32 s51, 1
    s_cbranch_scc1 L_r_w1_47
    v_bfe_u32 v20, v2, 6, 1
    v_lshlrev_b32 v20, 4, v20
    v_mov_b32 v21, 0x3f80
    v_lshlrev_b32 v20, v20, v21
    v_cndmask_b32 v16, 0, v20, s[76:77]
    v_cndmask_b32 v17, 0, v20, s[78:79]
    v_cndmask_b32 v18, 0, v20, s[80:81]
    v_cndmask_b32 v19, 0, v20, s[82:83]
    v_lshrrev_b32 v10, 4, v2
    v_and_b32 v10, 0x30, v10
    v_bfe_u32 v11, v2, 4, 2
    v_lshl_add_u32 v10, v11, 2, v10
    buffer_load_dwordx4 v[24:27], v2, s[28:31], s63 offen offset:0 sc1
    buffer_load_dwordx4 v[28:31], v2, s[28:31], s63 offen offset:1024 sc1
    v_cndmask_b32 v11, 0, -1, s[6:7]
    v_and_b32 v20, 0xc000, v11
    v_xor_b32 v20, s67, v20
    v_add_u32 v10, v10, v20
    v_bfe_u32 v13, v2, 2, 7
    v_and_b32 v15, 0x3c, v13
    v_add_u32 v15, s43, v15
    s_mov_b32 exec_lo, 0
    v_mov_b32 v13, v15
    s_mov_b32 exec_lo, -1
    v_mov_b32 v15, s56
    s_waitcnt vmcnt(3)
L_r_a_41:
    v_xor_b32 v12, s36, v48
    v_bitop3_b32 v12, v12, v50, s36 bitop3:0xf6
    v_bitop3_b32 v12, v12, v52, s36 bitop3:0xf6
    v_bitop3_b32 v12, v12, v54, s36 bitop3:0xf6
    v_and_b32 v12, 1, v12
    v_cmp_ne_u32 vcc, 0, v12
    v_mfma_f32_16x16x32_bf16 v[20:23], v[16:19], v[48:51], 0
    v_mfma_f32_16x16x32_bf16 v[20:23], v[16:19], v[52:55], v[20:23]
    s_cbranch_vccnz L_r_ab_42
    s_mov_b64 exec, s[72:73]
    buffer_store_dword v15, v2, s[28:31], s40 offen
    s_mov_b64 exec, -1
    s_nop 3
    v_add_f32_dpp v22, v20, v20 row_ror:8 row_mask:0xf bank_mask:0xf
    v_add_f32_dpp v23, v21, v21 row_ror:8 row_mask:0xf bank_mask:0xf
    s_nop 0
    v_add_f32_dpp v20, v22, v22 row_ror:4 row_mask:0xf bank_mask:0xf
    v_add_f32_dpp v21, v23, v23 row_ror:4 row_mask:0xf bank_mask:0xf
    v_cvt_pk_bf16_f32 v20, v20, v21
    v_min_u32 v20, -2, v20
    v_or_b32 v20, v20, v11
    v_mov_b32 v56, -1
    buffer_store_dword v20, v10, s[28:31], s66 offen
    s_branch L_r_h2_39
L_r_ab_42:
    s_waitcnt vmcnt(0)
    v_mov_b64 v[48:49], v[24:25]
    v_mov_b64 v[50:51], v[26:27]
    v_mov_b64 v[52:53], v[28:29]
    v_mov_b64 v[54:55], v[30:31]
    buffer_load_dwordx4 v[24:27], v2, s[28:31], s63 offen offset:0 sc1
    buffer_load_dwordx4 v[28:31], v2, s[28:31], s63 offen offset:1024 sc1
    s_sub_u32 s57, s57, 1
    s_cmp_lg_u32 s57, 0
    s_cbranch_scc1 L_r_a_41
    s_branch L_exit
L_r_w1_47:
    v_bfe_u32 v20, v2, 6, 1
    v_lshlrev_b32 v20, 4, v20
    v_mov_b32 v21, 0x3f80
    v_lshlrev_b32 v20, v20, v21
    v_cndmask_b32 v16, 0, v20, s[76:77]
    v_cndmask_b32 v17, 0, v20, s[78:79]
    v_cndmask_b32 v18, 0, v20, s[80:81]
    v_cndmask_b32 v19, 0, v20, s[82:83]
    v_lshrrev_b32 v10, 4, v2
    v_and_b32 v10, 0x30, v10
    v_bfe_u32 v11, v2, 4, 2
    v_lshl_add_u32 v10, v11, 2, v10
    v_cndmask_b32 v11, 0, -1, s[6:7]
    v_and_b32 v20, 0xc000, v11
    v_xor_b32 v20, s67, v20
    v_add_u32 v10, v10, v20
    buffer_load_dwordx4 v[48:51], v2, s[28:31], s63 offen offset:0 sc1
    buffer_load_dwordx4 v[52:55], v2, s[28:31], s63 offen offset:1024 sc1
    v_bfe_u32 v13, v2, 2, 7
    v_and_b32 v15, 0x3c, v13
    v_add_u32 v15, s43, v15
    s_mov_b32 exec_lo, 0
    v_mov_b32 v13, v15
    s_mov_b32 exec_lo, -1
    v_mov_b32 v15, s56
    ds_read_b128 v[64:67], v3 offset:0
    ds_read_b128 v[68:71], v3 offset:1024
    ds_read_b128 v[72:75], v3 offset:2048
    ds_read_b128 v[76:79], v3 offset:3072
    v_mov_b64 v[24:25], 0
    v_mov_b64 v[26:27], 0
    v_mov_b64 v[28:29], 0
    v_mov_b64 v[30:31], 0
    v_mov_b64 v[32:33], 0
    v_mov_b64 v[34:35], 0
    v_mov_b64 v[36:37], 0
    v_mov_b64 v[38:39], 0
    v_mov_b64 v[40:41], 0
    v_mov_b64 v[42:43], 0
    v_mov_b64 v[44:45], 0
    v_mov_b64 v[46:47], 0
L_r_d_48:
    s_waitcnt vmcnt(0)
    v_xor_b32 v12, s36, v48
    v_bitop3_b32 v12, v12, v50, s36 bitop3:0xf6
    v_bitop3_b32 v12, v12, v52, s36 bitop3:0xf6
    v_bitop3_b32 v12, v12, v54, s36 bitop3:0xf6
    v_and_b32 v12, 1, v12
    v_cmp_ne_u32 vcc, 0, v12
    v_mfma_f32_16x16x32_bf16 v[20:23], v[16:19], v[48:51], 0
    v_mfma_f32_16x16x32_bf16 v[20:23], v[16:19], v[52:55], v[20:23]
    s_cbranch_vccnz L_r_db_49
    s_mov_b64 exec, s[72:73]
    buffer_store_dword v15, v2, s[28:31], s40 offen
    s_mov_b64 exec, -1
    s_nop 3
    v_add_f32_dpp v22, v20, v20 row_ror:8 row_mask:0xf bank_mask:0xf
    v_add_f32_dpp v23, v21, v21 row_ror:8 row_mask:0xf bank_mask:0xf
    s_nop 0
    v_add_f32_dpp v20, v22, v22 row_ror:4 row_mask:0xf bank_mask:0xf
    v_add_f32_dpp v21, v23, v23 row_ror:4 row_mask:0xf bank_mask:0xf
    v_cvt_pk_bf16_f32 v20, v20, v21
    v_min_u32 v20, -2, v20
    v_or_b32 v20, v20, v11
    v_mov_b32 v56, -1
    buffer_store_dword v20, v10, s[28:31], s66 offen
    s_branch L_r_h2b_40
L_r_db_49:
    buffer_load_dwordx4 v[48:51], v2, s[28:31], s63 offen offset:0 sc1
    buffer_load_dwordx4 v[52:55], v2, s[28:31], s63 offen offset:1024 sc1
    s_sub_u32 s57, s57, 1
    s_cmp_lg_u32 s57, 0
    s_cbranch_scc1 L_r_d_48
    s_branch L_exit
L_r_late_37:
    v_bfe_u32 v20, v2, 6, 1
    v_lshlrev_b32 v20, 4, v20
    v_mov_b32 v21, 0x3f80
    v_lshlrev_b32 v20, v20, v21
    v_cndmask_b32 v16, 0, v20, s[76:77]
    v_cndmask_b32 v17, 0, v20, s[78:79]
    v_cndmask_b32 v18, 0, v20, s[80:81]
    v_cndmask_b32 v19, 0, v20, s[82:83]
    v_lshrrev_b32 v10, 4, v2
    v_and_b32 v10, 0x30, v10
    v_bfe_u32 v11, v2, 4, 2
    v_lshl_add_u32 v10, v11, 2, v10
    v_cndmask_b32 v11, 0, -1, s[6:7]
    v_and_b32 v20, 0xc000, v11
    v_xor_b32 v20, s67, v20
    v_add_u32 v10, v10, v20
    s_cmp_eq_u32 s33, 0
    s_cbranch_scc1 L_r_two_38
    v_mov_b32 v15, s56
    s_waitcnt vmcnt(1)
L_r_b_43:
    v_xor_b32 v12, s36, v48
    v_bitop3_b32 v12, v12, v50, s36 bitop3:0xf6
    v_bitop3_b32 v12, v12, v52, s36 bitop3:0xf6
    v_bitop3_b32 v12, v12, v54, s36 bitop3:0xf6
    v_and_b32 v12, 1, v12
    v_cmp_ne_u32 vcc, 0, v12
    v_mfma_f32_16x16x32_bf16 v[20:23], v[16:19], v[48:51], 0
    v_mfma_f32_16x16x32_bf16 v[20:23], v[16:19], v[52:55], v[20:23]
    s_cbranch_vccnz L_r_bb_44
    s_mov_b64 exec, s[72:73]
    buffer_store_dword v15, v2, s[28:31], s40 offen
    s_mov_b64 exec, -1
    s_nop 3
    v_add_f32_dpp v22, v20, v20 row_ror:8 row_mask:0xf bank_mask:0xf
    v_add_f32_dpp v23, v21, v21 row_ror:8 row_mask:0xf bank_mask:0xf
    s_nop 0
    v_add_f32_dpp v20, v22, v22 row_ror:4 row_mask:0xf bank_mask:0xf
    v_add_f32_dpp v21, v23, v23 row_ror:4 row_mask:0xf bank_mask:0xf
    v_cvt_pk_bf16_f32 v20, v20, v21
    v_min_u32 v20, -2, v20
    v_or_b32 v20, v20, v11
    v_mov_b32 v56, -1
    buffer_store_dword v20, v10, s[28:31], s47 offen
    buffer_load_dwordx4 v[48:51], v2, s[28:31], s63 offen offset:0 sc1
    buffer_load_dwordx4 v[52:55], v2, s[28:31], s63 offen offset:1024 sc1
    ds_read_b128 v[64:67], v3 offset:0
    ds_read_b128 v[68:71], v3 offset:1024
    ds_read_b128 v[72:75], v3 offset:2048
    ds_read_b128 v[76:79], v3 offset:3072
    v_mov_b64 v[24:25], 0
    v_mov_b64 v[26:27], 0
    v_mov_b64 v[28:29], 0
    v_mov_b64 v[30:31], 0
    v_mov_b64 v[32:33], 0
    v_mov_b64 v[34:35], 0
    v_mov_b64 v[36:37], 0
    v_mov_b64 v[38:39], 0
    v_mov_b64 v[40:41], 0
    v_mov_b64 v[42:43], 0
    v_mov_b64 v[44:45], 0
    v_mov_b64 v[46:47], 0
    s_branch L_r_b2_50
L_r_bb_44:
    buffer_load_dwordx4 v[48:51], v2, s[28:31], s46 offen offset:0 sc1
    buffer_load_dwordx4 v[52:55], v2, s[28:31], s46 offen offset:1024 sc1
    s_waitcnt vmcnt(0)
    s_sub_u32 s57, s57, 1
    s_cmp_lg_u32 s57, 0
    s_cbranch_scc1 L_r_b_43
    s_branch L_exit
L_r_two_38:
    ds_read_b128 v[64:67], v3 offset:0
    ds_read_b128 v[68:71], v3 offset:1024
    ds_read_b128 v[72:75], v3 offset:2048
    ds_read_b128 v[76:79], v3 offset:3072
    v_mov_b64 v[24:25], 0
    v_mov_b64 v[26:27], 0
    v_mov_b64 v[28:29], 0
    v_mov_b64 v[30:31], 0
    v_mov_b64 v[32:33], 0
    v_mov_b64 v[34:35], 0
    v_mov_b64 v[36:37], 0
    v_mov_b64 v[38:39], 0
    v_mov_b64 v[40:41], 0
    v_mov_b64 v[42:43], 0
    v_mov_b64 v[44:45], 0
    v_mov_b64 v[46:47], 0
    s_cmp_eq_u32 s51, 2
    s_cbranch_scc1 L_r_c_45
L_r_c_45:
    buffer_load_dwordx4 v[48:51], v2, s[28:31], s63 offen offset:0 sc1
    buffer_load_dwordx4 v[52:55], v2, s[28:31], s63 offen offset:1024 sc1
L_r_b2_50:
    s_waitcnt vmcnt(0)
    v_xor_b32 v12, s36, v48
    v_bitop3_b32 v12, v12, v50, s36 bitop3:0xf6
    v_bitop3_b32 v12, v12, v52, s36 bitop3:0xf6
    v_bitop3_b32 v12, v12, v54, s36 bitop3:0xf6
    v_and_b32 v12, 1, v12
    v_cmp_ne_u32 vcc, 0, v12
    v_mfma_f32_16x16x32_bf16 v[20:23], v[16:19], v[48:51], 0
    v_mfma_f32_16x16x32_bf16 v[20:23], v[16:19], v[52:55], v[20:23]
    s_cbranch_vccnz L_r_cb_46
    s_nop 6
    v_add_f32_dpp v22, v20, v20 row_ror:8 row_mask:0xf bank_mask:0xf
    v_add_f32_dpp v23, v21, v21 row_ror:8 row_mask:0xf bank_mask:0xf
    s_nop 0
    v_add_f32_dpp v20, v22, v22 row_ror:4 row_mask:0xf bank_mask:0xf
    v_add_f32_dpp v21, v23, v23 row_ror:4 row_mask:0xf bank_mask:0xf
    v_cvt_pk_bf16_f32 v20, v20, v21
    v_min_u32 v20, -2, v20
    v_or_b32 v20, v20, v11
    v_mov_b32 v56, -1
    buffer_store_dword v20, v10, s[28:31], s66 offen
    s_mov_b32 m0, s70
    s_add_u32 s56, s56, 1
    s_add_u32 s58, s58, 16384
    s_add_u32 s59, s59, 8192
    s_add_u32 s60, s60, 8192
    s_xor_b32 s36, s36, 1
    s_xor_b32 s67, s67, s68
    s_xor_b32 s68, s68, 0xc000
    s_mov_b32 s48, 0
    s_lshr_b32 s35, s51, 1
    v_and_b32 v10, 0x300, v2
    v_add_u32 v60, v10, v2
    v_and_b32 v10, 0x80, v2
    v_add_u32 v52, v10, v60
    v_min_u32 v10, s34, v2
    v_bfe_u32 v11, v10, 5, 4
    v_add_lshl_u32 v10, v10, v11, 2
    v_add_u32 v11, s70, v10
    s_cmp_gt_i32 s37, s56
    s_cbranch_scc1 L_kv_ok_52
    s_branch L_kv_u_54
L_kv_p_53:
    s_sub_u32 s57, s57, 1
    s_cmp_eq_u32 s57, 0
    s_cbranch_scc1 L_exit
    v_bfe_u32 v9, v2, 2, 4
    buffer_load_dword v9, v9, s[28:31], s98 offen sc1
    s_waitcnt vmcnt(0)
L_kv_u_54:
    v_readlane_b32 s37, v9, 0
    s_nop 3
    s_cmp_ge_u32 s37, 64
    s_cselect_b32 s37, 65, s37
    s_sub_u32 s37, s37, 1
    s_cmp_gt_i32 s37, s56
    s_cbranch_scc0 L_kv_p_53
L_kv_ok_52:
    s_branch L_r_bar_31
L_r_cb_46:
    s_sub_u32 s57, s57, 1
    s_cmp_lg_u32 s57, 0
    s_cbranch_scc1 L_r_c_45
    s_branch L_exit
L_r_h2b_40:
    buffer_load_dword v56, v13, s[28:31], s42 offen sc1
    s_mov_b32 m0, s70
    s_mov_b32 s55, s56
    s_add_u32 s56, s56, 1
    s_add_u32 s58, s58, 16384
    s_add_u32 s59, s59, 8192
    s_add_u32 s60, s60, 8192
    s_xor_b32 s36, s36, 1
    s_xor_b32 s67, s67, s68
    s_xor_b32 s68, s68, 0xc000
    s_mov_b32 s48, 0
    s_lshr_b32 s35, s51, 1
    buffer_load_dword v56, v13, s[28:31], s42 offen sc1
    v_and_b32 v10, 0x300, v2
    v_add_u32 v60, v10, v2
    v_and_b32 v10, 0x80, v2
    v_add_u32 v52, v10, v60
    v_min_u32 v10, s34, v2
    v_bfe_u32 v11, v10, 5, 4
    v_add_lshl_u32 v10, v10, v11, 2
    v_add_u32 v11, s70, v10
    buffer_load_dword v56, v13, s[28:31], s42 offen sc1
    s_cmp_gt_i32 s37, s56
    s_cbranch_scc1 L_kv_ok_60
    s_branch L_kv_u_62
L_kv_p_61:
    s_sub_u32 s57, s57, 1
    s_cmp_eq_u32 s57, 0
    s_cbranch_scc1 L_exit
    v_bfe_u32 v9, v2, 2, 4
    buffer_load_dword v9, v9, s[28:31], s98 offen sc1
    s_waitcnt vmcnt(0)
L_kv_u_62:
    v_readlane_b32 s37, v9, 0
    s_nop 3
    s_cmp_ge_u32 s37, 64
    s_cselect_b32 s37, 65, s37
    s_sub_u32 s37, s37, 1
    s_cmp_gt_i32 s37, s56
    s_cbranch_scc0 L_kv_p_61
L_kv_ok_60:
L_r_fp_63:
    v_cmp_ne_u32 vcc, s55, v56
    buffer_load_dword v56, v13, s[28:31], s42 offen sc1
    s_cbranch_vccz L_r_fok_64
    v_cmp_ne_u32 vcc, s55, v56
    buffer_load_dword v56, v13, s[28:31], s42 offen sc1
    s_cbranch_vccz L_r_fok_64
    v_cmp_ne_u32 vcc, s55, v56
    buffer_load_dword v56, v13, s[28:31], s42 offen sc1
    s_cbranch_vccz L_r_fok_64
    v_cmp_ne_u32 vcc, s55, v56
    buffer_load_dword v56, v13, s[28:31], s42 offen sc1
    s_cbranch_vccz L_r_fok_64
    s_waitcnt vmcnt(24)
    s_sub_u32 s57, s57, 1
    s_cmp_lg_u32 s57, 0
    s_cbranch_scc1 L_r_fp_63
    s_branch L_exit
L_r_fok_64:
    buffer_load_dwordx4 v2, s[28:31], s65 offen offset:0 sc1 lds
    buffer_load_dwordx4 v2, s[28:31], s65 offen offset:1024 sc1 lds
    s_branch L_r_bar_31
L_r_h2_39:
    buffer_load_dword v56, v13, s[28:31], s42 offen sc1
    s_mov_b32 m0, s70
    s_mov_b32 s55, s56
    ds_read_b128 v[64:67], v3 offset:0
    ds_read_b128 v[68:71], v3 offset:1024
    ds_read_b128 v[72:75], v3 offset:2048
    ds_read_b128 v[76:79], v3 offset:3072
    buffer_load_dword v56, v13, s[28:31], s42 offen sc1
    s_add_u32 s56, s56, 1
    s_add_u32 s58, s58, 16384
    s_add_u32 s59, s59, 8192
    s_add_u32 s60, s60, 8192
    s_xor_b32 s36, s36, 1
    s_xor_b32 s67, s67, s68
    s_xor_b32 s68, s68, 0xc000
    s_mov_b32 s48, 0
    s_lshr_b32 s35, s51, 1
    buffer_load_dword v56, v13, s[28:31], s42 offen sc1
L_r_fp_65:
    v_cmp_ne_u32 vcc, s55, v56
    buffer_load_dword v56, v13, s[28:31], s42 offen sc1
    s_cbranch_vccz L_r_fok_66
    v_cmp_ne_u32 vcc, s55, v56
    buffer_load_dword v56, v13, s[28:31], s42 offen sc1
    s_cbranch_vccz L_r_fok_66
    v_cmp_ne_u32 vcc, s55, v56
    buffer_load_dword v56, v13, s[28:31], s42 offen sc1
    s_cbranch_vccz L_r_fok_66
    v_cmp_ne_u32 vcc, s55, v56
    buffer_load_dword v56, v13, s[28:31], s42 offen sc1
    s_cbranch_vccz L_r_fok_66
    s_waitcnt vmcnt(24)
    s_sub_u32 s57, s57, 1
    s_cmp_lg_u32 s57, 0
    s_cbranch_scc1 L_r_fp_65
    s_branch L_exit
L_r_fok_66:
    buffer_load_dwordx4 v2, s[28:31], s65 offen offset:0 sc1 lds
    buffer_load_dwordx4 v2, s[28:31], s65 offen offset:1024 sc1 lds
    buffer_load_dwordx4 v2, s[28:31], s65 offen offset:2048 sc1 lds
    v_and_b32 v10, 0x300, v2
    v_add_u32 v60, v10, v2
    v_and_b32 v10, 0x80, v2
    v_add_u32 v52, v10, v60
    v_min_u32 v10, s34, v2
    v_bfe_u32 v11, v10, 5, 4
    v_add_lshl_u32 v10, v10, v11, 2
    v_add_u32 v11, s70, v10
    s_cmp_gt_i32 s37, s56
    s_cbranch_scc1 L_kv_ok_67
    s_branch L_kv_u_69
L_kv_p_68:
    s_sub_u32 s57, s57, 1
    s_cmp_eq_u32 s57, 0
    s_cbranch_scc1 L_exit
    v_bfe_u32 v9, v2, 2, 4
    buffer_load_dword v9, v9, s[28:31], s98 offen sc1
    s_waitcnt vmcnt(0)
L_kv_u_69:
    v_readlane_b32 s37, v9, 0
    s_nop 3
    s_cmp_ge_u32 s37, 64
    s_cselect_b32 s37, 65, s37
    s_sub_u32 s37, s37, 1
    s_cmp_gt_i32 s37, s56
    s_cbranch_scc0 L_kv_p_68
L_kv_ok_67:
    s_waitcnt vmcnt(8)
    v_mov_b64 v[24:25], 0
    v_mov_b64 v[26:27], 0
    v_mov_b64 v[28:29], 0
    v_mov_b64 v[30:31], 0
    v_mov_b64 v[32:33], 0
    v_mov_b64 v[34:35], 0
    v_mov_b64 v[36:37], 0
    v_mov_b64 v[38:39], 0
    v_mov_b64 v[40:41], 0
    v_mov_b64 v[42:43], 0
    v_mov_b64 v[44:45], 0
    v_mov_b64 v[46:47], 0
    s_branch L_r_bar0_30
L_r_again_25:
    s_cmp_lt_u32 s51, 2
    s_cbranch_scc1 L_r_back_26
    ds_read_b32 v10, v11
    buffer_load_dwordx4 v2, s[28:31], s65 offen sc1 lds
    s_cmp_lg_u32 s51, 0
    buffer_load_dwordx4 v2, s[28:31], s65 offen offset:1024 sc1 lds
    s_cbranch_scc1 L_r_g4_70
    buffer_load_dwordx4 v2, s[28:31], s65 offen offset:2048 sc1 lds
L_r_g4_70:
    s_waitcnt vmcnt(12) lgkmcnt(0)
    v_cmp_eq_u32 vcc, -1, v10
    s_cbranch_vccz L_r_back_26
    s_sub_u32 s57, s57, 1
    s_cmp_lg_u32 s57, 0
    s_cbranch_scc1 L_r_again_25
    s_branch L_exit
L_r_redo_23:
    s_cmp_eq_u32 s48, 1
    s_cbranch_scc1 L_r_go_24
    s_waitcnt vmcnt(0) lgkmcnt(0)
    s_nop 15
    s_barrier
    s_xor_b32 s52, s68, 0xc000
    s_xor_b32 s65, s65, s52
    v_add_u32 v37, s70, v2
    s_sub_u32 s55, s65, s70
    s_add_u32 s55, s55, 7168
L_r_rp_71:
    buffer_load_dwordx4 v[24:27], v2, s[28:31], s65 offen sc1
    buffer_load_dwordx4 v[28:31], v2, s[28:31], s65 offen offset:1024 sc1
    buffer_load_dwordx4 v[32:35], v2, s[28:31], s55 offen offset:2048 sc1
    s_waitcnt vmcnt(0)
    v_max3_u32 v38, v24, v25, v26
    v_max3_u32 v38, v38, v27, v28
    v_max3_u32 v38, v38, v29, v30
    v_max3_u32 v38, v38, v31, v32
    v_max3_u32 v38, v38, v33, v34
    v_max_u32 v38, v38, v35
    v_cmp_eq_u32 vcc, -1, v38
    s_cbranch_vccz L_r_rok_72
    s_sub_u32 s57, s57, 1
    s_cmp_lg_u32 s57, 0
    s_cbranch_scc1 L_r_rp_71
    s_branch L_exit
L_r_rok_72:
    ds_write_b128 v37, v[24:27]
    ds_write_b128 v37, v[28:31] offset:1024
    ds_write_b128 v2, v[32:35] offset:9216
    s_waitcnt lgkmcnt(0)
    ds_read_b128 v[64:67], v3 offset:0
    ds_read_b128 v[68:71], v3 offset:1024
    ds_read_b128 v[72:75], v3 offset:2048
    ds_read_b128 v[76:79], v3 offset:3072
    v_mov_b64 v[24:25], 0
    v_mov_b64 v[26:27], 0
    v_mov_b64 v[28:29], 0
    v_mov_b64 v[30:31], 0
    v_mov_b64 v[32:33], 0
    v_mov_b64 v[34:35], 0
    v_mov_b64 v[36:37], 0
    v_mov_b64 v[38:39], 0
    v_mov_b64 v[40:41], 0
    v_mov_b64 v[42:43], 0
    v_mov_b64 v[44:45], 0
    v_mov_b64 v[46:47], 0
    v_and_b32 v10, 0x300, v2
    v_add_u32 v60, v10, v2
    v_and_b32 v10, 0x80, v2
    v_add_u32 v52, v10, v60
    v_min_u32 v10, s34, v2
    v_bfe_u32 v11, v10, 5, 4
    v_add_lshl_u32 v10, v10, v11, 2
    v_add_u32 v11, s70, v10
    s_mov_b32 s48, 1
    s_mov_b32 s35, 0
    s_waitcnt lgkmcnt(0)
    s_barrier
    s_branch L_r_top_21
L_r_last_22:
    s_waitcnt vmcnt(0) lgkmcnt(0)
    s_barrier
    v_mov_b32 v9, 64
    s_mov_b64 exec, 1
    buffer_store_dword v9, off, s[28:31], s64 sc1
    s_mov_b64 exec, -1
    s_branch L_exit
L_r_slow_18:
    s_mov_b32 s37, 0
    s_lshl_b32 s64, s101, 2
    s_add_u32 s64, s64, s51
    s_lshl_b32 s64, s64, 7
    s_add_u32 s64, s64, 140673024
    s_cmp_gt_i32 s37, s56
    s_cbranch_scc1 L_kv_ok_79
    s_branch L_kv_u_81
L_kv_p_80:
    s_sub_u32 s57, s57, 1
    s_cmp_eq_u32 s57, 0
    s_cbranch_scc1 L_exit
    v_bfe_u32 v9, v2, 2, 4
    buffer_load_dword v9, v9, s[28:31], s98 offen sc1
    s_waitcnt vmcnt(0)
L_kv_u_81:
    v_readlane_b32 s37, v9, 0
    s_nop 3
    s_cmp_ge_u32 s37, 64
    s_cselect_b32 s37, 65, s37
    s_sub_u32 s37, s37, 1
    s_cmp_gt_i32 s37, s56
    s_cbranch_scc0 L_kv_p_80
L_kv_ok_79:
    ds_read_b128 v[64:67], v3 offset:0
    ds_read_b128 v[68:71], v3 offset:1024
    ds_read_b128 v[72:75], v3 offset:2048
    ds_read_b128 v[76:79], v3 offset:3072
    v_mov_b64 v[24:25], 0
    v_mov_b64 v[26:27], 0
    v_mov_b64 v[28:29], 0
    v_mov_b64 v[30:31], 0
    v_mov_b64 v[32:33], 0
    v_mov_b64 v[34:35], 0
    v_mov_b64 v[36:37], 0
    v_mov_b64 v[38:39], 0
    v_mov_b64 v[40:41], 0
    v_mov_b64 v[42:43], 0
    v_mov_b64 v[44:45], 0
    v_mov_b64 v[46:47], 0
    v_and_b32 v10, 0x300, v2
    v_add_u32 v60, v10, v2
    v_and_b32 v10, 0x80, v2
    v_add_u32 v52, v10, v60
    v_min_u32 v10, s34, v2
    v_bfe_u32 v11, v10, 5, 4
    v_add_lshl_u32 v10, v10, v11, 2
    v_add_u32 v11, s70, v10
.p2align 6
    s_nop 0
    s_nop 0
    s_nop 0
    s_nop 0
    s_nop 0
    s_nop 0
    s_nop 0
L_r_bar0_82:
    s_waitcnt vmcnt(0)
L_r_bar_83:
    s_waitcnt lgkmcnt(0)
    s_barrier
L_r_top_73:
    ds_read_b128 v[12:15], v2 offset:7168
    ds_read_b128 v[16:19], v2 offset:8192
    s_cmp_eq_u32 s35, 0
    s_cbranch_scc1 L_r_ng_84
    buffer_load_dwordx4 v2, s[28:31], s65 offen sc1 lds
    buffer_load_dwordx4 v2, s[28:31], s65 offen offset:1024 sc1 lds
L_r_ng_84:
    s_waitcnt lgkmcnt(1)
    v_smfmac_f32_16x16x64_bf16 v[24:27], v[12:15], v[64:71], v0
    s_add_u32 s52, s58, 8192
    ds_read_b128 v[20:23], v2 offset:9216
    v_and_b32 v10, 0x1f0, v2
    v_smfmac_f32_16x16x64_bf16 v[32:35], v[12:15], v[72:79], v0
    s_add_u32 s54, s58, 16384
    buffer_load_dwordx4 v[48:51], v52, s[28:31], s58 offen sc1
    v_lshlrev_b32 v10, 2, v10
    v_smfmac_f32_16x16x64_bf16 v[28:31], v[12:15], v[176:183], v0
    ds_read_b128 v[64:67], v3 offset:4096
    v_and_b32 v9, 0x200, v2
    v_smfmac_f32_16x16x64_bf16 v[36:39], v[12:15], v[184:191], v0
    ds_read_b128 v[68:71], v3 offset:5120
    v_lshl_add_u32 v9, v9, 4, v10
    v_smfmac_f32_16x16x64_bf16 v[40:43], v[12:15], a[32:39], v0
    ds_read_b128 v[72:75], v3 offset:6144
    v_smfmac_f32_16x16x64_bf16 v[44:47], v[12:15], a[40:47], v0
    s_waitcnt lgkmcnt(4)
    buffer_load_dwordx4 v[52:55], v52, s[28:31], s58 offen offset:128 sc1
    v_smfmac_f32_16x16x64_bf16 v[40:43], v[16:19], a[48:55], v0
    ds_read_b128 v[76:79], v3 offset:7168
    v_smfmac_f32_16x16x64_bf16 v[44:47], v[16:19], a[56:63], v0
    v_smfmac_f32_16x16x64_bf16 v[24:27], v[16:19], v[80:87], v0
    s_cmp_lg_u32 s51, 1
    s_cbranch_scc1 L_r_sk_87
    s_waitcnt vmcnt(2)
L_r_sk_87:
    v_smfmac_f32_16x16x64_bf16 v[32:35], v[16:19], v[88:95], v0
    s_barrier
    ds_read_b128 v[12:15], v2 offset:10240
    v_smfmac_f32_16x16x64_bf16 v[28:31], v[16:19], v[192:199], v0
    buffer_load_dwordx4 v[56:59], v60, s[28:31], s52 offen sc1
    v_smfmac_f32_16x16x64_bf16 v[36:39], v[16:19], v[200:207], v0
    s_waitcnt lgkmcnt(5)
    v_smfmac_f32_16x16x64_bf16 v[40:43], v[20:23], a[64:71], v0
    ds_read_b128 v[16:19], v2 offset:11264
    v_smfmac_f32_16x16x64_bf16 v[44:47], v[20:23], a[72:79], v0
    buffer_load_dwordx4 v[60:63], v60, s[28:31], s52 offen offset:256 sc1
    v_smfmac_f32_16x16x64_bf16 v[24:27], v[20:23], v[96:103], v0
    v_smfmac_f32_16x16x64_bf16 v[32:35], v[20:23], v[104:111], v0
    s_waitcnt lgkmcnt(4)
    v_smfmac_f32_16x16x64_bf16 v[28:31], v[20:23], v[64:71], v0
    ds_read_b128 v[64:67], v3 offset:8192
    s_waitcnt lgkmcnt(3)
    v_smfmac_f32_16x16x64_bf16 v[36:39], v[20:23], v[72:79], v0
    s_waitcnt lgkmcnt(2)
    ds_read_b128 v[68:71], v3 offset:9216
    v_smfmac_f32_16x16x64_bf16 v[40:43], v[12:15], a[80:87], v0
    s_waitcnt vmcnt(4)
    ds_read_b32 v10, v11
    v_smfmac_f32_16x16x64_bf16 v[44:47], v[12:15], a[88:95], v0
    buffer_load_dword v9, v9, s[28:31], s54 offen sc1
    v_smfmac_f32_16x16x64_bf16 v[24:27], v[12:15], v[112:119], v0
    ds_read_b128 v[72:75], v3 offset:10240
    v_smfmac_f32_16x16x64_bf16 v[32:35], v[12:15], v[120:127], v0
    s_waitcnt lgkmcnt(1)
    ds_read_b128 v[76:79], v3 offset:11264
    v_cmp_eq_u32 vcc, -1, v10
    v_smfmac_f32_16x16x64_bf16 v[28:31], v[12:15], v[208:215], v0
    v_smfmac_f32_16x16x64_bf16 v[36:39], v[12:15], v[216:223], v0
    s_cbranch_vccnz L_r_again_77
L_r_back_78:
    s_barrier
    ds_read_b128 v[20:23], v2 offset:12288
    v_smfmac_f32_16x16x64_bf16 v[40:43], v[16:19], a[96:103], v0
    s_xor_b32 s53, s68, 0xc000
    ds_read_b128 v[12:15], v2 offset:13312
    v_add_u32 v11, s99, v2
    v_smfmac_f32_16x16x64_bf16 v[44:47], v[16:19], a[104:111], v0
    s_xor_b32 s65, s65, s53
    v_mov_b32 v10, s56
    v_smfmac_f32_16x16x64_bf16 v[28:31], v[16:19], v[224:231], v0
    s_mov_b64 exec, 1
    buffer_store_dword v10, off, s[28:31], s64 sc1
    s_mov_b64 exec, -1
    v_smfmac_f32_16x16x64_bf16 v[36:39], v[16:19], v[232:239], v0
    v_smfmac_f32_16x16x64_bf16 v[24:27], v[16:19], v[64:71], v0
    ds_read_b128 v[64:67], v3 offset:12288
    s_waitcnt lgkmcnt(3)
    v_smfmac_f32_16x16x64_bf16 v[32:35], v[16:19], v[72:79], v0
    s_waitcnt lgkmcnt(2)
    ds_read_b128 v[68:71], v3 offset:13312
    v_smfmac_f32_16x16x64_bf16 v[40:43], v[20:23], a[112:119], v0
    ds_read_b128 v[16:19], v2 offset:14336
    v_smfmac_f32_16x16x64_bf16 v[44:47], v[20:23], a[120:127], v0
    ds_read_b128 v[72:75], v3 offset:14336
    v_smfmac_f32_16x16x64_bf16 v[24:27], v[20:23], v[128:135], v0
    ds_read_b128 v[76:79], v3 offset:15360
    v_bfe_u32 v10, v2, 2, 4
    v_smfmac_f32_16x16x64_bf16 v[32:35], v[20:23], v[136:143], v0
    buffer_load_dword v9, v10, s[28:31], s98 offen sc1
    v_smfmac_f32_16x16x64_bf16 v[28:31], v[20:23], v[240:247], v0
    v_smfmac_f32_16x16x64_bf16 v[36:39], v[20:23], v[248:255], v0
    s_waitcnt lgkmcnt(5)
    v_smfmac_f32_16x16x64_bf16 v[24:27], v[12:15], v[144:151], v0
    ds_read_b128 v[20:23], v2 offset:15360
    v_smfmac_f32_16x16x64_bf16 v[32:35], v[12:15], v[152:159], v0
    v_lshrrev_b32 v10, 1, v2
    s_waitcnt lgkmcnt(4)
    v_smfmac_f32_16x16x64_bf16 v[28:31], v[12:15], v[64:71], v0
    ds_read_b128 v[64:67], v3 offset:16384
    v_bfi_b32 v10, 31, v2, v10
    s_waitcnt lgkmcnt(2)
    v_smfmac_f32_16x16x64_bf16 v[36:39], v[12:15], v[72:79], v0
    ds_read_b128 v[68:71], v3 offset:17408
    v_smfmac_f32_16x16x64_bf16 v[24:27], v[16:19], v[160:167], v0
    ds_read_b128 v[12:15], v2 offset:13312
    v_smfmac_f32_16x16x64_bf16 v[32:35], v[16:19], v[168:175], v0
    ds_read_b128 v[72:75], v3 offset:18432
    v_smfmac_f32_16x16x64_bf16 v[28:31], v[16:19], a[0:7], v0
    ds_read_b128 v[76:79], v3 offset:19456
    v_smfmac_f32_16x16x64_bf16 v[36:39], v[16:19], a[8:15], v0
    s_waitcnt lgkmcnt(5)
    v_smfmac_f32_16x16x64_bf16 v[28:31], v[20:23], a[16:23], v0
    ds_read_b128 v[16:19], v2 offset:14336
    v_smfmac_f32_16x16x64_bf16 v[36:39], v[20:23], a[24:31], v0
    s_waitcnt lgkmcnt(4)
    v_smfmac_f32_16x16x64_bf16 v[24:27], v[20:23], v[64:71], v0
    ds_read_b128 v[64:67], v3 offset:20480
    s_waitcnt lgkmcnt(2)
    v_smfmac_f32_16x16x64_bf16 v[32:35], v[20:23], v[72:79], v0
    ds_read_b128 v[68:71], v3 offset:21504
    v_add_f32 v28, v28, v30
    v_add_f32 v29, v29, v31
    v_cvt_pk_bf16_f32 v31, v28, v29
    v_add_f32 v36, v36, v38
    v_add_f32 v37, v37, v39
    v_cvt_pk_bf16_f32 v39, v36, v37
    v_add_f32 v24, v24, v26
    v_add_f32 v25, v25, v27
    v_cvt_pk_bf16_f32 v30, v24, v25
    v_cmp_u_f32 vcc, v24, v25
    v_add_f32 v32, v32, v34
    v_add_f32 v33, v33, v35
    v_mfma_f32_16x16x16_bf16 v[24:27], v[30:31], v[4:5], 0
    v_cvt_pk_bf16_f32 v38, v32, v33
    s_cbranch_vccnz L_r_redo_75
L_r_go_76:
    s_nop 0
    v_mfma_f32_16x16x16_bf16 v[32:35], v[38:39], v[4:5], 0
    v_smfmac_f32_16x16x64_bf16 v[40:43], v[12:15], a[128:135], v0
    ds_read_b128 v[20:23], v2 offset:15360
    v_cvt_pk_bf16_f32 v28, v24, v25
    v_cvt_pk_bf16_f32 v29, v26, v27
    s_waitcnt vmcnt(5)
    v_cvt_pk_bf16_f32 v30, v32, v33
    v_cvt_pk_bf16_f32 v31, v34, v35
    s_nop 1
    v_mfma_f32_16x16x32_bf16 v[24:27], v[48:51], v[28:31], 0
    v_mfma_f32_16x16x32_bf16 v[32:35], v[52:55], v[28:31], 0
    v_mfma_f32_16x16x32_bf16 v[36:39], v[28:31], v[28:31], 0
    s_mov_b64 vcc, s[4:5]
    s_mov_b64 exec, s[38:39]
    buffer_store_dwordx4 v[28:31], v10, s[28:31], s59 offen sc1
    s_mov_b64 exec, -1
    v_cndmask_b32_dpp v24, v32, v24, vcc quad_perm:[0,1,0,1] row_mask:0xf bank_mask:0xf
    v_cndmask_b32_dpp v25, v33, v25, vcc quad_perm:[0,1,0,1] row_mask:0xf bank_mask:0xf
    v_cndmask_b32_dpp v26, v34, v26, vcc quad_perm:[0,1,0,1] row_mask:0xf bank_mask:0xf
    v_cndmask_b32_dpp v27, v35, v27, vcc quad_perm:[0,1,0,1] row_mask:0xf bank_mask:0xf
    ds_write_b128 v6, v[24:27] offset:1024
    s_mov_b64 exec, s[4:5]
    ds_write_b64 v11, v[38:39] offset:0
    s_mov_b64 exec, -1
    v_smfmac_f32_16x16x64_bf16 v[44:47], v[12:15], a[136:143], v0
    ds_read_b128 v[72:75], v3 offset:22528
    s_waitcnt lgkmcnt(6)
    v_smfmac_f32_16x16x64_bf16 v[40:43], v[16:19], a[144:151], v0
    ds_read_b128 v[76:79], v3 offset:23552
    v_smfmac_f32_16x16x64_bf16 v[44:47], v[16:19], a[152:159], v0
    s_waitcnt lgkmcnt(4)
    v_smfmac_f32_16x16x64_bf16 v[40:43], v[20:23], a[160:167], v0
    v_smfmac_f32_16x16x64_bf16 v[44:47], v[20:23], a[168:175], v0
    s_waitcnt lgkmcnt(2)
    s_barrier
    ds_read_b128 v[24:27], v2 offset:1024
    ds_read_b128 v[32:35], v2 offset:2048
    ds_read_b128 v[36:39], v2 offset:3072
    ds_read_b128 v[52:55], v2 offset:4096
    ds_read_b128 v[48:51], v2 offset:0
    v_lshrrev_b32 v11, 1, v2
    v_add_f32 v44, v44, v46
    v_add_f32 v45, v45, v47
    v_cvt_pk_bf16_f32 v47, v44, v45
    v_add_f32 v40, v40, v42
    v_add_f32 v41, v41, v43
    v_cvt_pk_bf16_f32 v46, v40, v41
    buffer_store_dwordx2 v[46:47], v11, s[28:31], s60 offen sc1
    s_cmp_eq_u32 s56, 63
    s_cbranch_scc1 L_r_last_74
    s_waitcnt lgkmcnt(3)
    v_pk_add_f32 v[24:25], v[24:25], v[32:33]
    v_pk_add_f32 v[26:27], v[26:27], v[34:35]
    s_waitcnt lgkmcnt(1)
    v_pk_add_f32 v[36:37], v[36:37], v[52:53]
    v_pk_add_f32 v[38:39], v[38:39], v[54:55]
    s_waitcnt lgkmcnt(0)
    v_pk_add_f32 v[48:49], v[48:49], v[50:51]
    v_pk_add_f32 v[24:25], v[24:25], v[36:37]
    v_pk_add_f32 v[26:27], v[26:27], v[38:39]
    v_add_f32_dpp v50, v48, v48 quad_perm:[2,3,0,1] row_mask:0xf bank_mask:0xf
    v_add_f32_dpp v51, v49, v49 quad_perm:[2,3,0,1] row_mask:0xf bank_mask:0xf
    v_max3_f32 v28, v24, v25, v26
    v_max3_f32 v29, v27, v50, v51
    v_max_f32 v28, v28, v29
    v_mov_b64 v[52:53], s[74:75]
    v_mov_b64 v[54:55], s[74:75]
    v_max_f32_dpp v29, v28, v28 quad_perm:[2,3,0,1] row_mask:0xf bank_mask:0xf
    v_mov_b32 v28, v29
    v_mov_b32 v37, 0
    v_mov_b32 v40, v47
    v_permlane16_swap_b32 v28, v29
    v_max_f32 v28, v28, v29
    v_mov_b32 v29, v28
    v_mov_b32 v41, v47
    s_nop 0
    v_permlane32_swap_b32 v28, v29
    v_max_f32 v28, v28, v29
    v_mul_f32 v28, s100, v28
    v_fma_f32 v24, v24, s100, -v28
    v_fma_f32 v25, v25, s100, -v28
    v_fma_f32 v26, v26, s100, -v28
    v_fma_f32 v27, v27, s100, -v28
    v_fma_f32 v50, v50, s100, -v28
    v_fma_f32 v51, v51, s100, -v28
    v_exp_f32 v50, v50
    v_exp_f32 v51, v51
    v_exp_f32 v24, v24
    v_exp_f32 v25, v25
    v_exp_f32 v26, v26
    v_exp_f32 v27, v27
    v_cvt_pk_bf16_f32 v36, v50, v51
    v_cvt_pk_bf16_f32 v32, v24, v25
    v_cvt_pk_bf16_f32 v33, v26, v27
    v_mfma_f32_16x16x16_bf16 v[24:27], v[52:53], v[36:37], 0
    v_mov_b32_dpp v34, v32 quad_perm:[2,3,0,1] row_mask:0xf bank_mask:0xf
    v_mov_b32_dpp v35, v33 quad_perm:[2,3,0,1] row_mask:0xf bank_mask:0xf
    v_mfma_f32_16x16x16_bf16 v[12:15], v[46:47], v[36:37], 0
    s_waitcnt vmcnt(5)
    v_mfma_f32_16x16x32_bf16 v[24:27], v[52:55], v[32:35], v[24:27]
    v_mfma_f32_16x16x16_bf16 v[16:19], v[40:41], v[36:37], 0
    v_mfma_f32_16x16x32_bf16 v[12:15], v[56:59], v[32:35], v[12:15]
    v_rcp_f32 v24, v24
    v_mfma_f32_16x16x32_bf16 v[16:19], v[60:63], v[32:35], v[16:19]
    v_mov_b64 v[40:41], 0
    v_mov_b64 v[42:43], 0
    v_mov_b64 v[44:45], 0
    v_mov_b64 v[46:47], 0
    v_mov_b64 v[28:29], 0
    v_mov_b64 v[30:31], 0
    v_pk_mul_f32 v[12:13], v[12:13], v[24:25] op_sel_hi:[1,0]
    v_pk_mul_f32 v[14:15], v[14:15], v[24:25] op_sel_hi:[1,0]
    v_pk_mul_f32 v[16:17], v[16:17], v[24:25] op_sel_hi:[1,0]
    v_pk_mul_f32 v[18:19], v[18:19], v[24:25] op_sel_hi:[1,0]
    v_cvt_pk_bf16_f32 v12, v12, v13
    v_cvt_pk_bf16_f32 v13, v14, v15
    v_cvt_pk_bf16_f32 v14, v16, v17
    v_cvt_pk_bf16_f32 v15, v18, v19
    s_mov_b64 exec, s[4:5]
    ds_write_b128 v7, v[12:15] offset:5120
    s_mov_b64 exec, -1
    ds_read_b128 v[48:51], v3 offset:24576
    ds_read_b128 v[52:55], v3 offset:25600
    ds_read_b128 v[56:59], v3 offset:26624
    ds_read_b128 v[60:63], v3 offset:27648
    s_waitcnt lgkmcnt(4)
    s_barrier
    ds_read_b128 v[16:19], v2 offset:5120
    ds_read_b128 v[20:23], v2 offset:6144
    v_mov_b64 v[24:25], 0
    v_mov_b64 v[26:27], 0
    v_mov_b64 v[32:33], 0
    v_mov_b64 v[34:35], 0
    v_mov_b64 v[36:37], 0
    v_mov_b64 v[38:39], 0
    s_waitcnt lgkmcnt(1)
    v_smfmac_f32_16x16x64_bf16 v[24:27], v[16:19], v[64:71], v0
    s_add_u32 s52, s61, 65536
    s_add_u32 s53, s61, 131072
    s_waitcnt lgkmcnt(0)
    v_smfmac_f32_16x16x64_bf16 v[24:27], v[20:23], v[72:79], v0
    s_add_u32 s54, s61, 196608
    ds_read_b128 v[64:67], v3 offset:32768
    v_smfmac_f32_16x16x64_bf16 v[28:31], v[16:19], v[48:55], v0
    ds_read_b128 v[68:71], v3 offset:33792
    v_smfmac_f32_16x16x64_bf16 v[28:31], v[20:23], a[176:183], v0
    ds_read_b128 v[48:51], v3 offset:28672
    v_add_f32 v24, v24, v26
    v_add_f32 v25, v25, v27
    v_smfmac_f32_16x16x64_bf16 v[32:35], v[16:19], v[56:63], v0
    ds_read_b128 v[52:55], v3 offset:29696
    v_cvt_pk_bf16_f32 v10, v24, v25
    v_and_or_b32 v10, v10, -2, s36
    v_smfmac_f32_16x16x64_bf16 v[32:35], v[20:23], a[184:191], v0
    buffer_store_dword v10, v1, s[28:31], s62 offen sc1
    v_add_f32 v28, v28, v30
    v_add_f32 v29, v29, v31
    v_smfmac_f32_16x16x64_bf16 v[36:39], v[16:19], a[192:199], v0
    ds_read_b128 v[56:59], v3 offset:30720
    v_cvt_pk_bf16_f32 v12, v28, v29
    v_and_or_b32 v12, v12, -2, s36
    v_smfmac_f32_16x16x64_bf16 v[36:39], v[20:23], a[208:215], v0
    ds_read_b128 v[60:63], v3 offset:31744
    v_add_f32 v32, v32, v34
    v_add_f32 v33, v33, v35
    v_cvt_pk_bf16_f32 v13, v32, v33
    v_smfmac_f32_16x16x64_bf16 v[40:43], v[16:19], a[200:207], v0
    buffer_store_dwordx2 v[12:13], v8, s[28:31], s61 offen sc1
    v_mov_b64 v[24:25], 0
    v_mov_b64 v[26:27], 0
    v_smfmac_f32_16x16x64_bf16 v[40:43], v[20:23], a[216:223], v0
    ds_read_b128 v[72:75], v3 offset:34816
    v_add_f32 v36, v36, v38
    v_add_f32 v37, v37, v39
    v_smfmac_f32_16x16x64_bf16 v[44:47], v[16:19], a[224:231], v0
    ds_read_b128 v[76:79], v3 offset:35840
    v_cvt_pk_bf16_f32 v14, v36, v37
    v_and_or_b32 v14, v14, -2, s36
    s_waitcnt lgkmcnt(4)
    v_smfmac_f32_16x16x64_bf16 v[44:47], v[20:23], v[48:55], v0
    v_add_f32 v40, v40, v42
    v_add_f32 v41, v41, v43
    v_cvt_pk_bf16_f32 v15, v40, v41
    v_smfmac_f32_16x16x64_bf16 v[24:27], v[16:19], a[232:239], v0
    v_mov_b64 v[28:29], 0
    v_mov_b64 v[30:31], 0
    s_waitcnt lgkmcnt(2)
    v_smfmac_f32_16x16x64_bf16 v[24:27], v[20:23], v[56:63], v0
    buffer_store_dwordx2 v[14:15], v8, s[28:31], s52 offen sc1
    v_mov_b64 v[32:33], 0
    v_add_f32 v44, v44, v46
    v_add_f32 v45, v45, v47
    v_smfmac_f32_16x16x64_bf16 v[28:31], v[16:19], a[240:247], v0
    s_cmp_eq_u32 s33, 0
    v_cvt_pk_bf16_f32 v12, v44, v45
    v_mov_b64 v[34:35], 0
    v_smfmac_f32_16x16x64_bf16 v[28:31], v[20:23], v[64:71], v0
    v_and_or_b32 v12, v12, -2, s36
    v_add_f32 v24, v24, v26
    v_smfmac_f32_16x16x64_bf16 v[32:35], v[16:19], a[248:255], v0
    v_add_f32 v25, v25, v27
    v_cvt_pk_bf16_f32 v13, v24, v25
    s_waitcnt lgkmcnt(0)
    v_smfmac_f32_16x16x64_bf16 v[32:35], v[20:23], v[72:79], v0
    buffer_store_dwordx2 v[12:13], v8, s[28:31], s53 offen sc1
    v_add_f32 v28, v28, v30
    v_add_f32 v29, v29, v31
    v_cvt_pk_bf16_f32 v14, v28, v29
    v_and_or_b32 v14, v14, -2, s36
    s_cbranch_scc1 L_r_ne_88
    buffer_load_dwordx4 v[48:51], v2, s[28:31], s32 offen offset:0 sc1
    buffer_load_dwordx4 v[52:55], v2, s[28:31], s32 offen offset:1024 sc1
L_r_ne_88:
    s_nop 1
    v_add_f32 v32, v32, v34
    v_add_f32 v33, v33, v35
    v_cvt_pk_bf16_f32 v15, v32, v33
    buffer_store_dwordx2 v[14:15], v8, s[28:31], s54 offen sc1
    s_cmp_ge_u32 s51, 2
    s_cbranch_scc1 L_r_late_89
    s_cmp_eq_u32 s51, 1
    s_cbranch_scc1 L_r_w1_99
    v_bfe_u32 v20, v2, 6, 1
    v_lshlrev_b32 v20, 4, v20
    v_mov_b32 v21, 0x3f80
    v_lshlrev_b32 v20, v20, v21
    v_cndmask_b32 v16, 0, v20, s[76:77]
    v_cndmask_b32 v17, 0, v20, s[78:79]
    v_cndmask_b32 v18, 0, v20, s[80:81]
    v_cndmask_b32 v19, 0, v20, s[82:83]
    v_lshrrev_b32 v10, 4, v2
    v_and_b32 v10, 0x30, v10
    v_bfe_u32 v11, v2, 4, 2
    v_lshl_add_u32 v10, v11, 2, v10
    buffer_load_dwordx4 v[24:27], v2, s[28:31], s63 offen offset:0 sc1
    buffer_load_dwordx4 v[28:31], v2, s[28:31], s63 offen offset:1024 sc1
    v_cndmask_b32 v11, 0, -1, s[6:7]
    v_and_b32 v20, 0xc000, v11
    v_xor_b32 v20, s67, v20
    v_add_u32 v10, v10, v20
    v_bfe_u32 v13, v2, 2, 7
    v_and_b32 v15, 0x3c, v13
    v_add_u32 v15, s43, v15
    s_mov_b32 exec_lo, 0
    v_mov_b32 v13, v15
    s_mov_b32 exec_lo, -1
    v_mov_b32 v15, s56
    s_waitcnt vmcnt(3)
L_r_a_93:
    v_xor_b32 v12, s36, v48
    v_bitop3_b32 v12, v12, v50, s36 bitop3:0xf6
    v_bitop3_b32 v12, v12, v52, s36 bitop3:0xf6
    v_bitop3_b32 v12, v12, v54, s36 bitop3:0xf6
    v_and_b32 v12, 1, v12
    v_cmp_ne_u32 vcc, 0, v12
    v_mfma_f32_16x16x32_bf16 v[20:23], v[16:19], v[48:51], 0
    v_mfma_f32_16x16x32_bf16 v[20:23], v[16:19], v[52:55], v[20:23]
    s_cbranch_vccnz L_r_ab_94
    s_mov_b64 exec, s[72:73]
    buffer_store_dword v15, v2, s[28:31], s40 offen sc1
    s_mov_b64 exec, -1
    s_nop 3
    v_add_f32_dpp v22, v20, v20 row_ror:8 row_mask:0xf bank_mask:0xf
    v_add_f32_dpp v23, v21, v21 row_ror:8 row_mask:0xf bank_mask:0xf
    s_nop 0
    v_add_f32_dpp v20, v22, v22 row_ror:4 row_mask:0xf bank_mask:0xf
    v_add_f32_dpp v21, v23, v23 row_ror:4 row_mask:0xf bank_mask:0xf
    v_cvt_pk_bf16_f32 v20, v20, v21
    v_min_u32 v20, -2, v20
    v_or_b32 v20, v20, v11
    v_mov_b32 v56, -1
    buffer_store_dword v20, v10, s[28:31], s66 offen sc1
    s_branch L_r_h2_91
L_r_ab_94:
    s_waitcnt vmcnt(0)
    v_mov_b64 v[48:49], v[24:25]
    v_mov_b64 v[50:51], v[26:27]
    v_mov_b64 v[52:53], v[28:29]
    v_mov_b64 v[54:55], v[30:31]
    buffer_load_dwordx4 v[24:27], v2, s[28:31], s63 offen offset:0 sc1
    buffer_load_dwordx4 v[28:31], v2, s[28:31], s63 offen offset:1024 sc1
    s_sub_u32 s57, s57, 1
    s_cmp_lg_u32 s57, 0
    s_cbranch_scc1 L_r_a_93
    s_branch L_exit
L_r_w1_99:
    v_bfe_u32 v20, v2, 6, 1
    v_lshlrev_b32 v20, 4, v20
    v_mov_b32 v21, 0x3f80
    v_lshlrev_b32 v20, v20, v21
    v_cndmask_b32 v16, 0, v20, s[76:77]
    v_cndmask_b32 v17, 0, v20, s[78:79]
    v_cndmask_b32 v18, 0, v20, s[80:81]
    v_cndmask_b32 v19, 0, v20, s[82:83]
    v_lshrrev_b32 v10, 4, v2
    v_and_b32 v10, 0x30, v10
    v_bfe_u32 v11, v2, 4, 2
    v_lshl_add_u32 v10, v11, 2, v10
    v_cndmask_b32 v11, 0, -1, s[6:7]
    v_and_b32 v20, 0xc000, v11
    v_xor_b32 v20, s67, v20
    v_add_u32 v10, v10, v20
    buffer_load_dwordx4 v[48:51], v2, s[28:31], s63 offen offset:0 sc1
    buffer_load_dwordx4 v[52:55], v2, s[28:31], s63 offen offset:1024 sc1
    v_bfe_u32 v13, v2, 2, 7
    v_and_b32 v15, 0x3c, v13
    v_add_u32 v15, s43, v15
    s_mov_b32 exec_lo, 0
    v_mov_b32 v13, v15
    s_mov_b32 exec_lo, -1
    v_mov_b32 v15, s56
    ds_read_b128 v[64:67], v3 offset:0
    ds_read_b128 v[68:71], v3 offset:1024
    ds_read_b128 v[72:75], v3 offset:2048
    ds_read_b128 v[76:79], v3 offset:3072
    v_mov_b64 v[24:25], 0
    v_mov_b64 v[26:27], 0
    v_mov_b64 v[28:29], 0
    v_mov_b64 v[30:31], 0
    v_mov_b64 v[32:33], 0
    v_mov_b64 v[34:35], 0
    v_mov_b64 v[36:37], 0
    v_mov_b64 v[38:39], 0
    v_mov_b64 v[40:41], 0
    v_mov_b64 v[42:43], 0
    v_mov_b64 v[44:45], 0
    v_mov_b64 v[46:47], 0
L_r_d_100:
    s_waitcnt vmcnt(0)
    v_xor_b32 v12, s36, v48
    v_bitop3_b32 v12, v12, v50, s36 bitop3:0xf6
    v_bitop3_b32 v12, v12, v52, s36 bitop3:0xf6
    v_bitop3_b32 v12, v12, v54, s36 bitop3:0xf6
    v_and_b32 v12, 1, v12
    v_cmp_ne_u32 vcc, 0, v12
    v_mfma_f32_16x16x32_bf16 v[20:23], v[16:19], v[48:51], 0
    v_mfma_f32_16x16x32_bf16 v[20:23], v[16:19], v[52:55], v[20:23]
    s_cbranch_vccnz L_r_db_101
    s_mov_b64 exec, s[72:73]
    buffer_store_dword v15, v2, s[28:31], s40 offen sc1
    s_mov_b64 exec, -1
    s_nop 3
    v_add_f32_dpp v22, v20, v20 row_ror:8 row_mask:0xf bank_mask:0xf
    v_add_f32_dpp v23, v21, v21 row_ror:8 row_mask:0xf bank_mask:0xf
    s_nop 0
    v_add_f32_dpp v20, v22, v22 row_ror:4 row_mask:0xf bank_mask:0xf
    v_add_f32_dpp v21, v23, v23 row_ror:4 row_mask:0xf bank_mask:0xf
    v_cvt_pk_bf16_f32 v20, v20, v21
    v_min_u32 v20, -2, v20
    v_or_b32 v20, v20, v11
    v_mov_b32 v56, -1
    buffer_store_dword v20, v10, s[28:31], s66 offen sc1
    s_branch L_r_h2b_92
L_r_db_101:
    buffer_load_dwordx4 v[48:51], v2, s[28:31], s63 offen offset:0 sc1
    buffer_load_dwordx4 v[52:55], v2, s[28:31], s63 offen offset:1024 sc1
    s_sub_u32 s57, s57, 1
    s_cmp_lg_u32 s57, 0
    s_cbranch_scc1 L_r_d_100
    s_branch L_exit
L_r_late_89:
    v_bfe_u32 v20, v2, 6, 1
    v_lshlrev_b32 v20, 4, v20
    v_mov_b32 v21, 0x3f80
    v_lshlrev_b32 v20, v20, v21
    v_cndmask_b32 v16, 0, v20, s[76:77]
    v_cndmask_b32 v17, 0, v20, s[78:79]
    v_cndmask_b32 v18, 0, v20, s[80:81]
    v_cndmask_b32 v19, 0, v20, s[82:83]
    v_lshrrev_b32 v10, 4, v2
    v_and_b32 v10, 0x30, v10
    v_bfe_u32 v11, v2, 4, 2
    v_lshl_add_u32 v10, v11, 2, v10
    v_cndmask_b32 v11, 0, -1, s[6:7]
    v_and_b32 v20, 0xc000, v11
    v_xor_b32 v20, s67, v20
    v_add_u32 v10, v10, v20
    s_cmp_eq_u32 s33, 0
    s_cbranch_scc1 L_r_two_90
    v_mov_b32 v15, s56
    s_waitcnt vmcnt(1)
L_r_b_95:
    v_xor_b32 v12, s36, v48
    v_bitop3_b32 v12, v12, v50, s36 bitop3:0xf6
    v_bitop3_b32 v12, v12, v52, s36 bitop3:0xf6
    v_bitop3_b32 v12, v12, v54, s36 bitop3:0xf6
    v_and_b32 v12, 1, v12
    v_cmp_ne_u32 vcc, 0, v12
    v_mfma_f32_16x16x32_bf16 v[20:23], v[16:19], v[48:51], 0
    v_mfma_f32_16x16x32_bf16 v[20:23], v[16:19], v[52:55], v[20:23]
    s_cbranch_vccnz L_r_bb_96
    s_mov_b64 exec, s[72:73]
    buffer_store_dword v15, v2, s[28:31], s40 offen sc1
    s_mov_b64 exec, -1
    s_nop 3
    v_add_f32_dpp v22, v20, v20 row_ror:8 row_mask:0xf bank_mask:0xf
    v_add_f32_dpp v23, v21, v21 row_ror:8 row_mask:0xf bank_mask:0xf
    s_nop 0
    v_add_f32_dpp v20, v22, v22 row_ror:4 row_mask:0xf bank_mask:0xf
    v_add_f32_dpp v21, v23, v23 row_ror:4 row_mask:0xf bank_mask:0xf
    v_cvt_pk_bf16_f32 v20, v20, v21
    v_min_u32 v20, -2, v20
    v_or_b32 v20, v20, v11
    v_mov_b32 v56, -1
    buffer_store_dword v20, v10, s[28:31], s47 offen sc1
    buffer_load_dwordx4 v[48:51], v2, s[28:31], s63 offen offset:0 sc1
    buffer_load_dwordx4 v[52:55], v2, s[28:31], s63 offen offset:1024 sc1
    ds_read_b128 v[64:67], v3 offset:0
    ds_read_b128 v[68:71], v3 offset:1024
    ds_read_b128 v[72:75], v3 offset:2048
    ds_read_b128 v[76:79], v3 offset:3072
    v_mov_b64 v[24:25], 0
    v_mov_b64 v[26:27], 0
    v_mov_b64 v[28:29], 0
    v_mov_b64 v[30:31], 0
    v_mov_b64 v[32:33], 0
    v_mov_b64 v[34:35], 0
    v_mov_b64 v[36:37], 0
    v_mov_b64 v[38:39], 0
    v_mov_b64 v[40:41], 0
    v_mov_b64 v[42:43], 0
    v_mov_b64 v[44:45], 0
    v_mov_b64 v[46:47], 0
    s_branch L_r_b2_102
L_r_bb_96:
    buffer_load_dwordx4 v[48:51], v2, s[28:31], s46 offen offset:0 sc1
    buffer_load_dwordx4 v[52:55], v2, s[28:31], s46 offen offset:1024 sc1
    s_waitcnt vmcnt(0)
    s_sub_u32 s57, s57, 1
    s_cmp_lg_u32 s57, 0
    s_cbranch_scc1 L_r_b_95
    s_branch L_exit
L_r_two_90:
    ds_read_b128 v[64:67], v3 offset:0
    ds_read_b128 v[68:71], v3 offset:1024
    ds_read_b128 v[72:75], v3 offset:2048
    ds_read_b128 v[76:79], v3 offset:3072
    v_mov_b64 v[24:25], 0
    v_mov_b64 v[26:27], 0
    v_mov_b64 v[28:29], 0
    v_mov_b64 v[30:31], 0
    v_mov_b64 v[32:33], 0
    v_mov_b64 v[34:35], 0
    v_mov_b64 v[36:37], 0
    v_mov_b64 v[38:39], 0
    v_mov_b64 v[40:41], 0
    v_mov_b64 v[42:43], 0
    v_mov_b64 v[44:45], 0
    v_mov_b64 v[46:47], 0
    s_cmp_eq_u32 s51, 2
    s_cbranch_scc1 L_r_c_97
L_r_c_97:
    buffer_load_dwordx4 v[48:51], v2, s[28:31], s63 offen offset:0 sc1
    buffer_load_dwordx4 v[52:55], v2, s[28:31], s63 offen offset:1024 sc1
L_r_b2_102:
    s_waitcnt vmcnt(0)
    v_xor_b32 v12, s36, v48
    v_bitop3_b32 v12, v12, v50, s36 bitop3:0xf6
    v_bitop3_b32 v12, v12, v52, s36 bitop3:0xf6
    v_bitop3_b32 v12, v12, v54, s36 bitop3:0xf6
    v_and_b32 v12, 1, v12
    v_cmp_ne_u32 vcc, 0, v12
    v_mfma_f32_16x16x32_bf16 v[20:23], v[16:19], v[48:51], 0
    v_mfma_f32_16x16x32_bf16 v[20:23], v[16:19], v[52:55], v[20:23]
    s_cbranch_vccnz L_r_cb_98
    s_nop 6
    v_add_f32_dpp v22, v20, v20 row_ror:8 row_mask:0xf bank_mask:0xf
    v_add_f32_dpp v23, v21, v21 row_ror:8 row_mask:0xf bank_mask:0xf
    s_nop 0
    v_add_f32_dpp v20, v22, v22 row_ror:4 row_mask:0xf bank_mask:0xf
    v_add_f32_dpp v21, v23, v23 row_ror:4 row_mask:0xf bank_mask:0xf
    v_cvt_pk_bf16_f32 v20, v20, v21
    v_min_u32 v20, -2, v20
    v_or_b32 v20, v20, v11
    v_mov_b32 v56, -1
    buffer_store_dword v20, v10, s[28:31], s66 offen sc1
    s_mov_b32 m0, s70
    s_add_u32 s56, s56, 1
    s_add_u32 s58, s58, 16384
    s_add_u32 s59, s59, 8192
    s_add_u32 s60, s60, 8192
    s_xor_b32 s36, s36, 1
    s_xor_b32 s67, s67, s68
    s_xor_b32 s68, s68, 0xc000
    s_mov_b32 s48, 0
    s_lshr_b32 s35, s51, 1
    v_and_b32 v10, 0x300, v2
    v_add_u32 v60, v10, v2
    v_and_b32 v10, 0x80, v2
    v_add_u32 v52, v10, v60
    v_min_u32 v10, s34, v2
    v_bfe_u32 v11, v10, 5, 4
    v_add_lshl_u32 v10, v10, v11, 2
    v_add_u32 v11, s70, v10
    s_cmp_gt_i32 s37, s56
    s_cbranch_scc1 L_kv_ok_104
    s_branch L_kv_u_106
L_kv_p_105:
    s_sub_u32 s57, s57, 1
    s_cmp_eq_u32 s57, 0
    s_cbranch_scc1 L_exit
    v_bfe_u32 v9, v2, 2, 4
    buffer_load_dword v9, v9, s[28:31], s98 offen sc1
    s_waitcnt vmcnt(0)
L_kv_u_106:
    v_readlane_b32 s37, v9, 0
    s_nop 3
    s_cmp_ge_u32 s37, 64
    s_cselect_b32 s37, 65, s37
    s_sub_u32 s37, s37, 1
    s_cmp_gt_i32 s37, s56
    s_cbranch_scc0 L_kv_p_105
L_kv_ok_104:
    s_branch L_r_bar_83
L_r_cb_98:
    s_sub_u32 s57, s57, 1
    s_cmp_lg_u32 s57, 0
    s_cbranch_scc1 L_r_c_97
    s_branch L_exit
L_r_h2b_92:
    buffer_load_dword v56, v13, s[28:31], s42 offen sc1
    s_mov_b32 m0, s70
    s_mov_b32 s55, s56
    s_add_u32 s56, s56, 1
    s_add_u32 s58, s58, 16384
    s_add_u32 s59, s59, 8192
    s_add_u32 s60, s60, 8192
    s_xor_b32 s36, s36, 1
    s_xor_b32 s67, s67, s68
    s_xor_b32 s68, s68, 0xc000
    s_mov_b32 s48, 0
    s_lshr_b32 s35, s51, 1
    buffer_load_dword v56, v13, s[28:31], s42 offen sc1
    v_and_b32 v10, 0x300, v2
    v_add_u32 v60, v10, v2
    v_and_b32 v10, 0x80, v2
    v_add_u32 v52, v10, v60
    v_min_u32 v10, s34, v2
    v_bfe_u32 v11, v10, 5, 4
    v_add_lshl_u32 v10, v10, v11, 2
    v_add_u32 v11, s70, v10
    buffer_load_dword v56, v13, s[28:31], s42 offen sc1
    s_cmp_gt_i32 s37, s56
    s_cbranch_scc1 L_kv_ok_112
    s_branch L_kv_u_114
L_kv_p_113:
    s_sub_u32 s57, s57, 1
    s_cmp_eq_u32 s57, 0
    s_cbranch_scc1 L_exit
    v_bfe_u32 v9, v2, 2, 4
    buffer_load_dword v9, v9, s[28:31], s98 offen sc1
    s_waitcnt vmcnt(0)
L_kv_u_114:
    v_readlane_b32 s37, v9, 0
    s_nop 3
    s_cmp_ge_u32 s37, 64
    s_cselect_b32 s37, 65, s37
    s_sub_u32 s37, s37, 1
    s_cmp_gt_i32 s37, s56
    s_cbranch_scc0 L_kv_p_113
L_kv_ok_112:
L_r_fp_115:
    v_cmp_ne_u32 vcc, s55, v56
    buffer_load_dword v56, v13, s[28:31], s42 offen sc1
    s_cbranch_vccz L_r_fok_116
    v_cmp_ne_u32 vcc, s55, v56
    buffer_load_dword v56, v13, s[28:31], s42 offen sc1
    s_cbranch_vccz L_r_fok_116
    v_cmp_ne_u32 vcc, s55, v56
    buffer_load_dword v56, v13, s[28:31], s42 offen sc1
    s_cbranch_vccz L_r_fok_116
    v_cmp_ne_u32 vcc, s55, v56
    buffer_load_dword v56, v13, s[28:31], s42 offen sc1
    s_cbranch_vccz L_r_fok_116
    s_waitcnt vmcnt(24)
    s_sub_u32 s57, s57, 1
    s_cmp_lg_u32 s57, 0
    s_cbranch_scc1 L_r_fp_115
    s_branch L_exit
L_r_fok_116:
    buffer_load_dwordx4 v2, s[28:31], s65 offen offset:0 sc1 lds
    buffer_load_dwordx4 v2, s[28:31], s65 offen offset:1024 sc1 lds
    s_branch L_r_bar_83
L_r_h2_91:
    buffer_load_dword v56, v13, s[28:31], s42 offen sc1
    s_mov_b32 m0, s70
    s_mov_b32 s55, s56
    ds_read_b128 v[64:67], v3 offset:0
    ds_read_b128 v[68:71], v3 offset:1024
    ds_read_b128 v[72:75], v3 offset:2048
    ds_read_b128 v[76:79], v3 offset:3072
    buffer_load_dword v56, v13, s[28:31], s42 offen sc1
    s_add_u32 s56, s56, 1
    s_add_u32 s58, s58, 16384
    s_add_u32 s59, s59, 8192
    s_add_u32 s60, s60, 8192
    s_xor_b32 s36, s36, 1
    s_xor_b32 s67, s67, s68
    s_xor_b32 s68, s68, 0xc000
    s_mov_b32 s48, 0
    s_lshr_b32 s35, s51, 1
    buffer_load_dword v56, v13, s[28:31], s42 offen sc1
L_r_fp_117:
    v_cmp_ne_u32 vcc, s55, v56
    buffer_load_dword v56, v13, s[28:31], s42 offen sc1
    s_cbranch_vccz L_r_fok_118
    v_cmp_ne_u32 vcc, s55, v56
    buffer_load_dword v56, v13, s[28:31], s42 offen sc1
    s_cbranch_vccz L_r_fok_118
    v_cmp_ne_u32 vcc, s55, v56
    buffer_load_dword v56, v13, s[28:31], s42 offen sc1
    s_cbranch_vccz L_r_fok_118
    v_cmp_ne_u32 vcc, s55, v56
    buffer_load_dword v56, v13, s[28:31], s42 offen sc1
    s_cbranch_vccz L_r_fok_118
    s_waitcnt vmcnt(24)
    s_sub_u32 s57, s57, 1
    s_cmp_lg_u32 s57, 0
    s_cbranch_scc1 L_r_fp_117
    s_branch L_exit
L_r_fok_118:
    buffer_load_dwordx4 v2, s[28:31], s65 offen offset:0 sc1 lds
    buffer_load_dwordx4 v2, s[28:31], s65 offen offset:1024 sc1 lds
    buffer_load_dwordx4 v2, s[28:31], s65 offen offset:2048 sc1 lds
    v_and_b32 v10, 0x300, v2
    v_add_u32 v60, v10, v2
    v_and_b32 v10, 0x80, v2
    v_add_u32 v52, v10, v60
    v_min_u32 v10, s34, v2
    v_bfe_u32 v11, v10, 5, 4
    v_add_lshl_u32 v10, v10, v11, 2
    v_add_u32 v11, s70, v10
    s_cmp_gt_i32 s37, s56
    s_cbranch_scc1 L_kv_ok_119
    s_branch L_kv_u_121
L_kv_p_120:
    s_sub_u32 s57, s57, 1
    s_cmp_eq_u32 s57, 0
    s_cbranch_scc1 L_exit
    v_bfe_u32 v9, v2, 2, 4
    buffer_load_dword v9, v9, s[28:31], s98 offen sc1
    s_waitcnt vmcnt(0)
L_kv_u_121:
    v_readlane_b32 s37, v9, 0
    s_nop 3
    s_cmp_ge_u32 s37, 64
    s_cselect_b32 s37, 65, s37
    s_sub_u32 s37, s37, 1
    s_cmp_gt_i32 s37, s56
    s_cbranch_scc0 L_kv_p_120
L_kv_ok_119:
    s_waitcnt vmcnt(8)
    v_mov_b64 v[24:25], 0
    v_mov_b64 v[26:27], 0
    v_mov_b64 v[28:29], 0
    v_mov_b64 v[30:31], 0
    v_mov_b64 v[32:33], 0
    v_mov_b64 v[34:35], 0
    v_mov_b64 v[36:37], 0
    v_mov_b64 v[38:39], 0
    v_mov_b64 v[40:41], 0
    v_mov_b64 v[42:43], 0
    v_mov_b64 v[44:45], 0
    v_mov_b64 v[46:47], 0
    s_branch L_r_bar0_82
L_r_again_77:
    s_cmp_lt_u32 s51, 2
    s_cbranch_scc1 L_r_back_78
    ds_read_b32 v10, v11
    buffer_load_dwordx4 v2, s[28:31], s65 offen sc1 lds
    s_cmp_lg_u32 s51, 0
    buffer_load_dwordx4 v2, s[28:31], s65 offen offset:1024 sc1 lds
    s_cbranch_scc1 L_r_g4_122
    buffer_load_dwordx4 v2, s[28:31], s65 offen offset:2048 sc1 lds
L_r_g4_122:
    s_waitcnt vmcnt(12) lgkmcnt(0)
    v_cmp_eq_u32 vcc, -1, v10
    s_cbranch_vccz L_r_back_78
    s_sub_u32 s57, s57, 1
    s_cmp_lg_u32 s57, 0
    s_cbranch_scc1 L_r_again_77
    s_branch L_exit
L_r_redo_75:
    s_cmp_eq_u32 s48, 1
    s_cbranch_scc1 L_r_go_76
    s_waitcnt vmcnt(0) lgkmcnt(0)
    s_nop 15
    s_barrier
    s_xor_b32 s52, s68, 0xc000
    s_xor_b32 s65, s65, s52
    v_add_u32 v37, s70, v2
    s_sub_u32 s55, s65, s70
    s_add_u32 s55, s55, 7168
L_r_rp_123:
    buffer_load_dwordx4 v[24:27], v2, s[28:31], s65 offen sc1
    buffer_load_dwordx4 v[28:31], v2, s[28:31], s65 offen offset:1024 sc1
    buffer_load_dwordx4 v[32:35], v2, s[28:31], s55 offen offset:2048 sc1
    s_waitcnt vmcnt(0)
    v_max3_u32 v38, v24, v25, v26
    v_max3_u32 v38, v38, v27, v28
    v_max3_u32 v38, v38, v29, v30
    v_max3_u32 v38, v38, v31, v32
    v_max3_u32 v38, v38, v33, v34
    v_max_u32 v38, v38, v35
    v_cmp_eq_u32 vcc, -1, v38
    s_cbranch_vccz L_r_rok_124
    s_sub_u32 s57, s57, 1
    s_cmp_lg_u32 s57, 0
    s_cbranch_scc1 L_r_rp_123
    s_branch L_exit
L_r_rok_124:
    ds_write_b128 v37, v[24:27]
    ds_write_b128 v37, v[28:31] offset:1024
    ds_write_b128 v2, v[32:35] offset:9216
    s_waitcnt lgkmcnt(0)
    ds_read_b128 v[64:67], v3 offset:0
    ds_read_b128 v[68:71], v3 offset:1024
    ds_read_b128 v[72:75], v3 offset:2048
    ds_read_b128 v[76:79], v3 offset:3072
    v_mov_b64 v[24:25], 0
    v_mov_b64 v[26:27], 0
    v_mov_b64 v[28:29], 0
    v_mov_b64 v[30:31], 0
    v_mov_b64 v[32:33], 0
    v_mov_b64 v[34:35], 0
    v_mov_b64 v[36:37], 0
    v_mov_b64 v[38:39], 0
    v_mov_b64 v[40:41], 0
    v_mov_b64 v[42:43], 0
    v_mov_b64 v[44:45], 0
    v_mov_b64 v[46:47], 0
    v_and_b32 v10, 0x300, v2
    v_add_u32 v60, v10, v2
    v_and_b32 v10, 0x80, v2
    v_add_u32 v52, v10, v60
    v_min_u32 v10, s34, v2
    v_bfe_u32 v11, v10, 5, 4
    v_add_lshl_u32 v10, v10, v11, 2
    v_add_u32 v11, s70, v10
    s_mov_b32 s48, 1
    s_mov_b32 s35, 0
    s_waitcnt lgkmcnt(0)
    s_barrier
    s_branch L_r_top_73
L_r_last_74:
    s_waitcnt vmcnt(0) lgkmcnt(0)
    s_barrier
    v_mov_b32 v9, 64
    s_mov_b64 exec, 1
    buffer_store_dword v9, off, s[28:31], s64 sc1
    s_mov_b64 exec, -1
    s_branch L_exit
L_worker:
    s_sub_u32 s46, s3, 64
    s_lshr_b32 s52, s46, 5
    s_and_b32 s53, s46, 31
    s_mul_i32 s54, s52, 11
    s_mul_i32 s55, s52, 10
    s_add_u32 s55, s55, 4
    s_cmp_lt_u32 s52, 4
    s_cselect_b32 s54, s54, s55
    s_cselect_b32 s55, 10, 12
    s_sub_u32 s48, s53, s55
    s_lshr_b32 s47, s48, 1
    s_add_u32 s47, s47, s54
    s_and_b32 s48, s48, 1
    s_cmp_lt_u32 s53, s55
    s_cselect_b32 s48, 2, s48
    s_cselect_b32 s47, s53, s47
    s_lshr_b32 s49, s47, 5
    s_and_b32 s50, s47, 31
    v_lshrrev_b32 v1, 6, v0
    s_nop 0
    v_readfirstlane_b32 s51, v1
    v_and_b32 v0, 63, v0
    s_cmp_eq_u32 s49, 0
    s_cselect_b32 s36, s62, s76
    s_cselect_b32 s37, s63, s77
    s_mov_b32 s38, 0x2400
    s_mov_b32 s39, 0x20000
    s_cselect_b32 s12, s64, s78
    s_cselect_b32 s13, s65, s79
    s_mov_b32 s14, 0x480000
    s_mov_b32 s15, 0x20000
    s_cselect_b32 s16, s66, s80
    s_cselect_b32 s17, s67, s81
    s_mov_b32 s18, 0x480000
    s_mov_b32 s19, 0x20000
    s_cselect_b32 s20, s68, s82
    s_cselect_b32 s21, s69, s83
    s_mov_b32 s22, 0x480000
    s_mov_b32 s23, 0x20000
    s_cselect_b32 s24, s70, s84
    s_cselect_b32 s25, s71, s85
    s_mov_b32 s26, 0x480000
    s_mov_b32 s27, 0x20000
    v_lshrrev_b32 v13, 2, v0
    v_lshlrev_b32 v1, 13, v13
    v_and_b32 v14, 3, v0
    v_lshl_add_u32 v1, v14, 4, v1
    v_lshrrev_b32 v13, 5, v0
    v_lshlrev_b32 v2, 9, v13
    v_bfe_u32 v13, v0, 2, 2
    v_lshl_add_u32 v2, v13, 6, v2
    v_bfe_u32 v13, v0, 4, 1
    v_lshl_add_u32 v2, v13, 5, v2
    v_lshl_add_u32 v2, v14, 3, v2
    s_mul_i32 s53, s51, 36864
    v_add_u32 v2, s53, v2
    v_lshlrev_b32 v12, 4, v0
    v_lshrrev_b32 v13, 3, v0
    s_lshl_b32 s54, s51, 3
    v_add_u32 v13, s54, v13
    v_bfe_u32 v14, v13, 1, 3
    v_and_b32 v15, 7, v0
    v_xor_b32 v14, v14, v15
    v_mul_u32_u24 v3, 1152, v13
    v_lshl_add_u32 v3, v14, 4, v3
    v_and_b32 v13, 31, v0
    v_bfe_u32 v14, v0, 1, 3
    v_lshrrev_b32 v15, 5, v0
    v_xor_b32 v14, v14, v15
    v_xor_b32 v15, 0, v14
    v_lshlrev_b32 v15, 4, v15
    v_lshl_add_u32 v4, v13, 7, v15
    v_xor_b32 v15, 2, v14
    v_lshlrev_b32 v15, 4, v15
    v_lshl_add_u32 v5, v13, 7, v15
    v_xor_b32 v15, 4, v14
    v_lshlrev_b32 v15, 4, v15
    v_lshl_add_u32 v6, v13, 7, v15
    v_xor_b32 v15, 6, v14
    v_lshlrev_b32 v15, 4, v15
    v_lshl_add_u32 v7, v13, 7, v15
    s_mov_b32 s99, 0x100000
    s_lshl_b32 s52, s46, 10
    s_lshl_b32 s53, s51, 8
    s_add_u32 s52, s52, s53
    s_add_u32 s52, s52, 140509184
    v_mov_b32 v32, 0
    v_mov_b32 v33, 0
    v_mov_b32 v34, 0
    v_mov_b32 v35, 0
    s_mov_b64 exec, 0xffff
    buffer_store_dwordx4 v[32:35], v12, s[28:31], s52 offen sc1
    s_mov_b64 exec, 0xff
    s_lshl_b32 s6, s47, 7
    s_add_u32 s6, s6, 140705792
    s_or_b32 s52, s48, s51
    s_cmp_eq_u32 s52, 0
    s_cselect_b32 s52, s6, 0x20000000
    buffer_store_dwordx4 v[32:35], v12, s[28:31], s52 offen sc1
    s_mov_b64 exec, -1
    s_cmp_lg_u32 s48, 1
    s_cbranch_scc1 L_g_skip_126
    v_lshrrev_b32 v112, 3, v0
    v_mul_u32_u24 v112, 1152, v112
    v_and_b32 v113, 7, v0
    v_lshlrev_b32 v113, 4, v113
    v_add_u32 v112, v112, v113
    s_lshl_b32 s52, s47, 2
    s_add_u32 s52, s52, s51
    s_mul_i32 s53, s52, 9216
    buffer_load_dwordx4 v[32:35], v112, s[8:11], s53 offen offset:0
    buffer_load_dwordx4 v[72:75], v113, s[40:43], 0 offen offset:0
    buffer_load_dwordx4 v[36:39], v112, s[8:11], s53 offen offset:128
    buffer_load_dwordx4 v[76:79], v113, s[40:43], 0 offen offset:128
    buffer_load_dwordx4 v[40:43], v112, s[8:11], s53 offen offset:256
    buffer_load_dwordx4 v[80:83], v113, s[40:43], 0 offen offset:256
    buffer_load_dwordx4 v[44:47], v112, s[8:11], s53 offen offset:384
    buffer_load_dwordx4 v[84:87], v113, s[40:43], 0 offen offset:384
    buffer_load_dwordx4 v[48:51], v112, s[8:11], s53 offen offset:512
    buffer_load_dwordx4 v[88:91], v113, s[40:43], 0 offen offset:512
    buffer_load_dwordx4 v[52:55], v112, s[8:11], s53 offen offset:640
    buffer_load_dwordx4 v[92:95], v113, s[40:43], 0 offen offset:640
    buffer_load_dwordx4 v[56:59], v112, s[8:11], s53 offen offset:768
    buffer_load_dwordx4 v[96:99], v113, s[40:43], 0 offen offset:768
    buffer_load_dwordx4 v[60:63], v112, s[8:11], s53 offen offset:896
    buffer_load_dwordx4 v[100:103], v113, s[40:43], 0 offen offset:896
    buffer_load_dwordx4 v[64:67], v112, s[8:11], s53 offen offset:1024
    buffer_load_dwordx4 v[104:107], v113, s[40:43], 0 offen offset:1024
    v_mov_b32 v114, 0
    v_mov_b32 v115, 0
    s_waitcnt vmcnt(0)
    v_lshlrev_b32 v116, 16, v32
    v_lshlrev_b32 v117, 16, v72
    v_fmac_f32 v114, v116, v117
    v_and_b32 v116, 0xffff0000, v32
    v_and_b32 v117, 0xffff0000, v72
    v_fmac_f32 v115, v116, v117
    v_lshlrev_b32 v116, 16, v33
    v_lshlrev_b32 v117, 16, v73
    v_fmac_f32 v114, v116, v117
    v_and_b32 v116, 0xffff0000, v33
    v_and_b32 v117, 0xffff0000, v73
    v_fmac_f32 v115, v116, v117
    v_lshlrev_b32 v116, 16, v34
    v_lshlrev_b32 v117, 16, v74
    v_fmac_f32 v114, v116, v117
    v_and_b32 v116, 0xffff0000, v34
    v_and_b32 v117, 0xffff0000, v74
    v_fmac_f32 v115, v116, v117
    v_lshlrev_b32 v116, 16, v35
    v_lshlrev_b32 v117, 16, v75
    v_fmac_f32 v114, v116, v117
    v_and_b32 v116, 0xffff0000, v35
    v_and_b32 v117, 0xffff0000, v75
    v_fmac_f32 v115, v116, v117
    v_lshlrev_b32 v116, 16, v36
    v_lshlrev_b32 v117, 16, v76
    v_fmac_f32 v114, v116, v117
    v_and_b32 v116, 0xffff0000, v36
    v_and_b32 v117, 0xffff0000, v76
    v_fmac_f32 v115, v116, v117
    v_lshlrev_b32 v116, 16, v37
    v_lshlrev_b32 v117, 16, v77
    v_fmac_f32 v114, v116, v117
    v_and_b32 v116, 0xffff0000, v37
    v_and_b32 v117, 0xffff0000, v77
    v_fmac_f32 v115, v116, v117
    v_lshlrev_b32 v116, 16, v38
    v_lshlrev_b32 v117, 16, v78
    v_fmac_f32 v114, v116, v117
    v_and_b32 v116, 0xffff0000, v38
    v_and_b32 v117, 0xffff0000, v78
    v_fmac_f32 v115, v116, v117
    v_lshlrev_b32 v116, 16, v39
    v_lshlrev_b32 v117, 16, v79
    v_fmac_f32 v114, v116, v117
    v_and_b32 v116, 0xffff0000, v39
    v_and_b32 v117, 0xffff0000, v79
    v_fmac_f32 v115, v116, v117
    v_lshlrev_b32 v116, 16, v40
    v_lshlrev_b32 v117, 16, v80
    v_fmac_f32 v114, v116, v117
    v_and_b32 v116, 0xffff0000, v40
    v_and_b32 v117, 0xffff0000, v80
    v_fmac_f32 v115, v116, v117
    v_lshlrev_b32 v116, 16, v41
    v_lshlrev_b32 v117, 16, v81
    v_fmac_f32 v114, v116, v117
    v_and_b32 v116, 0xffff0000, v41
    v_and_b32 v117, 0xffff0000, v81
    v_fmac_f32 v115, v116, v117
    v_lshlrev_b32 v116, 16, v42
    v_lshlrev_b32 v117, 16, v82
    v_fmac_f32 v114, v116, v117
    v_and_b32 v116, 0xffff0000, v42
    v_and_b32 v117, 0xffff0000, v82
    v_fmac_f32 v115, v116, v117
    v_lshlrev_b32 v116, 16, v43
    v_lshlrev_b32 v117, 16, v83
    v_fmac_f32 v114, v116, v117
    v_and_b32 v116, 0xffff0000, v43
    v_and_b32 v117, 0xffff0000, v83
    v_fmac_f32 v115, v116, v117
    v_lshlrev_b32 v116, 16, v44
    v_lshlrev_b32 v117, 16, v84
    v_fmac_f32 v114, v116, v117
    v_and_b32 v116, 0xffff0000, v44
    v_and_b32 v117, 0xffff0000, v84
    v_fmac_f32 v115, v116, v117
    v_lshlrev_b32 v116, 16, v45
    v_lshlrev_b32 v117, 16, v85
    v_fmac_f32 v114, v116, v117
    v_and_b32 v116, 0xffff0000, v45
    v_and_b32 v117, 0xffff0000, v85
    v_fmac_f32 v115, v116, v117
    v_lshlrev_b32 v116, 16, v46
    v_lshlrev_b32 v117, 16, v86
    v_fmac_f32 v114, v116, v117
    v_and_b32 v116, 0xffff0000, v46
    v_and_b32 v117, 0xffff0000, v86
    v_fmac_f32 v115, v116, v117
    v_lshlrev_b32 v116, 16, v47
    v_lshlrev_b32 v117, 16, v87
    v_fmac_f32 v114, v116, v117
    v_and_b32 v116, 0xffff0000, v47
    v_and_b32 v117, 0xffff0000, v87
    v_fmac_f32 v115, v116, v117
    v_lshlrev_b32 v116, 16, v48
    v_lshlrev_b32 v117, 16, v88
    v_fmac_f32 v114, v116, v117
    v_and_b32 v116, 0xffff0000, v48
    v_and_b32 v117, 0xffff0000, v88
    v_fmac_f32 v115, v116, v117
    v_lshlrev_b32 v116, 16, v49
    v_lshlrev_b32 v117, 16, v89
    v_fmac_f32 v114, v116, v117
    v_and_b32 v116, 0xffff0000, v49
    v_and_b32 v117, 0xffff0000, v89
    v_fmac_f32 v115, v116, v117
    v_lshlrev_b32 v116, 16, v50
    v_lshlrev_b32 v117, 16, v90
    v_fmac_f32 v114, v116, v117
    v_and_b32 v116, 0xffff0000, v50
    v_and_b32 v117, 0xffff0000, v90
    v_fmac_f32 v115, v116, v117
    v_lshlrev_b32 v116, 16, v51
    v_lshlrev_b32 v117, 16, v91
    v_fmac_f32 v114, v116, v117
    v_and_b32 v116, 0xffff0000, v51
    v_and_b32 v117, 0xffff0000, v91
    v_fmac_f32 v115, v116, v117
    v_lshlrev_b32 v116, 16, v52
    v_lshlrev_b32 v117, 16, v92
    v_fmac_f32 v114, v116, v117
    v_and_b32 v116, 0xffff0000, v52
    v_and_b32 v117, 0xffff0000, v92
    v_fmac_f32 v115, v116, v117
    v_lshlrev_b32 v116, 16, v53
    v_lshlrev_b32 v117, 16, v93
    v_fmac_f32 v114, v116, v117
    v_and_b32 v116, 0xffff0000, v53
    v_and_b32 v117, 0xffff0000, v93
    v_fmac_f32 v115, v116, v117
    v_lshlrev_b32 v116, 16, v54
    v_lshlrev_b32 v117, 16, v94
    v_fmac_f32 v114, v116, v117
    v_and_b32 v116, 0xffff0000, v54
    v_and_b32 v117, 0xffff0000, v94
    v_fmac_f32 v115, v116, v117
    v_lshlrev_b32 v116, 16, v55
    v_lshlrev_b32 v117, 16, v95
    v_fmac_f32 v114, v116, v117
    v_and_b32 v116, 0xffff0000, v55
    v_and_b32 v117, 0xffff0000, v95
    v_fmac_f32 v115, v116, v117
    v_lshlrev_b32 v116, 16, v56
    v_lshlrev_b32 v117, 16, v96
    v_fmac_f32 v114, v116, v117
    v_and_b32 v116, 0xffff0000, v56
    v_and_b32 v117, 0xffff0000, v96
    v_fmac_f32 v115, v116, v117
    v_lshlrev_b32 v116, 16, v57
    v_lshlrev_b32 v117, 16, v97
    v_fmac_f32 v114, v116, v117
    v_and_b32 v116, 0xffff0000, v57
    v_and_b32 v117, 0xffff0000, v97
    v_fmac_f32 v115, v116, v117
    v_lshlrev_b32 v116, 16, v58
    v_lshlrev_b32 v117, 16, v98
    v_fmac_f32 v114, v116, v117
    v_and_b32 v116, 0xffff0000, v58
    v_and_b32 v117, 0xffff0000, v98
    v_fmac_f32 v115, v116, v117
    v_lshlrev_b32 v116, 16, v59
    v_lshlrev_b32 v117, 16, v99
    v_fmac_f32 v114, v116, v117
    v_and_b32 v116, 0xffff0000, v59
    v_and_b32 v117, 0xffff0000, v99
    v_fmac_f32 v115, v116, v117
    v_lshlrev_b32 v116, 16, v60
    v_lshlrev_b32 v117, 16, v100
    v_fmac_f32 v114, v116, v117
    v_and_b32 v116, 0xffff0000, v60
    v_and_b32 v117, 0xffff0000, v100
    v_fmac_f32 v115, v116, v117
    v_lshlrev_b32 v116, 16, v61
    v_lshlrev_b32 v117, 16, v101
    v_fmac_f32 v114, v116, v117
    v_and_b32 v116, 0xffff0000, v61
    v_and_b32 v117, 0xffff0000, v101
    v_fmac_f32 v115, v116, v117
    v_lshlrev_b32 v116, 16, v62
    v_lshlrev_b32 v117, 16, v102
    v_fmac_f32 v114, v116, v117
    v_and_b32 v116, 0xffff0000, v62
    v_and_b32 v117, 0xffff0000, v102
    v_fmac_f32 v115, v116, v117
    v_lshlrev_b32 v116, 16, v63
    v_lshlrev_b32 v117, 16, v103
    v_fmac_f32 v114, v116, v117
    v_and_b32 v116, 0xffff0000, v63
    v_and_b32 v117, 0xffff0000, v103
    v_fmac_f32 v115, v116, v117
    v_lshlrev_b32 v116, 16, v64
    v_lshlrev_b32 v117, 16, v104
    v_fmac_f32 v114, v116, v117
    v_and_b32 v116, 0xffff0000, v64
    v_and_b32 v117, 0xffff0000, v104
    v_fmac_f32 v115, v116, v117
    v_lshlrev_b32 v116, 16, v65
    v_lshlrev_b32 v117, 16, v105
    v_fmac_f32 v114, v116, v117
    v_and_b32 v116, 0xffff0000, v65
    v_and_b32 v117, 0xffff0000, v105
    v_fmac_f32 v115, v116, v117
    v_lshlrev_b32 v116, 16, v66
    v_lshlrev_b32 v117, 16, v106
    v_fmac_f32 v114, v116, v117
    v_and_b32 v116, 0xffff0000, v66
    v_and_b32 v117, 0xffff0000, v106
    v_fmac_f32 v115, v116, v117
    v_lshlrev_b32 v116, 16, v67
    v_lshlrev_b32 v117, 16, v107
    v_fmac_f32 v114, v116, v117
    v_and_b32 v116, 0xffff0000, v67
    v_and_b32 v117, 0xffff0000, v107
    v_fmac_f32 v115, v116, v117
    v_add_f32 v114, v114, v115
    s_nop 1
    v_add_f32_dpp v115, v114, v114 quad_perm:[1,0,3,2] row_mask:0xf bank_mask:0xf
    v_mov_b32 v114, v115
    s_nop 1
    v_add_f32_dpp v115, v114, v114 quad_perm:[2,3,0,1] row_mask:0xf bank_mask:0xf
    v_mov_b32 v114, v115
    s_nop 1
    v_add_f32_dpp v115, v114, v114 row_half_mirror row_mask:0xf bank_mask:0xf
    v_mov_b32 v114, v115
    v_mul_f32 v114, 0xbfb8aa3b, v114
    v_exp_f32 v114, v114
    s_nop 0
    v_add_f32 v114, 1.0, v114
    v_rcp_f32 v114, v114
    v_lshrrev_b32 v112, 3, v0
    v_lshlrev_b32 v112, 2, v112
    s_lshl_b32 s52, s52, 5
    s_add_u32 s52, s52, 139460608
    s_mov_b32 exec_lo, 0x01010101
    s_mov_b32 exec_hi, 0x01010101
    buffer_store_dword v114, v112, s[28:31], s52 offen sc1
    s_mov_b64 exec, -1
    s_waitcnt vmcnt(0)
L_g_skip_126:
    s_waitcnt vmcnt(0)
    s_barrier
    s_cmp_lg_u32 s51, 0
    s_cbranch_scc1 L_w_z_125
    v_mov_b32 v32, 144
    v_mov_b32 v33, 1
    s_mov_b64 exec, 1
    global_atomic_add v32, v33, s[44:45]
    s_mov_b64 exec, -1
L_w_z_125:
    s_mov_b32 s100, s70
    s_mov_b32 s101, s71
    s_mov_b32 s4, s84
    s_mov_b32 s5, s85
    s_cmp_eq_u32 s48, 1
    s_cbranch_scc1 L_attn
    s_cmp_eq_u32 s48, 2
    s_cbranch_scc1 L_outproj
    s_cmp_eq_u32 s51, 0
    s_cselect_b32 s94, 1, 0
    s_mov_b32 s95, 0
    s_lshl_b32 s52, s50, 8
    s_lshl_b32 s54, s51, 6
    s_add_u32 s52, s52, s54
    s_mul_i32 s53, s51, 36864
    s_add_u32 m0, s53, 0
    s_add_u32 s54, s52, 0
    buffer_load_dwordx4 v1, s[16:19], s54 offen lds
    s_add_u32 m0, s53, 1024
    s_add_u32 s54, s52, 131072
    buffer_load_dwordx4 v1, s[16:19], s54 offen lds
    s_add_u32 m0, s53, 2048
    s_add_u32 s54, s52, 262144
    buffer_load_dwordx4 v1, s[16:19], s54 offen lds
    s_add_u32 m0, s53, 3072
    s_add_u32 s54, s52, 393216
    buffer_load_dwordx4 v1, s[16:19], s54 offen lds
    s_add_u32 m0, s53, 4096
    s_add_u32 s54, s52, 524288
    buffer_load_dwordx4 v1, s[16:19], s54 offen lds
    s_add_u32 m0, s53, 5120
    s_add_u32 s54, s52, 655360
    buffer_load_dwordx4 v1, s[16:19], s54 offen lds
    s_add_u32 m0, s53, 6144
    s_add_u32 s54, s52, 786432
    buffer_load_dwordx4 v1, s[16:19], s54 offen lds
    s_add_u32 m0, s53, 7168
    s_add_u32 s54, s52, 917504
    buffer_load_dwordx4 v1, s[16:19], s54 offen lds
    s_add_u32 m0, s53, 8192
    s_add_u32 s54, s52, 1048576
    buffer_load_dwordx4 v1, s[16:19], s54 offen lds
    s_add_u32 m0, s53, 9216
    s_add_u32 s54, s52, 1179648
    buffer_load_dwordx4 v1, s[16:19], s54 offen lds
    s_add_u32 m0, s53, 10240
    s_add_u32 s54, s52, 1310720
    buffer_load_dwordx4 v1, s[16:19], s54 offen lds
    s_add_u32 m0, s53, 11264
    s_add_u32 s54, s52, 1441792
    buffer_load_dwordx4 v1, s[16:19], s54 offen lds
    s_add_u32 m0, s53, 12288
    s_add_u32 s54, s52, 1572864
    buffer_load_dwordx4 v1, s[16:19], s54 offen lds
    s_add_u32 m0, s53, 13312
    s_add_u32 s54, s52, 1703936
    buffer_load_dwordx4 v1, s[16:19], s54 offen lds
    s_add_u32 m0, s53, 14336
    s_add_u32 s54, s52, 1835008
    buffer_load_dwordx4 v1, s[16:19], s54 offen lds
    s_add_u32 m0, s53, 15360
    s_add_u32 s54, s52, 1966080
    buffer_load_dwordx4 v1, s[16:19], s54 offen lds
    s_add_u32 m0, s53, 16384
    s_add_u32 s54, s52, 2097152
    buffer_load_dwordx4 v1, s[16:19], s54 offen lds
    s_add_u32 m0, s53, 17408
    s_add_u32 s54, s52, 2228224
    buffer_load_dwordx4 v1, s[16:19], s54 offen lds
    s_add_u32 m0, s53, 18432
    s_add_u32 s54, s52, 2359296
    buffer_load_dwordx4 v1, s[16:19], s54 offen lds
    s_add_u32 m0, s53, 19456
    s_add_u32 s54, s52, 2490368
    buffer_load_dwordx4 v1, s[16:19], s54 offen lds
    s_add_u32 m0, s53, 20480
    s_add_u32 s54, s52, 2621440
    buffer_load_dwordx4 v1, s[16:19], s54 offen lds
    s_add_u32 m0, s53, 21504
    s_add_u32 s54, s52, 2752512
    buffer_load_dwordx4 v1, s[16:19], s54 offen lds
    s_add_u32 m0, s53, 22528
    s_add_u32 s54, s52, 2883584
    buffer_load_dwordx4 v1, s[16:19], s54 offen lds
    s_add_u32 m0, s53, 23552
    s_add_u32 s54, s52, 3014656
    buffer_load_dwordx4 v1, s[16:19], s54 offen lds
    s_add_u32 m0, s53, 24576
    s_add_u32 s54, s52, 3145728
    buffer_load_dwordx4 v1, s[16:19], s54 offen lds
    s_add_u32 m0, s53, 25600
    s_add_u32 s54, s52, 3276800
    buffer_load_dwordx4 v1, s[16:19], s54 offen lds
    s_add_u32 m0, s53, 26624
    s_add_u32 s54, s52, 3407872
    buffer_load_dwordx4 v1, s[16:19], s54 offen lds
    s_add_u32 m0, s53, 27648
    s_add_u32 s54, s52, 3538944
    buffer_load_dwordx4 v1, s[16:19], s54 offen lds
    s_add_u32 m0, s53, 28672
    s_add_u32 s54, s52, 3670016
    buffer_load_dwordx4 v1, s[16:19], s54 offen lds
    s_add_u32 m0, s53, 29696
    s_add_u32 s54, s52, 3801088
    buffer_load_dwordx4 v1, s[16:19], s54 offen lds
    s_add_u32 m0, s53, 30720
    s_add_u32 s54, s52, 3932160
    buffer_load_dwordx4 v1, s[16:19], s54 offen lds
    s_add_u32 m0, s53, 31744
    s_add_u32 s54, s52, 4063232
    buffer_load_dwordx4 v1, s[16:19], s54 offen lds
    s_add_u32 m0, s53, 32768
    s_add_u32 s54, s52, 4194304
    buffer_load_dwordx4 v1, s[16:19], s54 offen lds
    s_add_u32 m0, s53, 33792
    s_add_u32 s54, s52, 4325376
    buffer_load_dwordx4 v1, s[16:19], s54 offen lds
    s_add_u32 m0, s53, 34816
    s_add_u32 s54, s52, 4456448
    buffer_load_dwordx4 v1, s[16:19], s54 offen lds
    s_add_u32 m0, s53, 35840
    s_add_u32 s54, s52, 4587520
    buffer_load_dwordx4 v1, s[16:19], s54 offen lds
    s_waitcnt vmcnt(32)
    ds_read_b64_tr_b16 v[112:113], v2 offset:0
    ds_read_b64_tr_b16 v[114:115], v2 offset:256
    ds_read_b64_tr_b16 v[116:117], v2 offset:1024
    ds_read_b64_tr_b16 v[118:119], v2 offset:1280
    ds_read_b64_tr_b16 v[120:121], v2 offset:2048
    ds_read_b64_tr_b16 v[122:123], v2 offset:2304
    ds_read_b64_tr_b16 v[124:125], v2 offset:3072
    ds_read_b64_tr_b16 v[126:127], v2 offset:3328
    s_waitcnt lgkmcnt(0)
    s_add_u32 m0, s53, 0
    s_add_u32 s54, s52, 0
    buffer_load_dwordx4 v1, s[20:23], s54 offen lds
    s_add_u32 m0, s53, 1024
    s_add_u32 s54, s52, 131072
    buffer_load_dwordx4 v1, s[20:23], s54 offen lds
    s_add_u32 m0, s53, 2048
    s_add_u32 s54, s52, 262144
    buffer_load_dwordx4 v1, s[20:23], s54 offen lds
    s_add_u32 m0, s53, 3072
    s_add_u32 s54, s52, 393216
    buffer_load_dwordx4 v1, s[20:23], s54 offen lds
    s_waitcnt vmcnt(32)
    ds_read_b64_tr_b16 v[128:129], v2 offset:4096
    ds_read_b64_tr_b16 v[130:131], v2 offset:4352
    ds_read_b64_tr_b16 v[132:133], v2 offset:5120
    ds_read_b64_tr_b16 v[134:135], v2 offset:5376
    ds_read_b64_tr_b16 v[136:137], v2 offset:6144
    ds_read_b64_tr_b16 v[138:139], v2 offset:6400
    ds_read_b64_tr_b16 v[140:141], v2 offset:7168
    ds_read_b64_tr_b16 v[142:143], v2 offset:7424
    s_waitcnt lgkmcnt(0)
    s_add_u32 m0, s53, 4096
    s_add_u32 s54, s52, 524288
    buffer_load_dwordx4 v1, s[20:23], s54 offen lds
    s_add_u32 m0, s53, 5120
    s_add_u32 s54, s52, 655360
    buffer_load_dwordx4 v1, s[20:23], s54 offen lds
    s_add_u32 m0, s53, 6144
    s_add_u32 s54, s52, 786432
    buffer_load_dwordx4 v1, s[20:23], s54 offen lds
    s_add_u32 m0, s53, 7168
    s_add_u32 s54, s52, 917504
    buffer_load_dwordx4 v1, s[20:23], s54 offen lds
    s_waitcnt vmcnt(32)
    ds_read_b64_tr_b16 v[144:145], v2 offset:8192
    ds_read_b64_tr_b16 v[146:147], v2 offset:8448
    ds_read_b64_tr_b16 v[148:149], v2 offset:9216
    ds_read_b64_tr_b16 v[150:151], v2 offset:9472
    ds_read_b64_tr_b16 v[152:153], v2 offset:10240
    ds_read_b64_tr_b16 v[154:155], v2 offset:10496
    ds_read_b64_tr_b16 v[156:157], v2 offset:11264
    ds_read_b64_tr_b16 v[158:159], v2 offset:11520
    s_waitcnt lgkmcnt(0)
    s_add_u32 m0, s53, 8192
    s_add_u32 s54, s52, 1048576
    buffer_load_dwordx4 v1, s[20:23], s54 offen lds
    s_add_u32 m0, s53, 9216
    s_add_u32 s54, s52, 1179648
    buffer_load_dwordx4 v1, s[20:23], s54 offen lds
    s_add_u32 m0, s53, 10240
    s_add_u32 s54, s52, 1310720
    buffer_load_dwordx4 v1, s[20:23], s54 offen lds
    s_add_u32 m0, s53, 11264
    s_add_u32 s54, s52, 1441792
    buffer_load_dwordx4 v1, s[20:23], s54 offen lds
    s_waitcnt vmcnt(32)
    ds_read_b64_tr_b16 v[160:161], v2 offset:12288
    ds_read_b64_tr_b16 v[162:163], v2 offset:12544
    ds_read_b64_tr_b16 v[164:165], v2 offset:13312
    ds_read_b64_tr_b16 v[166:167], v2 offset:13568
    ds_read_b64_tr_b16 v[168:169], v2 offset:14336
    ds_read_b64_tr_b16 v[170:171], v2 offset:14592
    ds_read_b64_tr_b16 v[172:173], v2 offset:15360
    ds_read_b64_tr_b16 v[174:175], v2 offset:15616
    s_waitcnt lgkmcnt(0)
    s_add_u32 m0, s53, 12288
    s_add_u32 s54, s52, 1572864
    buffer_load_dwordx4 v1, s[20:23], s54 offen lds
    s_add_u32 m0, s53, 13312
    s_add_u32 s54, s52, 1703936
    buffer_load_dwordx4 v1, s[20:23], s54 offen lds
    s_add_u32 m0, s53, 14336
    s_add_u32 s54, s52, 1835008
    buffer_load_dwordx4 v1, s[20:23], s54 offen lds
    s_add_u32 m0, s53, 15360
    s_add_u32 s54, s52, 1966080
    buffer_load_dwordx4 v1, s[20:23], s54 offen lds
    s_waitcnt vmcnt(32)
    ds_read_b64_tr_b16 v[176:177], v2 offset:16384
    ds_read_b64_tr_b16 v[178:179], v2 offset:16640
    ds_read_b64_tr_b16 v[180:181], v2 offset:17408
    ds_read_b64_tr_b16 v[182:183], v2 offset:17664
    ds_read_b64_tr_b16 v[184:185], v2 offset:18432
    ds_read_b64_tr_b16 v[186:187], v2 offset:18688
    ds_read_b64_tr_b16 v[188:189], v2 offset:19456
    ds_read_b64_tr_b16 v[190:191], v2 offset:19712
    s_waitcnt lgkmcnt(0)
    s_add_u32 m0, s53, 16384
    s_add_u32 s54, s52, 2097152
    buffer_load_dwordx4 v1, s[20:23], s54 offen lds
    s_add_u32 m0, s53, 17408
    s_add_u32 s54, s52, 2228224
    buffer_load_dwordx4 v1, s[20:23], s54 offen lds
    s_add_u32 m0, s53, 18432
    s_add_u32 s54, s52, 2359296
    buffer_load_dwordx4 v1, s[20:23], s54 offen lds
    s_add_u32 m0, s53, 19456
    s_add_u32 s54, s52, 2490368
    buffer_load_dwordx4 v1, s[20:23], s54 offen lds
    s_waitcnt vmcnt(32)
    ds_read_b64_tr_b16 v[192:193], v2 offset:20480
    ds_read_b64_tr_b16 v[194:195], v2 offset:20736
    ds_read_b64_tr_b16 v[196:197], v2 offset:21504
    ds_read_b64_tr_b16 v[198:199], v2 offset:21760
    ds_read_b64_tr_b16 v[200:201], v2 offset:22528
    ds_read_b64_tr_b16 v[202:203], v2 offset:22784
    ds_read_b64_tr_b16 v[204:205], v2 offset:23552
    ds_read_b64_tr_b16 v[206:207], v2 offset:23808
    s_waitcnt lgkmcnt(0)
    s_add_u32 m0, s53, 20480
    s_add_u32 s54, s52, 2621440
    buffer_load_dwordx4 v1, s[20:23], s54 offen lds
    s_add_u32 m0, s53, 21504
    s_add_u32 s54, s52, 2752512
    buffer_load_dwordx4 v1, s[20:23], s54 offen lds
    s_add_u32 m0, s53, 22528
    s_add_u32 s54, s52, 2883584
    buffer_load_dwordx4 v1, s[20:23], s54 offen lds
    s_add_u32 m0, s53, 23552
    s_add_u32 s54, s52, 3014656
    buffer_load_dwordx4 v1, s[20:23], s54 offen lds
    s_waitcnt vmcnt(32)
    ds_read_b64_tr_b16 v[208:209], v2 offset:24576
    ds_read_b64_tr_b16 v[210:211], v2 offset:24832
    ds_read_b64_tr_b16 v[212:213], v2 offset:25600
    ds_read_b64_tr_b16 v[214:215], v2 offset:25856
    ds_read_b64_tr_b16 v[216:217], v2 offset:26624
    ds_read_b64_tr_b16 v[218:219], v2 offset:26880
    ds_read_b64_tr_b16 v[220:221], v2 offset:27648
    ds_read_b64_tr_b16 v[222:223], v2 offset:27904
    s_waitcnt lgkmcnt(0)
    s_add_u32 m0, s53, 24576
    s_add_u32 s54, s52, 3145728
    buffer_load_dwordx4 v1, s[20:23], s54 offen lds
    s_add_u32 m0, s53, 25600
    s_add_u32 s54, s52, 3276800
    buffer_load_dwordx4 v1, s[20:23], s54 offen lds
    s_add_u32 m0, s53, 26624
    s_add_u32 s54, s52, 3407872
    buffer_load_dwordx4 v1, s[20:23], s54 offen lds
    s_add_u32 m0, s53, 27648
    s_add_u32 s54, s52, 3538944
    buffer_load_dwordx4 v1, s[20:23], s54 offen lds
    s_waitcnt vmcnt(32)
    ds_read_b64_tr_b16 v[224:225], v2 offset:28672
    ds_read_b64_tr_b16 v[226:227], v2 offset:28928
    ds_read_b64_tr_b16 v[228:229], v2 offset:29696
    ds_read_b64_tr_b16 v[230:231], v2 offset:29952
    ds_read_b64_tr_b16 v[232:233], v2 offset:30720
    ds_read_b64_tr_b16 v[234:235], v2 offset:30976
    ds_read_b64_tr_b16 v[236:237], v2 offset:31744
    ds_read_b64_tr_b16 v[238:239], v2 offset:32000
    s_waitcnt lgkmcnt(0)
    s_add_u32 m0, s53, 28672
    s_add_u32 s54, s52, 3670016
    buffer_load_dwordx4 v1, s[20:23], s54 offen lds
    s_add_u32 m0, s53, 29696
    s_add_u32 s54, s52, 3801088
    buffer_load_dwordx4 v1, s[20:23], s54 offen lds
    s_add_u32 m0, s53, 30720
    s_add_u32 s54, s52, 3932160
    buffer_load_dwordx4 v1, s[20:23], s54 offen lds
    s_add_u32 m0, s53, 31744
    s_add_u32 s54, s52, 4063232
    buffer_load_dwordx4 v1, s[20:23], s54 offen lds
    s_waitcnt vmcnt(32)
    ds_read_b64_tr_b16 v[240:241], v2 offset:32768
    ds_read_b64_tr_b16 v[242:243], v2 offset:33024
    ds_read_b64_tr_b16 v[244:245], v2 offset:33792
    ds_read_b64_tr_b16 v[246:247], v2 offset:34048
    ds_read_b64_tr_b16 v[248:249], v2 offset:34816
    ds_read_b64_tr_b16 v[250:251], v2 offset:35072
    ds_read_b64_tr_b16 v[252:253], v2 offset:35840
    ds_read_b64_tr_b16 v[254:255], v2 offset:36096
    s_waitcnt lgkmcnt(0)
    s_add_u32 m0, s53, 32768
    s_add_u32 s54, s52, 4194304
    buffer_load_dwordx4 v1, s[20:23], s54 offen lds
    s_add_u32 m0, s53, 33792
    s_add_u32 s54, s52, 4325376
    buffer_load_dwordx4 v1, s[20:23], s54 offen lds
    s_add_u32 m0, s53, 34816
    s_add_u32 s54, s52, 4456448
    buffer_load_dwordx4 v1, s[20:23], s54 offen lds
    s_add_u32 m0, s53, 35840
    s_add_u32 s54, s52, 4587520
    buffer_load_dwordx4 v1, s[20:23], s54 offen lds
    s_waitcnt vmcnt(32)
    ds_read_b64_tr_b16 a[0:1], v2 offset:0
    ds_read_b64_tr_b16 a[2:3], v2 offset:256
    ds_read_b64_tr_b16 a[4:5], v2 offset:1024
    ds_read_b64_tr_b16 a[6:7], v2 offset:1280
    ds_read_b64_tr_b16 a[8:9], v2 offset:2048
    ds_read_b64_tr_b16 a[10:11], v2 offset:2304
    ds_read_b64_tr_b16 a[12:13], v2 offset:3072
    ds_read_b64_tr_b16 a[14:15], v2 offset:3328
    s_waitcnt vmcnt(28)
    ds_read_b64_tr_b16 a[16:17], v2 offset:4096
    ds_read_b64_tr_b16 a[18:19], v2 offset:4352
    ds_read_b64_tr_b16 a[20:21], v2 offset:5120
    ds_read_b64_tr_b16 a[22:23], v2 offset:5376
    ds_read_b64_tr_b16 a[24:25], v2 offset:6144
    ds_read_b64_tr_b16 a[26:27], v2 offset:6400
    ds_read_b64_tr_b16 a[28:29], v2 offset:7168
    ds_read_b64_tr_b16 a[30:31], v2 offset:7424
    s_waitcnt vmcnt(24)
    ds_read_b64_tr_b16 a[32:33], v2 offset:8192
    ds_read_b64_tr_b16 a[34:35], v2 offset:8448
    ds_read_b64_tr_b16 a[36:37], v2 offset:9216
    ds_read_b64_tr_b16 a[38:39], v2 offset:9472
    ds_read_b64_tr_b16 a[40:41], v2 offset:10240
    ds_read_b64_tr_b16 a[42:43], v2 offset:10496
    ds_read_b64_tr_b16 a[44:45], v2 offset:11264
    ds_read_b64_tr_b16 a[46:47], v2 offset:11520
    s_waitcnt vmcnt(20)
    ds_read_b64_tr_b16 a[48:49], v2 offset:12288
    ds_read_b64_tr_b16 a[50:51], v2 offset:12544
    ds_read_b64_tr_b16 a[52:53], v2 offset:13312
    ds_read_b64_tr_b16 a[54:55], v2 offset:13568
    ds_read_b64_tr_b16 a[56:57], v2 offset:14336
    ds_read_b64_tr_b16 a[58:59], v2 offset:14592
    ds_read_b64_tr_b16 a[60:61], v2 offset:15360
    ds_read_b64_tr_b16 a[62:63], v2 offset:15616
    s_waitcnt vmcnt(16)
    ds_read_b64_tr_b16 a[64:65], v2 offset:16384
    ds_read_b64_tr_b16 a[66:67], v2 offset:16640
    ds_read_b64_tr_b16 a[68:69], v2 offset:17408
    ds_read_b64_tr_b16 a[70:71], v2 offset:17664
    ds_read_b64_tr_b16 a[72:73], v2 offset:18432
    ds_read_b64_tr_b16 a[74:75], v2 offset:18688
    ds_read_b64_tr_b16 a[76:77], v2 offset:19456
    ds_read_b64_tr_b16 a[78:79], v2 offset:19712
    s_waitcnt vmcnt(12)
    ds_read_b64_tr_b16 a[80:81], v2 offset:20480
    ds_read_b64_tr_b16 a[82:83], v2 offset:20736
    ds_read_b64_tr_b16 a[84:85], v2 offset:21504
    ds_read_b64_tr_b16 a[86:87], v2 offset:21760
    ds_read_b64_tr_b16 a[88:89], v2 offset:22528
    ds_read_b64_tr_b16 a[90:91], v2 offset:22784
    ds_read_b64_tr_b16 a[92:93], v2 offset:23552
    ds_read_b64_tr_b16 a[94:95], v2 offset:23808
    s_waitcnt vmcnt(8)
    ds_read_b64_tr_b16 a[96:97], v2 offset:24576
    ds_read_b64_tr_b16 a[98:99], v2 offset:24832
    ds_read_b64_tr_b16 a[100:101], v2 offset:25600
    ds_read_b64_tr_b16 a[102:103], v2 offset:25856
    ds_read_b64_tr_b16 a[104:105], v2 offset:26624
    ds_read_b64_tr_b16 a[106:107], v2 offset:26880
    ds_read_b64_tr_b16 a[108:109], v2 offset:27648
    ds_read_b64_tr_b16 a[110:111], v2 offset:27904
    s_waitcnt vmcnt(4)
    ds_read_b64_tr_b16 a[112:113], v2 offset:28672
    ds_read_b64_tr_b16 a[114:115], v2 offset:28928
    ds_read_b64_tr_b16 a[116:117], v2 offset:29696
    ds_read_b64_tr_b16 a[118:119], v2 offset:29952
    ds_read_b64_tr_b16 a[120:121], v2 offset:30720
    ds_read_b64_tr_b16 a[122:123], v2 offset:30976
    ds_read_b64_tr_b16 a[124:125], v2 offset:31744
    ds_read_b64_tr_b16 a[126:127], v2 offset:32000
    s_waitcnt vmcnt(0)
    ds_read_b64_tr_b16 a[128:129], v2 offset:32768
    ds_read_b64_tr_b16 a[130:131], v2 offset:33024
    ds_read_b64_tr_b16 a[132:133], v2 offset:33792
    ds_read_b64_tr_b16 a[134:135], v2 offset:34048
    ds_read_b64_tr_b16 a[136:137], v2 offset:34816
    ds_read_b64_tr_b16 a[138:139], v2 offset:35072
    ds_read_b64_tr_b16 a[140:141], v2 offset:35840
    ds_read_b64_tr_b16 a[142:143], v2 offset:36096
    s_waitcnt lgkmcnt(0)
    s_barrier
    s_mov_b32 s57, 0
    s_mul_i32 s96, s57, 36864
    s_lshl_b32 s59, s51, 10
    s_add_u32 m0, s59, 0
    s_add_u32 s54, s96, 0
    buffer_load_dwordx4 v3, s[8:11], s54 offen lds
    s_add_u32 m0, s59, 4096
    s_add_u32 s54, s96, 128
    buffer_load_dwordx4 v3, s[8:11], s54 offen lds
    s_add_u32 m0, s59, 8192
    s_add_u32 s54, s96, 256
    buffer_load_dwordx4 v3, s[8:11], s54 offen lds
    s_add_u32 m0, s59, 12288
    s_add_u32 s54, s96, 384
    buffer_load_dwordx4 v3, s[8:11], s54 offen lds
    s_add_u32 m0, s59, 16384
    s_add_u32 s54, s96, 512
    buffer_load_dwordx4 v3, s[8:11], s54 offen lds
    s_add_u32 m0, s59, 20480
    s_add_u32 s54, s96, 640
    buffer_load_dwordx4 v3, s[8:11], s54 offen lds
    s_add_u32 m0, s59, 24576
    s_add_u32 s54, s96, 768
    buffer_load_dwordx4 v3, s[8:11], s54 offen lds
    s_add_u32 m0, s59, 28672
    s_add_u32 s54, s96, 896
    buffer_load_dwordx4 v3, s[8:11], s54 offen lds
    s_add_u32 m0, s59, 32768
    s_add_u32 s54, s96, 1024
    buffer_load_dwordx4 v3, s[8:11], s54 offen lds
    s_add_u32 s96, s96, 36864
    s_add_u32 s59, s59, 36864
    s_add_u32 m0, s59, 0
    s_add_u32 s54, s96, 0
    buffer_load_dwordx4 v3, s[8:11], s54 offen lds
    s_add_u32 m0, s59, 4096
    s_add_u32 s54, s96, 128
    buffer_load_dwordx4 v3, s[8:11], s54 offen lds
    s_add_u32 m0, s59, 8192
    s_add_u32 s54, s96, 256
    buffer_load_dwordx4 v3, s[8:11], s54 offen lds
    s_add_u32 m0, s59, 12288
    s_add_u32 s54, s96, 384
    buffer_load_dwordx4 v3, s[8:11], s54 offen lds
    s_add_u32 m0, s59, 16384
    s_add_u32 s54, s96, 512
    buffer_load_dwordx4 v3, s[8:11], s54 offen lds
    s_add_u32 m0, s59, 20480
    s_add_u32 s54, s96, 640
    buffer_load_dwordx4 v3, s[8:11], s54 offen lds
    s_add_u32 m0, s59, 24576
    s_add_u32 s54, s96, 768
    buffer_load_dwordx4 v3, s[8:11], s54 offen lds
    s_add_u32 m0, s59, 28672
    s_add_u32 s54, s96, 896
    buffer_load_dwordx4 v3, s[8:11], s54 offen lds
    s_add_u32 m0, s59, 32768
    s_add_u32 s54, s96, 1024
    buffer_load_dwordx4 v3, s[8:11], s54 offen lds
    s_add_u32 s96, s96, 36864
    s_add_u32 s59, s59, 36864
    s_add_u32 m0, s59, 0
    s_add_u32 s54, s96, 0
    buffer_load_dwordx4 v3, s[8:11], s54 offen lds
    s_add_u32 m0, s59, 4096
    s_add_u32 s54, s96, 128
    buffer_load_dwordx4 v3, s[8:11], s54 offen lds
    s_add_u32 m0, s59, 8192
    s_add_u32 s54, s96, 256
    buffer_load_dwordx4 v3, s[8:11], s54 offen lds
    s_add_u32 m0, s59, 12288
    s_add_u32 s54, s96, 384
    buffer_load_dwordx4 v3, s[8:11], s54 offen lds
    s_add_u32 m0, s59, 16384
    s_add_u32 s54, s96, 512
    buffer_load_dwordx4 v3, s[8:11], s54 offen lds
    s_add_u32 m0, s59, 20480
    s_add_u32 s54, s96, 640
    buffer_load_dwordx4 v3, s[8:11], s54 offen lds
    s_add_u32 m0, s59, 24576
    s_add_u32 s54, s96, 768
    buffer_load_dwordx4 v3, s[8:11], s54 offen lds
    s_add_u32 m0, s59, 28672
    s_add_u32 s54, s96, 896
    buffer_load_dwordx4 v3, s[8:11], s54 offen lds
    s_add_u32 m0, s59, 32768
    s_add_u32 s54, s96, 1024
    buffer_load_dwordx4 v3, s[8:11], s54 offen lds
    s_add_u32 s96, s96, 36864
    s_add_u32 s59, s59, 36864
    s_mov_b32 s56, 36864
    s_mov_b32 s98, 0
    s_lshl_b32 s97, s47, 6
    s_add_u32 s97, s97, s57
    s_lshl_b32 s97, s97, 14
    s_lshl_b32 s54, s51, 11
    s_add_u32 s97, s97, s54
    s_waitcnt vmcnt(18)
    s_barrier
    v_mov_b32 v8, v4
    v_mov_b32 v9, v5
    v_mov_b32 v10, v6
    v_mov_b32 v11, v7
    ds_read_b128 v[16:19], v8 offset:0
    ds_read_b128 v[20:23], v9 offset:0
    ds_read_b128 v[24:27], v10 offset:0
    s_waitcnt lgkmcnt(2)
    v_mfma_f32_32x32x16_bf16 v[48:63], v[112:115], v[16:19], 0
    ds_read_b128 v[28:31], v11 offset:0
    v_mfma_f32_32x32x16_bf16 v[64:79], v[16:19], a[0:3], 0
    s_waitcnt lgkmcnt(2)
    v_mfma_f32_32x32x16_bf16 v[48:63], v[116:119], v[20:23], v[48:63]
    ds_read_b128 v[16:19], v8 offset:4096
    v_mfma_f32_32x32x16_bf16 v[64:79], v[20:23], a[4:7], v[64:79]
    s_waitcnt lgkmcnt(2)
    v_mfma_f32_32x32x16_bf16 v[48:63], v[120:123], v[24:27], v[48:63]
    ds_read_b128 v[20:23], v9 offset:4096
    v_mfma_f32_32x32x16_bf16 v[64:79], v[24:27], a[8:11], v[64:79]
    s_waitcnt lgkmcnt(2)
    v_mfma_f32_32x32x16_bf16 v[48:63], v[124:127], v[28:31], v[48:63]
    ds_read_b128 v[24:27], v10 offset:4096
    v_mfma_f32_32x32x16_bf16 v[64:79], v[28:31], a[12:15], v[64:79]
    s_waitcnt lgkmcnt(2)
    v_mfma_f32_32x32x16_bf16 v[48:63], v[128:131], v[16:19], v[48:63]
    ds_read_b128 v[28:31], v11 offset:4096
    v_mfma_f32_32x32x16_bf16 v[64:79], v[16:19], a[16:19], v[64:79]
    s_waitcnt lgkmcnt(2)
    v_mfma_f32_32x32x16_bf16 v[48:63], v[132:135], v[20:23], v[48:63]
    ds_read_b128 v[16:19], v8 offset:8192
    v_mfma_f32_32x32x16_bf16 v[64:79], v[20:23], a[20:23], v[64:79]
    s_waitcnt lgkmcnt(2)
    v_mfma_f32_32x32x16_bf16 v[48:63], v[136:139], v[24:27], v[48:63]
    ds_read_b128 v[20:23], v9 offset:8192
    v_mfma_f32_32x32x16_bf16 v[64:79], v[24:27], a[24:27], v[64:79]
    s_waitcnt lgkmcnt(2)
    v_mfma_f32_32x32x16_bf16 v[48:63], v[140:143], v[28:31], v[48:63]
    ds_read_b128 v[24:27], v10 offset:8192
    v_mfma_f32_32x32x16_bf16 v[64:79], v[28:31], a[28:31], v[64:79]
    s_waitcnt lgkmcnt(2)
    v_mfma_f32_32x32x16_bf16 v[48:63], v[144:147], v[16:19], v[48:63]
    ds_read_b128 v[28:31], v11 offset:8192
    v_mfma_f32_32x32x16_bf16 v[64:79], v[16:19], a[32:35], v[64:79]
    s_barrier
    s_waitcnt lgkmcnt(2)
    v_mfma_f32_32x32x16_bf16 v[48:63], v[148:151], v[20:23], v[48:63]
    ds_read_b128 v[16:19], v8 offset:12288
    s_add_u32 m0, s59, 0
    s_add_u32 s54, s96, 0
    buffer_load_dwordx4 v3, s[8:11], s54 offen lds
    v_mfma_f32_32x32x16_bf16 v[64:79], v[20:23], a[36:39], v[64:79]
    s_waitcnt lgkmcnt(2)
    v_mfma_f32_32x32x16_bf16 v[48:63], v[152:155], v[24:27], v[48:63]
    ds_read_b128 v[20:23], v9 offset:12288
    v_mfma_f32_32x32x16_bf16 v[64:79], v[24:27], a[40:43], v[64:79]
    s_waitcnt lgkmcnt(2)
    v_mfma_f32_32x32x16_bf16 v[48:63], v[156:159], v[28:31], v[48:63]
    ds_read_b128 v[24:27], v10 offset:12288
    s_add_u32 m0, s59, 4096
    s_add_u32 s54, s96, 128
    buffer_load_dwordx4 v3, s[8:11], s54 offen lds
    v_mfma_f32_32x32x16_bf16 v[64:79], v[28:31], a[44:47], v[64:79]
    s_waitcnt lgkmcnt(2)
    v_mfma_f32_32x32x16_bf16 v[48:63], v[160:163], v[16:19], v[48:63]
    ds_read_b128 v[28:31], v11 offset:12288
    v_mfma_f32_32x32x16_bf16 v[64:79], v[16:19], a[48:51], v[64:79]
    s_waitcnt lgkmcnt(2)
    v_mfma_f32_32x32x16_bf16 v[48:63], v[164:167], v[20:23], v[48:63]
    ds_read_b128 v[16:19], v8 offset:16384
    s_add_u32 m0, s59, 8192
    s_add_u32 s54, s96, 256
    buffer_load_dwordx4 v3, s[8:11], s54 offen lds
    v_mfma_f32_32x32x16_bf16 v[64:79], v[20:23], a[52:55], v[64:79]
    s_waitcnt lgkmcnt(2)
    v_mfma_f32_32x32x16_bf16 v[48:63], v[168:171], v[24:27], v[48:63]
    ds_read_b128 v[20:23], v9 offset:16384
    v_mfma_f32_32x32x16_bf16 v[64:79], v[24:27], a[56:59], v[64:79]
    s_waitcnt lgkmcnt(2)
    v_mfma_f32_32x32x16_bf16 v[48:63], v[172:175], v[28:31], v[48:63]
    ds_read_b128 v[24:27], v10 offset:16384
    s_add_u32 m0, s59, 12288
    s_add_u32 s54, s96, 384
    buffer_load_dwordx4 v3, s[8:11], s54 offen lds
    v_mfma_f32_32x32x16_bf16 v[64:79], v[28:31], a[60:63], v[64:79]
    s_waitcnt lgkmcnt(2)
    v_mfma_f32_32x32x16_bf16 v[48:63], v[176:179], v[16:19], v[48:63]
    ds_read_b128 v[28:31], v11 offset:16384
    v_mfma_f32_32x32x16_bf16 v[64:79], v[16:19], a[64:67], v[64:79]
    s_waitcnt lgkmcnt(2)
    v_mfma_f32_32x32x16_bf16 v[48:63], v[180:183], v[20:23], v[48:63]
    ds_read_b128 v[16:19], v8 offset:20480
    s_add_u32 m0, s59, 16384
    s_add_u32 s54, s96, 512
    buffer_load_dwordx4 v3, s[8:11], s54 offen lds
    v_mfma_f32_32x32x16_bf16 v[64:79], v[20:23], a[68:71], v[64:79]
    s_waitcnt lgkmcnt(2)
    v_mfma_f32_32x32x16_bf16 v[48:63], v[184:187], v[24:27], v[48:63]
    ds_read_b128 v[20:23], v9 offset:20480
    v_mfma_f32_32x32x16_bf16 v[64:79], v[24:27], a[72:75], v[64:79]
    s_waitcnt lgkmcnt(2)
    v_mfma_f32_32x32x16_bf16 v[48:63], v[188:191], v[28:31], v[48:63]
    ds_read_b128 v[24:27], v10 offset:20480
    s_add_u32 m0, s59, 20480
    s_add_u32 s54, s96, 640
    buffer_load_dwordx4 v3, s[8:11], s54 offen lds
    v_mfma_f32_32x32x16_bf16 v[64:79], v[28:31], a[76:79], v[64:79]
    s_waitcnt lgkmcnt(2)
    v_mfma_f32_32x32x16_bf16 v[48:63], v[192:195], v[16:19], v[48:63]
    ds_read_b128 v[28:31], v11 offset:20480
    v_mfma_f32_32x32x16_bf16 v[64:79], v[16:19], a[80:83], v[64:79]
    s_waitcnt lgkmcnt(2)
    v_mfma_f32_32x32x16_bf16 v[48:63], v[196:199], v[20:23], v[48:63]
    ds_read_b128 v[16:19], v8 offset:24576
    s_add_u32 m0, s59, 24576
    s_add_u32 s54, s96, 768
    buffer_load_dwordx4 v3, s[8:11], s54 offen lds
    v_mfma_f32_32x32x16_bf16 v[64:79], v[20:23], a[84:87], v[64:79]
    s_waitcnt lgkmcnt(2)
    v_mfma_f32_32x32x16_bf16 v[48:63], v[200:203], v[24:27], v[48:63]
    ds_read_b128 v[20:23], v9 offset:24576
    v_mfma_f32_32x32x16_bf16 v[64:79], v[24:27], a[88:91], v[64:79]
    s_waitcnt lgkmcnt(2)
    v_mfma_f32_32x32x16_bf16 v[48:63], v[204:207], v[28:31], v[48:63]
    ds_read_b128 v[24:27], v10 offset:24576
    s_add_u32 m0, s59, 28672
    s_add_u32 s54, s96, 896
    buffer_load_dwordx4 v3, s[8:11], s54 offen lds
    v_mfma_f32_32x32x16_bf16 v[64:79], v[28:31], a[92:95], v[64:79]
    s_waitcnt lgkmcnt(2)
    v_mfma_f32_32x32x16_bf16 v[48:63], v[208:211], v[16:19], v[48:63]
    ds_read_b128 v[28:31], v11 offset:24576
    v_mfma_f32_32x32x16_bf16 v[64:79], v[16:19], a[96:99], v[64:79]
    s_waitcnt lgkmcnt(2)
    v_mfma_f32_32x32x16_bf16 v[48:63], v[212:215], v[20:23], v[48:63]
    ds_read_b128 v[16:19], v8 offset:28672
    s_add_u32 m0, s59, 32768
    s_add_u32 s54, s96, 1024
    buffer_load_dwordx4 v3, s[8:11], s54 offen lds
    v_mfma_f32_32x32x16_bf16 v[64:79], v[20:23], a[100:103], v[64:79]
    s_waitcnt lgkmcnt(2)
    v_mfma_f32_32x32x16_bf16 v[48:63], v[216:219], v[24:27], v[48:63]
    ds_read_b128 v[20:23], v9 offset:28672
    v_mfma_f32_32x32x16_bf16 v[64:79], v[24:27], a[104:107], v[64:79]
    s_waitcnt lgkmcnt(2)
    v_mfma_f32_32x32x16_bf16 v[48:63], v[220:223], v[28:31], v[48:63]
    ds_read_b128 v[24:27], v10 offset:28672
    s_add_u32 s96, s96, 36864
    s_add_u32 s59, s59, 36864
    s_cmp_ge_u32 s59, 147456
    s_cselect_b32 s54, 147456, 0
    s_sub_u32 s59, s59, s54
    v_mfma_f32_32x32x16_bf16 v[64:79], v[28:31], a[108:111], v[64:79]
    s_waitcnt lgkmcnt(2)
    v_mfma_f32_32x32x16_bf16 v[48:63], v[224:227], v[16:19], v[48:63]
    ds_read_b128 v[28:31], v11 offset:28672
    s_waitcnt vmcnt(9)
    v_mfma_f32_32x32x16_bf16 v[64:79], v[16:19], a[112:115], v[64:79]
    s_barrier
    s_waitcnt lgkmcnt(2)
    v_mfma_f32_32x32x16_bf16 v[48:63], v[228:231], v[20:23], v[48:63]
    ds_read_b128 v[16:19], v8 offset:32768
    v_mov_b32 v13, s98
    s_mov_b64 exec, s[94:95]
    buffer_store_dword v13, off, s[28:31], s6 sc1
    s_mov_b64 exec, -1
    s_add_u32 s98, s98, 1
    v_mfma_f32_32x32x16_bf16 v[64:79], v[20:23], a[116:119], v[64:79]
    s_waitcnt lgkmcnt(2)
    v_mfma_f32_32x32x16_bf16 v[48:63], v[232:235], v[24:27], v[48:63]
    ds_read_b128 v[20:23], v9 offset:32768
    v_mfma_f32_32x32x16_bf16 v[64:79], v[24:27], a[120:123], v[64:79]
    v_add_u32 v8, s56, v4
    s_waitcnt lgkmcnt(2)
    v_mfma_f32_32x32x16_bf16 v[48:63], v[236:239], v[28:31], v[48:63]
    ds_read_b128 v[24:27], v10 offset:32768
    v_mfma_f32_32x32x16_bf16 v[64:79], v[28:31], a[124:127], v[64:79]
    v_add_u32 v9, s56, v5
    s_waitcnt lgkmcnt(2)
    v_mfma_f32_32x32x16_bf16 v[48:63], v[240:243], v[16:19], v[48:63]
    ds_read_b128 v[28:31], v11 offset:32768
    v_mfma_f32_32x32x16_bf16 v[64:79], v[16:19], a[128:131], v[64:79]
    v_add_u32 v10, s56, v6
    s_waitcnt lgkmcnt(2)
    v_mfma_f32_32x32x16_bf16 v[48:63], v[244:247], v[20:23], v[48:63]
    ds_read_b128 v[16:19], v8 offset:0
    v_mfma_f32_32x32x16_bf16 v[64:79], v[20:23], a[132:135], v[64:79]
    v_add_u32 v11, s56, v7
    s_waitcnt lgkmcnt(2)
    v_mfma_f32_32x32x16_bf16 v[48:63], v[248:251], v[24:27], v[48:63]
    ds_read_b128 v[20:23], v9 offset:0
    v_mfma_f32_32x32x16_bf16 v[64:79], v[24:27], a[136:139], v[64:79]
    s_add_u32 s56, s56, 36864
    s_cmp_ge_u32 s56, 147456
    s_cselect_b32 s56, 0, s56
    s_add_u32 s57, s57, 1
    s_waitcnt lgkmcnt(2)
    v_mfma_f32_32x32x16_bf16 v[48:63], v[252:255], v[28:31], v[48:63]
    ds_read_b128 v[24:27], v10 offset:0
    v_mfma_f32_32x32x16_bf16 v[64:79], v[28:31], a[140:143], v[64:79]
L_a_loop_127:
    s_waitcnt lgkmcnt(2)
    v_mfma_f32_32x32x16_bf16 v[80:95], v[112:115], v[16:19], 0
    ds_read_b128 v[28:31], v11 offset:0
    s_mov_b32 s55, s97
    s_add_u32 s58, s97, 8192
    v_mfma_f32_32x32x16_bf16 v[96:111], v[16:19], a[0:3], 0
    s_waitcnt lgkmcnt(2)
    v_mfma_f32_32x32x16_bf16 v[80:95], v[116:119], v[20:23], v[80:95]
    ds_read_b128 v[16:19], v8 offset:4096
    v_cvt_pk_bf16_f32 v32, v48, v49
    v_cvt_pk_bf16_f32 v33, v50, v51
    v_cvt_pk_bf16_f32 v34, v52, v53
    v_cvt_pk_bf16_f32 v35, v54, v55
    v_mfma_f32_32x32x16_bf16 v[96:111], v[20:23], a[4:7], v[96:111]
    buffer_store_dwordx4 v[32:35], v12, s[28:31], s55 offen offset:0 sc1
    s_waitcnt lgkmcnt(2)
    v_mfma_f32_32x32x16_bf16 v[80:95], v[120:123], v[24:27], v[80:95]
    ds_read_b128 v[20:23], v9 offset:4096
    v_mfma_f32_32x32x16_bf16 v[96:111], v[24:27], a[8:11], v[96:111]
    s_waitcnt lgkmcnt(2)
    v_mfma_f32_32x32x16_bf16 v[80:95], v[124:127], v[28:31], v[80:95]
    ds_read_b128 v[24:27], v10 offset:4096
    v_cvt_pk_bf16_f32 v36, v56, v57
    v_cvt_pk_bf16_f32 v37, v58, v59
    v_cvt_pk_bf16_f32 v38, v60, v61
    v_cvt_pk_bf16_f32 v39, v62, v63
    v_mfma_f32_32x32x16_bf16 v[96:111], v[28:31], a[12:15], v[96:111]
    buffer_store_dwordx4 v[36:39], v12, s[28:31], s55 offen offset:1024 sc1
    s_waitcnt lgkmcnt(2)
    v_mfma_f32_32x32x16_bf16 v[80:95], v[128:131], v[16:19], v[80:95]
    ds_read_b128 v[28:31], v11 offset:4096
    v_mfma_f32_32x32x16_bf16 v[96:111], v[16:19], a[16:19], v[96:111]
    s_waitcnt lgkmcnt(2)
    v_mfma_f32_32x32x16_bf16 v[80:95], v[132:135], v[20:23], v[80:95]
    ds_read_b128 v[16:19], v8 offset:8192
    v_cvt_pk_bf16_f32 v40, v64, v65
    v_cvt_pk_bf16_f32 v41, v66, v67
    v_cvt_pk_bf16_f32 v42, v68, v69
    v_cvt_pk_bf16_f32 v43, v70, v71
    v_mfma_f32_32x32x16_bf16 v[96:111], v[20:23], a[20:23], v[96:111]
    buffer_store_dwordx4 v[40:43], v12, s[28:31], s58 offen offset:0 sc1
    s_waitcnt lgkmcnt(2)
    v_mfma_f32_32x32x16_bf16 v[80:95], v[136:139], v[24:27], v[80:95]
    ds_read_b128 v[20:23], v9 offset:8192
    v_mfma_f32_32x32x16_bf16 v[96:111], v[24:27], a[24:27], v[96:111]
    s_waitcnt lgkmcnt(2)
    v_mfma_f32_32x32x16_bf16 v[80:95], v[140:143], v[28:31], v[80:95]
    ds_read_b128 v[24:27], v10 offset:8192
    v_cvt_pk_bf16_f32 v44, v72, v73
    v_cvt_pk_bf16_f32 v45, v74, v75
    v_cvt_pk_bf16_f32 v46, v76, v77
    v_cvt_pk_bf16_f32 v47, v78, v79
    v_mfma_f32_32x32x16_bf16 v[96:111], v[28:31], a[28:31], v[96:111]
    buffer_store_dwordx4 v[44:47], v12, s[28:31], s58 offen offset:1024 sc1
    s_waitcnt lgkmcnt(2)
    v_mfma_f32_32x32x16_bf16 v[80:95], v[144:147], v[16:19], v[80:95]
    ds_read_b128 v[28:31], v11 offset:8192
    s_add_u32 s97, s97, 16384
    v_mfma_f32_32x32x16_bf16 v[96:111], v[16:19], a[32:35], v[96:111]
    s_barrier
    s_waitcnt lgkmcnt(2)
    v_mfma_f32_32x32x16_bf16 v[80:95], v[148:151], v[20:23], v[80:95]
    ds_read_b128 v[16:19], v8 offset:12288
    s_add_u32 m0, s59, 0
    s_add_u32 s54, s96, 0
    buffer_load_dwordx4 v3, s[8:11], s54 offen lds
    v_mfma_f32_32x32x16_bf16 v[96:111], v[20:23], a[36:39], v[96:111]
    s_waitcnt lgkmcnt(2)
    v_mfma_f32_32x32x16_bf16 v[80:95], v[152:155], v[24:27], v[80:95]
    ds_read_b128 v[20:23], v9 offset:12288
    v_mfma_f32_32x32x16_bf16 v[96:111], v[24:27], a[40:43], v[96:111]
    s_waitcnt lgkmcnt(2)
    v_mfma_f32_32x32x16_bf16 v[80:95], v[156:159], v[28:31], v[80:95]
    ds_read_b128 v[24:27], v10 offset:12288
    s_add_u32 m0, s59, 4096
    s_add_u32 s54, s96, 128
    buffer_load_dwordx4 v3, s[8:11], s54 offen lds
    v_mfma_f32_32x32x16_bf16 v[96:111], v[28:31], a[44:47], v[96:111]
    s_waitcnt lgkmcnt(2)
    v_mfma_f32_32x32x16_bf16 v[80:95], v[160:163], v[16:19], v[80:95]
    ds_read_b128 v[28:31], v11 offset:12288
    v_mfma_f32_32x32x16_bf16 v[96:111], v[16:19], a[48:51], v[96:111]
    s_waitcnt lgkmcnt(2)
    v_mfma_f32_32x32x16_bf16 v[80:95], v[164:167], v[20:23], v[80:95]
    ds_read_b128 v[16:19], v8 offset:16384
    s_add_u32 m0, s59, 8192
    s_add_u32 s54, s96, 256
    buffer_load_dwordx4 v3, s[8:11], s54 offen lds
    v_mfma_f32_32x32x16_bf16 v[96:111], v[20:23], a[52:55], v[96:111]
    s_waitcnt lgkmcnt(2)
    v_mfma_f32_32x32x16_bf16 v[80:95], v[168:171], v[24:27], v[80:95]
    ds_read_b128 v[20:23], v9 offset:16384
    v_mfma_f32_32x32x16_bf16 v[96:111], v[24:27], a[56:59], v[96:111]
    s_waitcnt lgkmcnt(2)
    v_mfma_f32_32x32x16_bf16 v[80:95], v[172:175], v[28:31], v[80:95]
    ds_read_b128 v[24:27], v10 offset:16384
    s_add_u32 m0, s59, 12288
    s_add_u32 s54, s96, 384
    buffer_load_dwordx4 v3, s[8:11], s54 offen lds
    v_mfma_f32_32x32x16_bf16 v[96:111], v[28:31], a[60:63], v[96:111]
    s_waitcnt lgkmcnt(2)
    v_mfma_f32_32x32x16_bf16 v[80:95], v[176:179], v[16:19], v[80:95]
    ds_read_b128 v[28:31], v11 offset:16384
    v_mfma_f32_32x32x16_bf16 v[96:111], v[16:19], a[64:67], v[96:111]
    s_waitcnt lgkmcnt(2)
    v_mfma_f32_32x32x16_bf16 v[80:95], v[180:183], v[20:23], v[80:95]
    ds_read_b128 v[16:19], v8 offset:20480
    s_add_u32 m0, s59, 16384
    s_add_u32 s54, s96, 512
    buffer_load_dwordx4 v3, s[8:11], s54 offen lds
    v_mfma_f32_32x32x16_bf16 v[96:111], v[20:23], a[68:71], v[96:111]
    s_waitcnt lgkmcnt(2)
    v_mfma_f32_32x32x16_bf16 v[80:95], v[184:187], v[24:27], v[80:95]
    ds_read_b128 v[20:23], v9 offset:20480
    v_mfma_f32_32x32x16_bf16 v[96:111], v[24:27], a[72:75], v[96:111]
    s_waitcnt lgkmcnt(2)
    v_mfma_f32_32x32x16_bf16 v[80:95], v[188:191], v[28:31], v[80:95]
    ds_read_b128 v[24:27], v10 offset:20480
    s_add_u32 m0, s59, 20480
    s_add_u32 s54, s96, 640
    buffer_load_dwordx4 v3, s[8:11], s54 offen lds
    v_mfma_f32_32x32x16_bf16 v[96:111], v[28:31], a[76:79], v[96:111]
    s_waitcnt lgkmcnt(2)
    v_mfma_f32_32x32x16_bf16 v[80:95], v[192:195], v[16:19], v[80:95]
    ds_read_b128 v[28:31], v11 offset:20480
    v_mfma_f32_32x32x16_bf16 v[96:111], v[16:19], a[80:83], v[96:111]
    s_waitcnt lgkmcnt(2)
    v_mfma_f32_32x32x16_bf16 v[80:95], v[196:199], v[20:23], v[80:95]
    ds_read_b128 v[16:19], v8 offset:24576
    s_add_u32 m0, s59, 24576
    s_add_u32 s54, s96, 768
    buffer_load_dwordx4 v3, s[8:11], s54 offen lds
    v_mfma_f32_32x32x16_bf16 v[96:111], v[20:23], a[84:87], v[96:111]
    s_waitcnt lgkmcnt(2)
    v_mfma_f32_32x32x16_bf16 v[80:95], v[200:203], v[24:27], v[80:95]
    ds_read_b128 v[20:23], v9 offset:24576
    v_mfma_f32_32x32x16_bf16 v[96:111], v[24:27], a[88:91], v[96:111]
    s_waitcnt lgkmcnt(2)
    v_mfma_f32_32x32x16_bf16 v[80:95], v[204:207], v[28:31], v[80:95]
    ds_read_b128 v[24:27], v10 offset:24576
    s_add_u32 m0, s59, 28672
    s_add_u32 s54, s96, 896
    buffer_load_dwordx4 v3, s[8:11], s54 offen lds
    v_mfma_f32_32x32x16_bf16 v[96:111], v[28:31], a[92:95], v[96:111]
    s_waitcnt lgkmcnt(2)
    v_mfma_f32_32x32x16_bf16 v[80:95], v[208:211], v[16:19], v[80:95]
    ds_read_b128 v[28:31], v11 offset:24576
    v_mfma_f32_32x32x16_bf16 v[96:111], v[16:19], a[96:99], v[96:111]
    s_waitcnt lgkmcnt(2)
    v_mfma_f32_32x32x16_bf16 v[80:95], v[212:215], v[20:23], v[80:95]
    ds_read_b128 v[16:19], v8 offset:28672
    s_add_u32 m0, s59, 32768
    s_add_u32 s54, s96, 1024
    buffer_load_dwordx4 v3, s[8:11], s54 offen lds
    v_mfma_f32_32x32x16_bf16 v[96:111], v[20:23], a[100:103], v[96:111]
    s_waitcnt lgkmcnt(2)
    v_mfma_f32_32x32x16_bf16 v[80:95], v[216:219], v[24:27], v[80:95]
    ds_read_b128 v[20:23], v9 offset:28672
    v_mfma_f32_32x32x16_bf16 v[96:111], v[24:27], a[104:107], v[96:111]
    s_waitcnt lgkmcnt(2)
    v_mfma_f32_32x32x16_bf16 v[80:95], v[220:223], v[28:31], v[80:95]
    ds_read_b128 v[24:27], v10 offset:28672
    s_add_u32 s96, s96, 36864
    s_add_u32 s59, s59, 36864
    s_cmp_ge_u32 s59, 147456
    s_cselect_b32 s54, 147456, 0
    s_sub_u32 s59, s59, s54
    v_mfma_f32_32x32x16_bf16 v[96:111], v[28:31], a[108:111], v[96:111]
    s_waitcnt lgkmcnt(2)
    v_mfma_f32_32x32x16_bf16 v[80:95], v[224:227], v[16:19], v[80:95]
    ds_read_b128 v[28:31], v11 offset:28672
    s_waitcnt vmcnt(9)
    v_mfma_f32_32x32x16_bf16 v[96:111], v[16:19], a[112:115], v[96:111]
    s_barrier
    s_waitcnt lgkmcnt(2)
    v_mfma_f32_32x32x16_bf16 v[80:95], v[228:231], v[20:23], v[80:95]
    ds_read_b128 v[16:19], v8 offset:32768
    v_mov_b32 v13, s98
    s_mov_b64 exec, s[94:95]
    buffer_store_dword v13, off, s[28:31], s6 sc1
    s_mov_b64 exec, -1
    s_add_u32 s98, s98, 1
    v_mfma_f32_32x32x16_bf16 v[96:111], v[20:23], a[116:119], v[96:111]
    s_waitcnt lgkmcnt(2)
    v_mfma_f32_32x32x16_bf16 v[80:95], v[232:235], v[24:27], v[80:95]
    ds_read_b128 v[20:23], v9 offset:32768
    v_mfma_f32_32x32x16_bf16 v[96:111], v[24:27], a[120:123], v[96:111]
    v_add_u32 v8, s56, v4
    s_waitcnt lgkmcnt(2)
    v_mfma_f32_32x32x16_bf16 v[80:95], v[236:239], v[28:31], v[80:95]
    ds_read_b128 v[24:27], v10 offset:32768
    v_mfma_f32_32x32x16_bf16 v[96:111], v[28:31], a[124:127], v[96:111]
    v_add_u32 v9, s56, v5
    s_waitcnt lgkmcnt(2)
    v_mfma_f32_32x32x16_bf16 v[80:95], v[240:243], v[16:19], v[80:95]
    ds_read_b128 v[28:31], v11 offset:32768
    v_mfma_f32_32x32x16_bf16 v[96:111], v[16:19], a[128:131], v[96:111]
    v_add_u32 v10, s56, v6
    s_waitcnt lgkmcnt(2)
    v_mfma_f32_32x32x16_bf16 v[80:95], v[244:247], v[20:23], v[80:95]
    ds_read_b128 v[16:19], v8 offset:0
    v_mfma_f32_32x32x16_bf16 v[96:111], v[20:23], a[132:135], v[96:111]
    v_add_u32 v11, s56, v7
    s_waitcnt lgkmcnt(2)
    v_mfma_f32_32x32x16_bf16 v[80:95], v[248:251], v[24:27], v[80:95]
    ds_read_b128 v[20:23], v9 offset:0
    v_mfma_f32_32x32x16_bf16 v[96:111], v[24:27], a[136:139], v[96:111]
    s_add_u32 s56, s56, 36864
    s_cmp_ge_u32 s56, 147456
    s_cselect_b32 s56, 0, s56
    s_add_u32 s57, s57, 1
    s_waitcnt lgkmcnt(2)
    v_mfma_f32_32x32x16_bf16 v[80:95], v[252:255], v[28:31], v[80:95]
    ds_read_b128 v[24:27], v10 offset:0
    v_mfma_f32_32x32x16_bf16 v[96:111], v[28:31], a[140:143], v[96:111]
    s_cmp_ge_u32 s57, 64
    s_cbranch_scc1 L_a_end1_129
    s_waitcnt lgkmcnt(2)
    v_mfma_f32_32x32x16_bf16 v[48:63], v[112:115], v[16:19], 0
    ds_read_b128 v[28:31], v11 offset:0
    s_mov_b32 s55, s97
    s_add_u32 s58, s97, 8192
    v_mfma_f32_32x32x16_bf16 v[64:79], v[16:19], a[0:3], 0
    s_waitcnt lgkmcnt(2)
    v_mfma_f32_32x32x16_bf16 v[48:63], v[116:119], v[20:23], v[48:63]
    ds_read_b128 v[16:19], v8 offset:4096
    v_cvt_pk_bf16_f32 v32, v80, v81
    v_cvt_pk_bf16_f32 v33, v82, v83
    v_cvt_pk_bf16_f32 v34, v84, v85
    v_cvt_pk_bf16_f32 v35, v86, v87
    v_mfma_f32_32x32x16_bf16 v[64:79], v[20:23], a[4:7], v[64:79]
    buffer_store_dwordx4 v[32:35], v12, s[28:31], s55 offen offset:0 sc1
    s_waitcnt lgkmcnt(2)
    v_mfma_f32_32x32x16_bf16 v[48:63], v[120:123], v[24:27], v[48:63]
    ds_read_b128 v[20:23], v9 offset:4096
    v_mfma_f32_32x32x16_bf16 v[64:79], v[24:27], a[8:11], v[64:79]
    s_waitcnt lgkmcnt(2)
    v_mfma_f32_32x32x16_bf16 v[48:63], v[124:127], v[28:31], v[48:63]
    ds_read_b128 v[24:27], v10 offset:4096
    v_cvt_pk_bf16_f32 v36, v88, v89
    v_cvt_pk_bf16_f32 v37, v90, v91
    v_cvt_pk_bf16_f32 v38, v92, v93
    v_cvt_pk_bf16_f32 v39, v94, v95
    v_mfma_f32_32x32x16_bf16 v[64:79], v[28:31], a[12:15], v[64:79]
    buffer_store_dwordx4 v[36:39], v12, s[28:31], s55 offen offset:1024 sc1
    s_waitcnt lgkmcnt(2)
    v_mfma_f32_32x32x16_bf16 v[48:63], v[128:131], v[16:19], v[48:63]
    ds_read_b128 v[28:31], v11 offset:4096
    v_mfma_f32_32x32x16_bf16 v[64:79], v[16:19], a[16:19], v[64:79]
    s_waitcnt lgkmcnt(2)
    v_mfma_f32_32x32x16_bf16 v[48:63], v[132:135], v[20:23], v[48:63]
    ds_read_b128 v[16:19], v8 offset:8192
    v_cvt_pk_bf16_f32 v40, v96, v97
    v_cvt_pk_bf16_f32 v41, v98, v99
    v_cvt_pk_bf16_f32 v42, v100, v101
    v_cvt_pk_bf16_f32 v43, v102, v103
    v_mfma_f32_32x32x16_bf16 v[64:79], v[20:23], a[20:23], v[64:79]
    buffer_store_dwordx4 v[40:43], v12, s[28:31], s58 offen offset:0 sc1
    s_waitcnt lgkmcnt(2)
    v_mfma_f32_32x32x16_bf16 v[48:63], v[136:139], v[24:27], v[48:63]
    ds_read_b128 v[20:23], v9 offset:8192
    v_mfma_f32_32x32x16_bf16 v[64:79], v[24:27], a[24:27], v[64:79]
    s_waitcnt lgkmcnt(2)
    v_mfma_f32_32x32x16_bf16 v[48:63], v[140:143], v[28:31], v[48:63]
    ds_read_b128 v[24:27], v10 offset:8192
    v_cvt_pk_bf16_f32 v44, v104, v105
    v_cvt_pk_bf16_f32 v45, v106, v107
    v_cvt_pk_bf16_f32 v46, v108, v109
    v_cvt_pk_bf16_f32 v47, v110, v111
    v_mfma_f32_32x32x16_bf16 v[64:79], v[28:31], a[28:31], v[64:79]
    buffer_store_dwordx4 v[44:47], v12, s[28:31], s58 offen offset:1024 sc1
    s_waitcnt lgkmcnt(2)
    v_mfma_f32_32x32x16_bf16 v[48:63], v[144:147], v[16:19], v[48:63]
    ds_read_b128 v[28:31], v11 offset:8192
    s_add_u32 s97, s97, 16384
    v_mfma_f32_32x32x16_bf16 v[64:79], v[16:19], a[32:35], v[64:79]
    s_barrier
    s_waitcnt lgkmcnt(2)
    v_mfma_f32_32x32x16_bf16 v[48:63], v[148:151], v[20:23], v[48:63]
    ds_read_b128 v[16:19], v8 offset:12288
    s_add_u32 m0, s59, 0
    s_add_u32 s54, s96, 0
    buffer_load_dwordx4 v3, s[8:11], s54 offen lds
    v_mfma_f32_32x32x16_bf16 v[64:79], v[20:23], a[36:39], v[64:79]
    s_waitcnt lgkmcnt(2)
    v_mfma_f32_32x32x16_bf16 v[48:63], v[152:155], v[24:27], v[48:63]
    ds_read_b128 v[20:23], v9 offset:12288
    v_mfma_f32_32x32x16_bf16 v[64:79], v[24:27], a[40:43], v[64:79]
    s_waitcnt lgkmcnt(2)
    v_mfma_f32_32x32x16_bf16 v[48:63], v[156:159], v[28:31], v[48:63]
    ds_read_b128 v[24:27], v10 offset:12288
    s_add_u32 m0, s59, 4096
    s_add_u32 s54, s96, 128
    buffer_load_dwordx4 v3, s[8:11], s54 offen lds
    v_mfma_f32_32x32x16_bf16 v[64:79], v[28:31], a[44:47], v[64:79]
    s_waitcnt lgkmcnt(2)
    v_mfma_f32_32x32x16_bf16 v[48:63], v[160:163], v[16:19], v[48:63]
    ds_read_b128 v[28:31], v11 offset:12288
    v_mfma_f32_32x32x16_bf16 v[64:79], v[16:19], a[48:51], v[64:79]
    s_waitcnt lgkmcnt(2)
    v_mfma_f32_32x32x16_bf16 v[48:63], v[164:167], v[20:23], v[48:63]
    ds_read_b128 v[16:19], v8 offset:16384
    s_add_u32 m0, s59, 8192
    s_add_u32 s54, s96, 256
    buffer_load_dwordx4 v3, s[8:11], s54 offen lds
    v_mfma_f32_32x32x16_bf16 v[64:79], v[20:23], a[52:55], v[64:79]
    s_waitcnt lgkmcnt(2)
    v_mfma_f32_32x32x16_bf16 v[48:63], v[168:171], v[24:27], v[48:63]
    ds_read_b128 v[20:23], v9 offset:16384
    v_mfma_f32_32x32x16_bf16 v[64:79], v[24:27], a[56:59], v[64:79]
    s_waitcnt lgkmcnt(2)
    v_mfma_f32_32x32x16_bf16 v[48:63], v[172:175], v[28:31], v[48:63]
    ds_read_b128 v[24:27], v10 offset:16384
    s_add_u32 m0, s59, 12288
    s_add_u32 s54, s96, 384
    buffer_load_dwordx4 v3, s[8:11], s54 offen lds
    v_mfma_f32_32x32x16_bf16 v[64:79], v[28:31], a[60:63], v[64:79]
    s_waitcnt lgkmcnt(2)
    v_mfma_f32_32x32x16_bf16 v[48:63], v[176:179], v[16:19], v[48:63]
    ds_read_b128 v[28:31], v11 offset:16384
    v_mfma_f32_32x32x16_bf16 v[64:79], v[16:19], a[64:67], v[64:79]
    s_waitcnt lgkmcnt(2)
    v_mfma_f32_32x32x16_bf16 v[48:63], v[180:183], v[20:23], v[48:63]
    ds_read_b128 v[16:19], v8 offset:20480
    s_add_u32 m0, s59, 16384
    s_add_u32 s54, s96, 512
    buffer_load_dwordx4 v3, s[8:11], s54 offen lds
    v_mfma_f32_32x32x16_bf16 v[64:79], v[20:23], a[68:71], v[64:79]
    s_waitcnt lgkmcnt(2)
    v_mfma_f32_32x32x16_bf16 v[48:63], v[184:187], v[24:27], v[48:63]
    ds_read_b128 v[20:23], v9 offset:20480
    v_mfma_f32_32x32x16_bf16 v[64:79], v[24:27], a[72:75], v[64:79]
    s_waitcnt lgkmcnt(2)
    v_mfma_f32_32x32x16_bf16 v[48:63], v[188:191], v[28:31], v[48:63]
    ds_read_b128 v[24:27], v10 offset:20480
    s_add_u32 m0, s59, 20480
    s_add_u32 s54, s96, 640
    buffer_load_dwordx4 v3, s[8:11], s54 offen lds
    v_mfma_f32_32x32x16_bf16 v[64:79], v[28:31], a[76:79], v[64:79]
    s_waitcnt lgkmcnt(2)
    v_mfma_f32_32x32x16_bf16 v[48:63], v[192:195], v[16:19], v[48:63]
    ds_read_b128 v[28:31], v11 offset:20480
    v_mfma_f32_32x32x16_bf16 v[64:79], v[16:19], a[80:83], v[64:79]
    s_waitcnt lgkmcnt(2)
    v_mfma_f32_32x32x16_bf16 v[48:63], v[196:199], v[20:23], v[48:63]
    ds_read_b128 v[16:19], v8 offset:24576
    s_add_u32 m0, s59, 24576
    s_add_u32 s54, s96, 768
    buffer_load_dwordx4 v3, s[8:11], s54 offen lds
    v_mfma_f32_32x32x16_bf16 v[64:79], v[20:23], a[84:87], v[64:79]
    s_waitcnt lgkmcnt(2)
    v_mfma_f32_32x32x16_bf16 v[48:63], v[200:203], v[24:27], v[48:63]
    ds_read_b128 v[20:23], v9 offset:24576
    v_mfma_f32_32x32x16_bf16 v[64:79], v[24:27], a[88:91], v[64:79]
    s_waitcnt lgkmcnt(2)
    v_mfma_f32_32x32x16_bf16 v[48:63], v[204:207], v[28:31], v[48:63]
    ds_read_b128 v[24:27], v10 offset:24576
    s_add_u32 m0, s59, 28672
    s_add_u32 s54, s96, 896
    buffer_load_dwordx4 v3, s[8:11], s54 offen lds
    v_mfma_f32_32x32x16_bf16 v[64:79], v[28:31], a[92:95], v[64:79]
    s_waitcnt lgkmcnt(2)
    v_mfma_f32_32x32x16_bf16 v[48:63], v[208:211], v[16:19], v[48:63]
    ds_read_b128 v[28:31], v11 offset:24576
    v_mfma_f32_32x32x16_bf16 v[64:79], v[16:19], a[96:99], v[64:79]
    s_waitcnt lgkmcnt(2)
    v_mfma_f32_32x32x16_bf16 v[48:63], v[212:215], v[20:23], v[48:63]
    ds_read_b128 v[16:19], v8 offset:28672
    s_add_u32 m0, s59, 32768
    s_add_u32 s54, s96, 1024
    buffer_load_dwordx4 v3, s[8:11], s54 offen lds
    v_mfma_f32_32x32x16_bf16 v[64:79], v[20:23], a[100:103], v[64:79]
    s_waitcnt lgkmcnt(2)
    v_mfma_f32_32x32x16_bf16 v[48:63], v[216:219], v[24:27], v[48:63]
    ds_read_b128 v[20:23], v9 offset:28672
    v_mfma_f32_32x32x16_bf16 v[64:79], v[24:27], a[104:107], v[64:79]
    s_waitcnt lgkmcnt(2)
    v_mfma_f32_32x32x16_bf16 v[48:63], v[220:223], v[28:31], v[48:63]
    ds_read_b128 v[24:27], v10 offset:28672
    s_add_u32 s96, s96, 36864
    s_add_u32 s59, s59, 36864
    s_cmp_ge_u32 s59, 147456
    s_cselect_b32 s54, 147456, 0
    s_sub_u32 s59, s59, s54
    v_mfma_f32_32x32x16_bf16 v[64:79], v[28:31], a[108:111], v[64:79]
    s_waitcnt lgkmcnt(2)
    v_mfma_f32_32x32x16_bf16 v[48:63], v[224:227], v[16:19], v[48:63]
    ds_read_b128 v[28:31], v11 offset:28672
    s_waitcnt vmcnt(9)
    v_mfma_f32_32x32x16_bf16 v[64:79], v[16:19], a[112:115], v[64:79]
    s_barrier
    s_waitcnt lgkmcnt(2)
    v_mfma_f32_32x32x16_bf16 v[48:63], v[228:231], v[20:23], v[48:63]
    ds_read_b128 v[16:19], v8 offset:32768
    v_mov_b32 v13, s98
    s_mov_b64 exec, s[94:95]
    buffer_store_dword v13, off, s[28:31], s6 sc1
    s_mov_b64 exec, -1
    s_add_u32 s98, s98, 1
    v_mfma_f32_32x32x16_bf16 v[64:79], v[20:23], a[116:119], v[64:79]
    s_waitcnt lgkmcnt(2)
    v_mfma_f32_32x32x16_bf16 v[48:63], v[232:235], v[24:27], v[48:63]
    ds_read_b128 v[20:23], v9 offset:32768
    v_mfma_f32_32x32x16_bf16 v[64:79], v[24:27], a[120:123], v[64:79]
    v_add_u32 v8, s56, v4
    s_waitcnt lgkmcnt(2)
    v_mfma_f32_32x32x16_bf16 v[48:63], v[236:239], v[28:31], v[48:63]
    ds_read_b128 v[24:27], v10 offset:32768
    v_mfma_f32_32x32x16_bf16 v[64:79], v[28:31], a[124:127], v[64:79]
    v_add_u32 v9, s56, v5
    s_waitcnt lgkmcnt(2)
    v_mfma_f32_32x32x16_bf16 v[48:63], v[240:243], v[16:19], v[48:63]
    ds_read_b128 v[28:31], v11 offset:32768
    v_mfma_f32_32x32x16_bf16 v[64:79], v[16:19], a[128:131], v[64:79]
    v_add_u32 v10, s56, v6
    s_waitcnt lgkmcnt(2)
    v_mfma_f32_32x32x16_bf16 v[48:63], v[244:247], v[20:23], v[48:63]
    ds_read_b128 v[16:19], v8 offset:0
    v_mfma_f32_32x32x16_bf16 v[64:79], v[20:23], a[132:135], v[64:79]
    v_add_u32 v11, s56, v7
    s_waitcnt lgkmcnt(2)
    v_mfma_f32_32x32x16_bf16 v[48:63], v[248:251], v[24:27], v[48:63]
    ds_read_b128 v[20:23], v9 offset:0
    v_mfma_f32_32x32x16_bf16 v[64:79], v[24:27], a[136:139], v[64:79]
    s_add_u32 s56, s56, 36864
    s_cmp_ge_u32 s56, 147456
    s_cselect_b32 s56, 0, s56
    s_add_u32 s57, s57, 1
    s_waitcnt lgkmcnt(2)
    v_mfma_f32_32x32x16_bf16 v[48:63], v[252:255], v[28:31], v[48:63]
    ds_read_b128 v[24:27], v10 offset:0
    v_mfma_f32_32x32x16_bf16 v[64:79], v[28:31], a[140:143], v[64:79]
    s_cmp_lt_u32 s57, 64
    s_cbranch_scc1 L_a_loop_127
L_a_end0_128:
    s_mov_b32 s55, s97
    s_add_u32 s58, s97, 8192
    s_nop 15
    v_cvt_pk_bf16_f32 v32, v48, v49
    v_cvt_pk_bf16_f32 v33, v50, v51
    v_cvt_pk_bf16_f32 v34, v52, v53
    v_cvt_pk_bf16_f32 v35, v54, v55
    buffer_store_dwordx4 v[32:35], v12, s[28:31], s55 offen offset:0 sc1
    v_cvt_pk_bf16_f32 v36, v56, v57
    v_cvt_pk_bf16_f32 v37, v58, v59
    v_cvt_pk_bf16_f32 v38, v60, v61
    v_cvt_pk_bf16_f32 v39, v62, v63
    buffer_store_dwordx4 v[36:39], v12, s[28:31], s55 offen offset:1024 sc1
    v_cvt_pk_bf16_f32 v40, v64, v65
    v_cvt_pk_bf16_f32 v41, v66, v67
    v_cvt_pk_bf16_f32 v42, v68, v69
    v_cvt_pk_bf16_f32 v43, v70, v71
    buffer_store_dwordx4 v[40:43], v12, s[28:31], s58 offen offset:0 sc1
    v_cvt_pk_bf16_f32 v44, v72, v73
    v_cvt_pk_bf16_f32 v45, v74, v75
    v_cvt_pk_bf16_f32 v46, v76, v77
    v_cvt_pk_bf16_f32 v47, v78, v79
    buffer_store_dwordx4 v[44:47], v12, s[28:31], s58 offen offset:1024 sc1
    s_branch L_a_done_130
L_a_end1_129:
    s_mov_b32 s55, s97
    s_add_u32 s58, s97, 8192
    s_nop 15
    v_cvt_pk_bf16_f32 v32, v80, v81
    v_cvt_pk_bf16_f32 v33, v82, v83
    v_cvt_pk_bf16_f32 v34, v84, v85
    v_cvt_pk_bf16_f32 v35, v86, v87
    buffer_store_dwordx4 v[32:35], v12, s[28:31], s55 offen offset:0 sc1
    v_cvt_pk_bf16_f32 v36, v88, v89
    v_cvt_pk_bf16_f32 v37, v90, v91
    v_cvt_pk_bf16_f32 v38, v92, v93
    v_cvt_pk_bf16_f32 v39, v94, v95
    buffer_store_dwordx4 v[36:39], v12, s[28:31], s55 offen offset:1024 sc1
    v_cvt_pk_bf16_f32 v40, v96, v97
    v_cvt_pk_bf16_f32 v41, v98, v99
    v_cvt_pk_bf16_f32 v42, v100, v101
    v_cvt_pk_bf16_f32 v43, v102, v103
    buffer_store_dwordx4 v[40:43], v12, s[28:31], s58 offen offset:0 sc1
    v_cvt_pk_bf16_f32 v44, v104, v105
    v_cvt_pk_bf16_f32 v45, v106, v107
    v_cvt_pk_bf16_f32 v46, v108, v109
    v_cvt_pk_bf16_f32 v47, v110, v111
    buffer_store_dwordx4 v[44:47], v12, s[28:31], s58 offen offset:1024 sc1
L_a_done_130:
    s_waitcnt vmcnt(0) lgkmcnt(0)
    s_barrier
    v_mov_b32 v13, s98
    s_mov_b64 exec, s[94:95]
    buffer_store_dword v13, off, s[28:31], s6 sc1
    s_mov_b64 exec, -1
    s_add_u32 s98, s98, 1
    s_cmp_ge_u32 s47, 48
    s_cbranch_scc1 L_exit
    s_mul_hi_u32 s52, s47, 0x2aaaaaab
    s_mul_i32 s53, s52, 6
    s_sub_u32 s47, s47, s53
    s_and_b32 s48, s52, 1
    s_add_u32 s48, s48, 50
    s_lshr_b32 s46, s52, 1
    s_branch L_op_go
L_attn:
    s_cmp_lg_u32 s51, 0
    s_cbranch_scc1 L_hold_ok_132
L_wi_133:
    s_sleep 127
    s_load_dword s54, s[44:45], 144 glc
    s_waitcnt lgkmcnt(0)
    s_cmp_ge_u32 s54, 192
    s_cbranch_scc1 L_wi_ok_134
    s_sub_u32 s99, s99, 1
    s_cmp_lg_u32 s99, 0
    s_cbranch_scc1 L_wi_133
    s_branch L_exit
L_wi_ok_134:
L_sw_135:
    s_buffer_load_dword s54, s[28:31], s6 glc
    s_waitcnt lgkmcnt(0)
    s_cmp_ge_u32 s54, 5
    s_cbranch_scc1 L_sw_ok_136
    s_sleep 32
    s_sub_u32 s99, s99, 1
    s_cmp_lg_u32 s99, 0
    s_cbranch_scc1 L_sw_135
    s_branch L_exit
L_sw_ok_136:
L_hold_ok_132:
    s_barrier
    s_lshl_b32 s52, s50, 8
    s_lshl_b32 s54, s51, 6
    s_add_u32 s52, s52, s54
    s_mul_i32 s53, s51, 36864
    s_add_u32 m0, s53, 0
    s_add_u32 s54, s52, 0
    buffer_load_dwordx4 v1, s[12:15], s54 offen lds
    s_add_u32 m0, s53, 1024
    s_add_u32 s54, s52, 131072
    buffer_load_dwordx4 v1, s[12:15], s54 offen lds
    s_add_u32 m0, s53, 2048
    s_add_u32 s54, s52, 262144
    buffer_load_dwordx4 v1, s[12:15], s54 offen lds
    s_add_u32 m0, s53, 3072
    s_add_u32 s54, s52, 393216
    buffer_load_dwordx4 v1, s[12:15], s54 offen lds
    s_add_u32 m0, s53, 4096
    s_add_u32 s54, s52, 524288
    buffer_load_dwordx4 v1, s[12:15], s54 offen lds
    s_add_u32 m0, s53, 5120
    s_add_u32 s54, s52, 655360
    buffer_load_dwordx4 v1, s[12:15], s54 offen lds
    s_add_u32 m0, s53, 6144
    s_add_u32 s54, s52, 786432
    buffer_load_dwordx4 v1, s[12:15], s54 offen lds
    s_add_u32 m0, s53, 7168
    s_add_u32 s54, s52, 917504
    buffer_load_dwordx4 v1, s[12:15], s54 offen lds
    s_add_u32 m0, s53, 8192
    s_add_u32 s54, s52, 1048576
    buffer_load_dwordx4 v1, s[12:15], s54 offen lds
    s_add_u32 m0, s53, 9216
    s_add_u32 s54, s52, 1179648
    buffer_load_dwordx4 v1, s[12:15], s54 offen lds
    s_add_u32 m0, s53, 10240
    s_add_u32 s54, s52, 1310720
    buffer_load_dwordx4 v1, s[12:15], s54 offen lds
    s_add_u32 m0, s53, 11264
    s_add_u32 s54, s52, 1441792
    buffer_load_dwordx4 v1, s[12:15], s54 offen lds
    s_add_u32 m0, s53, 12288
    s_add_u32 s54, s52, 1572864
    buffer_load_dwordx4 v1, s[12:15], s54 offen lds
    s_add_u32 m0, s53, 13312
    s_add_u32 s54, s52, 1703936
    buffer_load_dwordx4 v1, s[12:15], s54 offen lds
    s_add_u32 m0, s53, 14336
    s_add_u32 s54, s52, 1835008
    buffer_load_dwordx4 v1, s[12:15], s54 offen lds
    s_add_u32 m0, s53, 15360
    s_add_u32 s54, s52, 1966080
    buffer_load_dwordx4 v1, s[12:15], s54 offen lds
    s_add_u32 m0, s53, 16384
    s_add_u32 s54, s52, 2097152
    buffer_load_dwordx4 v1, s[12:15], s54 offen lds
    s_add_u32 m0, s53, 17408
    s_add_u32 s54, s52, 2228224
    buffer_load_dwordx4 v1, s[12:15], s54 offen lds
    s_add_u32 m0, s53, 18432
    s_add_u32 s54, s52, 2359296
    buffer_load_dwordx4 v1, s[12:15], s54 offen lds
    s_add_u32 m0, s53, 19456
    s_add_u32 s54, s52, 2490368
    buffer_load_dwordx4 v1, s[12:15], s54 offen lds
    s_add_u32 m0, s53, 20480
    s_add_u32 s54, s52, 2621440
    buffer_load_dwordx4 v1, s[12:15], s54 offen lds
    s_add_u32 m0, s53, 21504
    s_add_u32 s54, s52, 2752512
    buffer_load_dwordx4 v1, s[12:15], s54 offen lds
    s_add_u32 m0, s53, 22528
    s_add_u32 s54, s52, 2883584
    buffer_load_dwordx4 v1, s[12:15], s54 offen lds
    s_add_u32 m0, s53, 23552
    s_add_u32 s54, s52, 3014656
    buffer_load_dwordx4 v1, s[12:15], s54 offen lds
    s_add_u32 m0, s53, 24576
    s_add_u32 s54, s52, 3145728
    buffer_load_dwordx4 v1, s[12:15], s54 offen lds
    s_add_u32 m0, s53, 25600
    s_add_u32 s54, s52, 3276800
    buffer_load_dwordx4 v1, s[12:15], s54 offen lds
    s_add_u32 m0, s53, 26624
    s_add_u32 s54, s52, 3407872
    buffer_load_dwordx4 v1, s[12:15], s54 offen lds
    s_add_u32 m0, s53, 27648
    s_add_u32 s54, s52, 3538944
    buffer_load_dwordx4 v1, s[12:15], s54 offen lds
    s_add_u32 m0, s53, 28672
    s_add_u32 s54, s52, 3670016
    buffer_load_dwordx4 v1, s[12:15], s54 offen lds
    s_add_u32 m0, s53, 29696
    s_add_u32 s54, s52, 3801088
    buffer_load_dwordx4 v1, s[12:15], s54 offen lds
    s_add_u32 m0, s53, 30720
    s_add_u32 s54, s52, 3932160
    buffer_load_dwordx4 v1, s[12:15], s54 offen lds
    s_add_u32 m0, s53, 31744
    s_add_u32 s54, s52, 4063232
    buffer_load_dwordx4 v1, s[12:15], s54 offen lds
    s_add_u32 m0, s53, 32768
    s_add_u32 s54, s52, 4194304
    buffer_load_dwordx4 v1, s[12:15], s54 offen lds
    s_add_u32 m0, s53, 33792
    s_add_u32 s54, s52, 4325376
    buffer_load_dwordx4 v1, s[12:15], s54 offen lds
    s_add_u32 m0, s53, 34816
    s_add_u32 s54, s52, 4456448
    buffer_load_dwordx4 v1, s[12:15], s54 offen lds
    s_add_u32 m0, s53, 35840
    s_add_u32 s54, s52, 4587520
    buffer_load_dwordx4 v1, s[12:15], s54 offen lds
    s_waitcnt vmcnt(32)
    ds_read_b64_tr_b16 a[0:1], v2 offset:0
    ds_read_b64_tr_b16 a[2:3], v2 offset:256
    ds_read_b64_tr_b16 a[4:5], v2 offset:1024
    ds_read_b64_tr_b16 a[6:7], v2 offset:1280
    ds_read_b64_tr_b16 a[8:9], v2 offset:2048
    ds_read_b64_tr_b16 a[10:11], v2 offset:2304
    ds_read_b64_tr_b16 a[12:13], v2 offset:3072
    ds_read_b64_tr_b16 a[14:15], v2 offset:3328
    s_waitcnt vmcnt(28)
    ds_read_b64_tr_b16 a[16:17], v2 offset:4096
    ds_read_b64_tr_b16 a[18:19], v2 offset:4352
    ds_read_b64_tr_b16 a[20:21], v2 offset:5120
    ds_read_b64_tr_b16 a[22:23], v2 offset:5376
    ds_read_b64_tr_b16 a[24:25], v2 offset:6144
    ds_read_b64_tr_b16 a[26:27], v2 offset:6400
    ds_read_b64_tr_b16 a[28:29], v2 offset:7168
    ds_read_b64_tr_b16 a[30:31], v2 offset:7424
    s_waitcnt vmcnt(24)
    ds_read_b64_tr_b16 a[32:33], v2 offset:8192
    ds_read_b64_tr_b16 a[34:35], v2 offset:8448
    ds_read_b64_tr_b16 a[36:37], v2 offset:9216
    ds_read_b64_tr_b16 a[38:39], v2 offset:9472
    ds_read_b64_tr_b16 a[40:41], v2 offset:10240
    ds_read_b64_tr_b16 a[42:43], v2 offset:10496
    ds_read_b64_tr_b16 a[44:45], v2 offset:11264
    ds_read_b64_tr_b16 a[46:47], v2 offset:11520
    s_waitcnt vmcnt(20)
    ds_read_b64_tr_b16 a[48:49], v2 offset:12288
    ds_read_b64_tr_b16 a[50:51], v2 offset:12544
    ds_read_b64_tr_b16 a[52:53], v2 offset:13312
    ds_read_b64_tr_b16 a[54:55], v2 offset:13568
    ds_read_b64_tr_b16 a[56:57], v2 offset:14336
    ds_read_b64_tr_b16 a[58:59], v2 offset:14592
    ds_read_b64_tr_b16 a[60:61], v2 offset:15360
    ds_read_b64_tr_b16 a[62:63], v2 offset:15616
    s_waitcnt vmcnt(16)
    ds_read_b64_tr_b16 a[64:65], v2 offset:16384
    ds_read_b64_tr_b16 a[66:67], v2 offset:16640
    ds_read_b64_tr_b16 a[68:69], v2 offset:17408
    ds_read_b64_tr_b16 a[70:71], v2 offset:17664
    ds_read_b64_tr_b16 a[72:73], v2 offset:18432
    ds_read_b64_tr_b16 a[74:75], v2 offset:18688
    ds_read_b64_tr_b16 a[76:77], v2 offset:19456
    ds_read_b64_tr_b16 a[78:79], v2 offset:19712
    s_waitcnt vmcnt(12)
    ds_read_b64_tr_b16 a[80:81], v2 offset:20480
    ds_read_b64_tr_b16 a[82:83], v2 offset:20736
    ds_read_b64_tr_b16 a[84:85], v2 offset:21504
    ds_read_b64_tr_b16 a[86:87], v2 offset:21760
    ds_read_b64_tr_b16 a[88:89], v2 offset:22528
    ds_read_b64_tr_b16 a[90:91], v2 offset:22784
    ds_read_b64_tr_b16 a[92:93], v2 offset:23552
    ds_read_b64_tr_b16 a[94:95], v2 offset:23808
    s_waitcnt vmcnt(8)
    ds_read_b64_tr_b16 a[96:97], v2 offset:24576
    ds_read_b64_tr_b16 a[98:99], v2 offset:24832
    ds_read_b64_tr_b16 a[100:101], v2 offset:25600
    ds_read_b64_tr_b16 a[102:103], v2 offset:25856
    ds_read_b64_tr_b16 a[104:105], v2 offset:26624
    ds_read_b64_tr_b16 a[106:107], v2 offset:26880
    ds_read_b64_tr_b16 a[108:109], v2 offset:27648
    ds_read_b64_tr_b16 a[110:111], v2 offset:27904
    s_waitcnt vmcnt(4)
    ds_read_b64_tr_b16 a[112:113], v2 offset:28672
    ds_read_b64_tr_b16 a[114:115], v2 offset:28928
    ds_read_b64_tr_b16 a[116:117], v2 offset:29696
    ds_read_b64_tr_b16 a[118:119], v2 offset:29952
    ds_read_b64_tr_b16 a[120:121], v2 offset:30720
    ds_read_b64_tr_b16 a[122:123], v2 offset:30976
    ds_read_b64_tr_b16 a[124:125], v2 offset:31744
    ds_read_b64_tr_b16 a[126:127], v2 offset:32000
    s_waitcnt vmcnt(0)
    ds_read_b64_tr_b16 a[128:129], v2 offset:32768
    ds_read_b64_tr_b16 a[130:131], v2 offset:33024
    ds_read_b64_tr_b16 a[132:133], v2 offset:33792
    ds_read_b64_tr_b16 a[134:135], v2 offset:34048
    ds_read_b64_tr_b16 a[136:137], v2 offset:34816
    ds_read_b64_tr_b16 a[138:139], v2 offset:35072
    ds_read_b64_tr_b16 a[140:141], v2 offset:35840
    ds_read_b64_tr_b16 a[142:143], v2 offset:36096
    s_waitcnt lgkmcnt(0)
    s_barrier
    s_mov_b32 s100, 0x3e0293ee
    s_mov_b32 s101, 0xd028965f
    v_and_b32 v32, 31, v0
    v_lshrrev_b32 v33, 5, v0
    v_lshlrev_b32 v34, 2, v33
    v_sub_u32 v34, v32, v34
    v_cmp_le_i32 s[60:61], 0, v34
    v_cmp_le_i32 s[62:63], 1, v34
    v_cmp_le_i32 s[64:65], 2, v34
    v_cmp_le_i32 s[66:67], 3, v34
    v_cmp_le_i32 s[68:69], 8, v34
    v_cmp_le_i32 s[70:71], 9, v34
    v_cmp_le_i32 s[72:73], 10, v34
    v_cmp_le_i32 s[74:75], 11, v34
    v_cmp_le_i32 s[76:77], 16, v34
    v_cmp_le_i32 s[78:79], 17, v34
    v_cmp_le_i32 s[80:81], 18, v34
    v_cmp_le_i32 s[82:83], 19, v34
    v_cmp_le_i32 s[84:85], 24, v34
    v_cmp_le_i32 s[86:87], 25, v34
    v_cmp_le_i32 s[88:89], 26, v34
    v_cmp_le_i32 s[90:91], 27, v34
    v_and_b32 v34, 7, v0
    v_lshlrev_b32 v13, 4, v34
    v_lshl_add_u32 v13, v33, 7, v13
    v_and_b32 v34, 15, v0
    v_lshlrev_b32 v14, 3, v34
    v_lshl_add_u32 v14, v33, 8, v14
    v_bfe_u32 v34, v0, 4, 1
    v_lshl_add_u32 v14, v34, 2, v14
    v_lshlrev_b32 v1, 2, v32
    s_lshl_b32 s52, s51, 11
    s_add_u32 s52, s52, 110592
    v_add_u32 v2, s52, v12
    s_mov_b32 s92, 0
    s_mul_i32 s96, s92, 147456
    s_lshl_b32 s59, s51, 10
    s_add_u32 m0, s59, 0
    s_add_u32 s54, s96, 0
    buffer_load_dwordx4 v3, s[8:11], s54 offen lds
    s_add_u32 m0, s59, 4096
    s_add_u32 s54, s96, 128
    buffer_load_dwordx4 v3, s[8:11], s54 offen lds
    s_add_u32 m0, s59, 8192
    s_add_u32 s54, s96, 256
    buffer_load_dwordx4 v3, s[8:11], s54 offen lds
    s_add_u32 m0, s59, 12288
    s_add_u32 s54, s96, 384
    buffer_load_dwordx4 v3, s[8:11], s54 offen lds
    s_add_u32 m0, s59, 16384
    s_add_u32 s54, s96, 512
    buffer_load_dwordx4 v3, s[8:11], s54 offen lds
    s_add_u32 m0, s59, 20480
    s_add_u32 s54, s96, 640
    buffer_load_dwordx4 v3, s[8:11], s54 offen lds
    s_add_u32 m0, s59, 24576
    s_add_u32 s54, s96, 768
    buffer_load_dwordx4 v3, s[8:11], s54 offen lds
    s_add_u32 m0, s59, 28672
    s_add_u32 s54, s96, 896
    buffer_load_dwordx4 v3, s[8:11], s54 offen lds
    s_add_u32 m0, s59, 32768
    s_add_u32 s54, s96, 1024
    buffer_load_dwordx4 v3, s[8:11], s54 offen lds
    s_add_u32 s96, s96, 36864
    s_add_u32 s59, s59, 36864
    s_add_u32 m0, s59, 0
    s_add_u32 s54, s96, 0
    buffer_load_dwordx4 v3, s[8:11], s54 offen lds
    s_add_u32 m0, s59, 4096
    s_add_u32 s54, s96, 128
    buffer_load_dwordx4 v3, s[8:11], s54 offen lds
    s_add_u32 m0, s59, 8192
    s_add_u32 s54, s96, 256
    buffer_load_dwordx4 v3, s[8:11], s54 offen lds
    s_add_u32 m0, s59, 12288
    s_add_u32 s54, s96, 384
    buffer_load_dwordx4 v3, s[8:11], s54 offen lds
    s_add_u32 m0, s59, 16384
    s_add_u32 s54, s96, 512
    buffer_load_dwordx4 v3, s[8:11], s54 offen lds
    s_add_u32 m0, s59, 20480
    s_add_u32 s54, s96, 640
    buffer_load_dwordx4 v3, s[8:11], s54 offen lds
    s_add_u32 m0, s59, 24576
    s_add_u32 s54, s96, 768
    buffer_load_dwordx4 v3, s[8:11], s54 offen lds
    s_add_u32 m0, s59, 28672
    s_add_u32 s54, s96, 896
    buffer_load_dwordx4 v3, s[8:11], s54 offen lds
    s_add_u32 m0, s59, 32768
    s_add_u32 s54, s96, 1024
    buffer_load_dwordx4 v3, s[8:11], s54 offen lds
    s_add_u32 s96, s96, 36864
    s_add_u32 s59, s59, 36864
    s_mov_b32 s56, 0
    s_mov_b32 s7, 0
    s_waitcnt vmcnt(9)
    s_barrier
    v_add_u32 v8, s56, v4
    v_add_u32 v9, s56, v5
    v_add_u32 v10, s56, v6
    v_add_u32 v11, s56, v7
    ds_read_b128 v[16:19], v8 offset:0
    ds_read_b128 v[20:23], v9 offset:0
    ds_read_b128 v[24:27], v10 offset:0
    ds_read_b128 v[28:31], v11 offset:0
    s_waitcnt lgkmcnt(3)
    v_mfma_f32_32x32x16_bf16 v[32:47], a[0:3], v[16:19], 0
    s_add_u32 m0, s59, 0
    s_add_u32 s54, s96, 0
    buffer_load_dwordx4 v3, s[8:11], s54 offen lds
    ds_read_b128 v[16:19], v8 offset:4096
    s_waitcnt lgkmcnt(3)
    v_mfma_f32_32x32x16_bf16 v[32:47], a[4:7], v[20:23], v[32:47]
    ds_read_b128 v[20:23], v9 offset:4096
    s_waitcnt lgkmcnt(3)
    v_mfma_f32_32x32x16_bf16 v[32:47], a[8:11], v[24:27], v[32:47]
    s_add_u32 m0, s59, 4096
    s_add_u32 s54, s96, 128
    buffer_load_dwordx4 v3, s[8:11], s54 offen lds
    ds_read_b128 v[24:27], v10 offset:4096
    s_waitcnt lgkmcnt(3)
    v_mfma_f32_32x32x16_bf16 v[32:47], a[12:15], v[28:31], v[32:47]
    ds_read_b128 v[28:31], v11 offset:4096
    s_waitcnt lgkmcnt(3)
    v_mfma_f32_32x32x16_bf16 v[32:47], a[16:19], v[16:19], v[32:47]
    s_add_u32 m0, s59, 8192
    s_add_u32 s54, s96, 256
    buffer_load_dwordx4 v3, s[8:11], s54 offen lds
    ds_read_b128 v[16:19], v8 offset:8192
    s_waitcnt lgkmcnt(3)
    v_mfma_f32_32x32x16_bf16 v[32:47], a[20:23], v[20:23], v[32:47]
    ds_read_b128 v[20:23], v9 offset:8192
    s_waitcnt lgkmcnt(3)
    v_mfma_f32_32x32x16_bf16 v[32:47], a[24:27], v[24:27], v[32:47]
    s_add_u32 m0, s59, 12288
    s_add_u32 s54, s96, 384
    buffer_load_dwordx4 v3, s[8:11], s54 offen lds
    ds_read_b128 v[24:27], v10 offset:8192
    s_waitcnt lgkmcnt(3)
    v_mfma_f32_32x32x16_bf16 v[32:47], a[28:31], v[28:31], v[32:47]
    ds_read_b128 v[28:31], v11 offset:8192
    s_waitcnt lgkmcnt(3)
    v_mfma_f32_32x32x16_bf16 v[32:47], a[32:35], v[16:19], v[32:47]
    s_add_u32 m0, s59, 16384
    s_add_u32 s54, s96, 512
    buffer_load_dwordx4 v3, s[8:11], s54 offen lds
    ds_read_b128 v[16:19], v8 offset:12288
    s_waitcnt lgkmcnt(3)
    v_mfma_f32_32x32x16_bf16 v[32:47], a[36:39], v[20:23], v[32:47]
    ds_read_b128 v[20:23], v9 offset:12288
    s_waitcnt lgkmcnt(3)
    v_mfma_f32_32x32x16_bf16 v[32:47], a[40:43], v[24:27], v[32:47]
    s_add_u32 m0, s59, 20480
    s_add_u32 s54, s96, 640
    buffer_load_dwordx4 v3, s[8:11], s54 offen lds
    ds_read_b128 v[24:27], v10 offset:12288
    s_waitcnt lgkmcnt(3)
    v_mfma_f32_32x32x16_bf16 v[32:47], a[44:47], v[28:31], v[32:47]
    ds_read_b128 v[28:31], v11 offset:12288
    s_waitcnt lgkmcnt(3)
    v_mfma_f32_32x32x16_bf16 v[32:47], a[48:51], v[16:19], v[32:47]
    s_add_u32 m0, s59, 24576
    s_add_u32 s54, s96, 768
    buffer_load_dwordx4 v3, s[8:11], s54 offen lds
    ds_read_b128 v[16:19], v8 offset:16384
    s_waitcnt lgkmcnt(3)
    v_mfma_f32_32x32x16_bf16 v[32:47], a[52:55], v[20:23], v[32:47]
    ds_read_b128 v[20:23], v9 offset:16384
    s_waitcnt lgkmcnt(3)
    v_mfma_f32_32x32x16_bf16 v[32:47], a[56:59], v[24:27], v[32:47]
    s_add_u32 m0, s59, 28672
    s_add_u32 s54, s96, 896
    buffer_load_dwordx4 v3, s[8:11], s54 offen lds
    ds_read_b128 v[24:27], v10 offset:16384
    s_waitcnt lgkmcnt(3)
    v_mfma_f32_32x32x16_bf16 v[32:47], a[60:63], v[28:31], v[32:47]
    ds_read_b128 v[28:31], v11 offset:16384
    s_waitcnt lgkmcnt(3)
    v_mfma_f32_32x32x16_bf16 v[32:47], a[64:67], v[16:19], v[32:47]
    s_add_u32 m0, s59, 32768
    s_add_u32 s54, s96, 1024
    buffer_load_dwordx4 v3, s[8:11], s54 offen lds
    ds_read_b128 v[16:19], v8 offset:20480
    s_waitcnt lgkmcnt(3)
    v_mfma_f32_32x32x16_bf16 v[32:47], a[68:71], v[20:23], v[32:47]
    ds_read_b128 v[20:23], v9 offset:20480
    s_waitcnt lgkmcnt(3)
    v_mfma_f32_32x32x16_bf16 v[32:47], a[72:75], v[24:27], v[32:47]
    ds_read_b128 v[24:27], v10 offset:20480
    s_waitcnt lgkmcnt(3)
    v_mfma_f32_32x32x16_bf16 v[32:47], a[76:79], v[28:31], v[32:47]
    ds_read_b128 v[28:31], v11 offset:20480
    s_waitcnt lgkmcnt(3)
    v_mfma_f32_32x32x16_bf16 v[32:47], a[80:83], v[16:19], v[32:47]
    ds_read_b128 v[16:19], v8 offset:24576
    s_waitcnt lgkmcnt(3)
    v_mfma_f32_32x32x16_bf16 v[32:47], a[84:87], v[20:23], v[32:47]
    ds_read_b128 v[20:23], v9 offset:24576
    s_waitcnt lgkmcnt(3)
    v_mfma_f32_32x32x16_bf16 v[32:47], a[88:91], v[24:27], v[32:47]
    ds_read_b128 v[24:27], v10 offset:24576
    s_waitcnt lgkmcnt(3)
    v_mfma_f32_32x32x16_bf16 v[32:47], a[92:95], v[28:31], v[32:47]
    ds_read_b128 v[28:31], v11 offset:24576
    s_waitcnt lgkmcnt(3)
    v_mfma_f32_32x32x16_bf16 v[32:47], a[96:99], v[16:19], v[32:47]
    ds_read_b128 v[16:19], v8 offset:28672
    s_waitcnt lgkmcnt(3)
    v_mfma_f32_32x32x16_bf16 v[32:47], a[100:103], v[20:23], v[32:47]
    ds_read_b128 v[20:23], v9 offset:28672
    s_waitcnt lgkmcnt(3)
    v_mfma_f32_32x32x16_bf16 v[32:47], a[104:107], v[24:27], v[32:47]
    ds_read_b128 v[24:27], v10 offset:28672
    s_waitcnt lgkmcnt(3)
    v_mfma_f32_32x32x16_bf16 v[32:47], a[108:111], v[28:31], v[32:47]
    ds_read_b128 v[28:31], v11 offset:28672
    s_waitcnt lgkmcnt(3)
    v_mfma_f32_32x32x16_bf16 v[32:47], a[112:115], v[16:19], v[32:47]
    ds_read_b128 v[16:19], v8 offset:32768
    s_waitcnt lgkmcnt(3)
    v_mfma_f32_32x32x16_bf16 v[32:47], a[116:119], v[20:23], v[32:47]
    ds_read_b128 v[20:23], v9 offset:32768
    s_waitcnt lgkmcnt(3)
    v_mfma_f32_32x32x16_bf16 v[32:47], a[120:123], v[24:27], v[32:47]
    ds_read_b128 v[24:27], v10 offset:32768
    s_waitcnt lgkmcnt(3)
    v_mfma_f32_32x32x16_bf16 v[32:47], a[124:127], v[28:31], v[32:47]
    ds_read_b128 v[28:31], v11 offset:32768
    s_waitcnt lgkmcnt(3)
    v_mfma_f32_32x32x16_bf16 v[32:47], a[128:131], v[16:19], v[32:47]
    s_waitcnt lgkmcnt(2)
    v_mfma_f32_32x32x16_bf16 v[32:47], a[132:135], v[20:23], v[32:47]
    s_waitcnt lgkmcnt(1)
    v_mfma_f32_32x32x16_bf16 v[32:47], a[136:139], v[24:27], v[32:47]
    s_waitcnt lgkmcnt(0)
    v_mfma_f32_32x32x16_bf16 v[32:47], a[140:143], v[28:31], v[32:47]
    s_add_u32 s96, s96, 36864
    s_add_u32 s59, s59, 36864
    s_cmp_ge_u32 s59, 110592
    s_cselect_b32 s54, 110592, 0
    s_sub_u32 s59, s59, s54
    s_add_u32 s56, s56, 36864
    s_cmp_ge_u32 s56, 110592
    s_cselect_b32 s56, 0, s56
    s_nop 3
    v_cvt_pk_bf16_f32 v48, v32, v33
    v_cvt_pk_bf16_f32 v49, v34, v35
    v_cvt_pk_bf16_f32 v50, v36, v37
    v_cvt_pk_bf16_f32 v51, v38, v39
    v_cvt_pk_bf16_f32 v52, v40, v41
    v_cvt_pk_bf16_f32 v53, v42, v43
    v_cvt_pk_bf16_f32 v54, v44, v45
    v_cvt_pk_bf16_f32 v55, v46, v47
    ds_write_b128 v2, v[48:51] offset:0
    ds_write_b128 v2, v[52:55] offset:1024
    s_waitcnt vmcnt(9)
    s_barrier
    v_add_u32 v8, s56, v4
    v_add_u32 v9, s56, v5
    v_add_u32 v10, s56, v6
    v_add_u32 v11, s56, v7
    ds_read_b128 v[16:19], v8 offset:0
    ds_read_b128 v[20:23], v9 offset:0
    ds_read_b128 v[24:27], v10 offset:0
    ds_read_b128 v[28:31], v11 offset:0
    s_waitcnt lgkmcnt(3)
    v_mfma_f32_32x32x16_bf16 v[32:47], a[0:3], v[16:19], 0
    s_add_u32 m0, s59, 0
    s_add_u32 s54, s96, 0
    buffer_load_dwordx4 v3, s[8:11], s54 offen lds
    ds_read_b128 v[16:19], v8 offset:4096
    s_waitcnt lgkmcnt(3)
    v_mfma_f32_32x32x16_bf16 v[32:47], a[4:7], v[20:23], v[32:47]
    ds_read_b128 v[20:23], v9 offset:4096
    s_waitcnt lgkmcnt(3)
    v_mfma_f32_32x32x16_bf16 v[32:47], a[8:11], v[24:27], v[32:47]
    s_add_u32 m0, s59, 4096
    s_add_u32 s54, s96, 128
    buffer_load_dwordx4 v3, s[8:11], s54 offen lds
    ds_read_b128 v[24:27], v10 offset:4096
    s_waitcnt lgkmcnt(3)
    v_mfma_f32_32x32x16_bf16 v[32:47], a[12:15], v[28:31], v[32:47]
    ds_read_b128 v[28:31], v11 offset:4096
    s_waitcnt lgkmcnt(3)
    v_mfma_f32_32x32x16_bf16 v[32:47], a[16:19], v[16:19], v[32:47]
    s_add_u32 m0, s59, 8192
    s_add_u32 s54, s96, 256
    buffer_load_dwordx4 v3, s[8:11], s54 offen lds
    ds_read_b128 v[16:19], v8 offset:8192
    s_waitcnt lgkmcnt(3)
    v_mfma_f32_32x32x16_bf16 v[32:47], a[20:23], v[20:23], v[32:47]
    ds_read_b128 v[20:23], v9 offset:8192
    s_waitcnt lgkmcnt(3)
    v_mfma_f32_32x32x16_bf16 v[32:47], a[24:27], v[24:27], v[32:47]
    s_add_u32 m0, s59, 12288
    s_add_u32 s54, s96, 384
    buffer_load_dwordx4 v3, s[8:11], s54 offen lds
    ds_read_b128 v[24:27], v10 offset:8192
    s_waitcnt lgkmcnt(3)
    v_mfma_f32_32x32x16_bf16 v[32:47], a[28:31], v[28:31], v[32:47]
    ds_read_b128 v[28:31], v11 offset:8192
    s_waitcnt lgkmcnt(3)
    v_mfma_f32_32x32x16_bf16 v[32:47], a[32:35], v[16:19], v[32:47]
    s_add_u32 m0, s59, 16384
    s_add_u32 s54, s96, 512
    buffer_load_dwordx4 v3, s[8:11], s54 offen lds
    ds_read_b128 v[16:19], v8 offset:12288
    s_waitcnt lgkmcnt(3)
    v_mfma_f32_32x32x16_bf16 v[32:47], a[36:39], v[20:23], v[32:47]
    ds_read_b128 v[20:23], v9 offset:12288
    s_waitcnt lgkmcnt(3)
    v_mfma_f32_32x32x16_bf16 v[32:47], a[40:43], v[24:27], v[32:47]
    s_add_u32 m0, s59, 20480
    s_add_u32 s54, s96, 640
    buffer_load_dwordx4 v3, s[8:11], s54 offen lds
    ds_read_b128 v[24:27], v10 offset:12288
    s_waitcnt lgkmcnt(3)
    v_mfma_f32_32x32x16_bf16 v[32:47], a[44:47], v[28:31], v[32:47]
    ds_read_b128 v[28:31], v11 offset:12288
    s_waitcnt lgkmcnt(3)
    v_mfma_f32_32x32x16_bf16 v[32:47], a[48:51], v[16:19], v[32:47]
    s_add_u32 m0, s59, 24576
    s_add_u32 s54, s96, 768
    buffer_load_dwordx4 v3, s[8:11], s54 offen lds
    ds_read_b128 v[16:19], v8 offset:16384
    s_waitcnt lgkmcnt(3)
    v_mfma_f32_32x32x16_bf16 v[32:47], a[52:55], v[20:23], v[32:47]
    ds_read_b128 v[20:23], v9 offset:16384
    s_waitcnt lgkmcnt(3)
    v_mfma_f32_32x32x16_bf16 v[32:47], a[56:59], v[24:27], v[32:47]
    s_add_u32 m0, s59, 28672
    s_add_u32 s54, s96, 896
    buffer_load_dwordx4 v3, s[8:11], s54 offen lds
    ds_read_b128 v[24:27], v10 offset:16384
    s_waitcnt lgkmcnt(3)
    v_mfma_f32_32x32x16_bf16 v[32:47], a[60:63], v[28:31], v[32:47]
    ds_read_b128 v[28:31], v11 offset:16384
    s_waitcnt lgkmcnt(3)
    v_mfma_f32_32x32x16_bf16 v[32:47], a[64:67], v[16:19], v[32:47]
    s_add_u32 m0, s59, 32768
    s_add_u32 s54, s96, 1024
    buffer_load_dwordx4 v3, s[8:11], s54 offen lds
    ds_read_b128 v[16:19], v8 offset:20480
    s_waitcnt lgkmcnt(3)
    v_mfma_f32_32x32x16_bf16 v[32:47], a[68:71], v[20:23], v[32:47]
    ds_read_b128 v[20:23], v9 offset:20480
    s_waitcnt lgkmcnt(3)
    v_mfma_f32_32x32x16_bf16 v[32:47], a[72:75], v[24:27], v[32:47]
    ds_read_b128 v[24:27], v10 offset:20480
    s_waitcnt lgkmcnt(3)
    v_mfma_f32_32x32x16_bf16 v[32:47], a[76:79], v[28:31], v[32:47]
    ds_read_b128 v[28:31], v11 offset:20480
    s_waitcnt lgkmcnt(3)
    v_mfma_f32_32x32x16_bf16 v[32:47], a[80:83], v[16:19], v[32:47]
    ds_read_b128 v[16:19], v8 offset:24576
    s_waitcnt lgkmcnt(3)
    v_mfma_f32_32x32x16_bf16 v[32:47], a[84:87], v[20:23], v[32:47]
    ds_read_b128 v[20:23], v9 offset:24576
    s_waitcnt lgkmcnt(3)
    v_mfma_f32_32x32x16_bf16 v[32:47], a[88:91], v[24:27], v[32:47]
    ds_read_b128 v[24:27], v10 offset:24576
    s_waitcnt lgkmcnt(3)
    v_mfma_f32_32x32x16_bf16 v[32:47], a[92:95], v[28:31], v[32:47]
    ds_read_b128 v[28:31], v11 offset:24576
    s_waitcnt lgkmcnt(3)
    v_mfma_f32_32x32x16_bf16 v[32:47], a[96:99], v[16:19], v[32:47]
    ds_read_b128 v[16:19], v8 offset:28672
    s_waitcnt lgkmcnt(3)
    v_mfma_f32_32x32x16_bf16 v[32:47], a[100:103], v[20:23], v[32:47]
    ds_read_b128 v[20:23], v9 offset:28672
    s_waitcnt lgkmcnt(3)
    v_mfma_f32_32x32x16_bf16 v[32:47], a[104:107], v[24:27], v[32:47]
    ds_read_b128 v[24:27], v10 offset:28672
    s_waitcnt lgkmcnt(3)
    v_mfma_f32_32x32x16_bf16 v[32:47], a[108:111], v[28:31], v[32:47]
    ds_read_b128 v[28:31], v11 offset:28672
    s_waitcnt lgkmcnt(3)
    v_mfma_f32_32x32x16_bf16 v[32:47], a[112:115], v[16:19], v[32:47]
    ds_read_b128 v[16:19], v8 offset:32768
    s_waitcnt lgkmcnt(3)
    v_mfma_f32_32x32x16_bf16 v[32:47], a[116:119], v[20:23], v[32:47]
    ds_read_b128 v[20:23], v9 offset:32768
    s_waitcnt lgkmcnt(3)
    v_mfma_f32_32x32x16_bf16 v[32:47], a[120:123], v[24:27], v[32:47]
    ds_read_b128 v[24:27], v10 offset:32768
    s_waitcnt lgkmcnt(3)
    v_mfma_f32_32x32x16_bf16 v[32:47], a[124:127], v[28:31], v[32:47]
    ds_read_b128 v[28:31], v11 offset:32768
    s_waitcnt lgkmcnt(3)
    v_mfma_f32_32x32x16_bf16 v[32:47], a[128:131], v[16:19], v[32:47]
    s_waitcnt lgkmcnt(2)
    v_mfma_f32_32x32x16_bf16 v[32:47], a[132:135], v[20:23], v[32:47]
    s_waitcnt lgkmcnt(1)
    v_mfma_f32_32x32x16_bf16 v[32:47], a[136:139], v[24:27], v[32:47]
    s_waitcnt lgkmcnt(0)
    v_mfma_f32_32x32x16_bf16 v[32:47], a[140:143], v[28:31], v[32:47]
    s_add_u32 s96, s96, 36864
    s_add_u32 s59, s59, 36864
    s_cmp_ge_u32 s59, 110592
    s_cselect_b32 s54, 110592, 0
    s_sub_u32 s59, s59, s54
    s_add_u32 s56, s56, 36864
    s_cmp_ge_u32 s56, 110592
    s_cselect_b32 s56, 0, s56
    s_nop 3
    v_cvt_pk_bf16_f32 v48, v32, v33
    v_cvt_pk_bf16_f32 v49, v34, v35
    v_cvt_pk_bf16_f32 v50, v36, v37
    v_cvt_pk_bf16_f32 v51, v38, v39
    v_cvt_pk_bf16_f32 v52, v40, v41
    v_cvt_pk_bf16_f32 v53, v42, v43
    v_cvt_pk_bf16_f32 v54, v44, v45
    v_cvt_pk_bf16_f32 v55, v46, v47
    ds_write_b128 v2, v[48:51] offset:8192
    ds_write_b128 v2, v[52:55] offset:9216
    s_waitcnt vmcnt(9)
    s_barrier
    v_add_u32 v8, s56, v4
    v_add_u32 v9, s56, v5
    v_add_u32 v10, s56, v6
    v_add_u32 v11, s56, v7
    ds_read_b128 v[16:19], v8 offset:0
    ds_read_b128 v[20:23], v9 offset:0
    ds_read_b128 v[24:27], v10 offset:0
    ds_read_b128 v[28:31], v11 offset:0
    s_waitcnt lgkmcnt(3)
    v_mfma_f32_32x32x16_bf16 v[32:47], a[0:3], v[16:19], 0
    s_add_u32 m0, s59, 0
    s_add_u32 s54, s96, 0
    buffer_load_dwordx4 v3, s[8:11], s54 offen lds
    ds_read_b128 v[16:19], v8 offset:4096
    s_waitcnt lgkmcnt(3)
    v_mfma_f32_32x32x16_bf16 v[32:47], a[4:7], v[20:23], v[32:47]
    ds_read_b128 v[20:23], v9 offset:4096
    s_waitcnt lgkmcnt(3)
    v_mfma_f32_32x32x16_bf16 v[32:47], a[8:11], v[24:27], v[32:47]
    s_add_u32 m0, s59, 4096
    s_add_u32 s54, s96, 128
    buffer_load_dwordx4 v3, s[8:11], s54 offen lds
    ds_read_b128 v[24:27], v10 offset:4096
    s_waitcnt lgkmcnt(3)
    v_mfma_f32_32x32x16_bf16 v[32:47], a[12:15], v[28:31], v[32:47]
    ds_read_b128 v[28:31], v11 offset:4096
    s_waitcnt lgkmcnt(3)
    v_mfma_f32_32x32x16_bf16 v[32:47], a[16:19], v[16:19], v[32:47]
    s_add_u32 m0, s59, 8192
    s_add_u32 s54, s96, 256
    buffer_load_dwordx4 v3, s[8:11], s54 offen lds
    ds_read_b128 v[16:19], v8 offset:8192
    s_waitcnt lgkmcnt(3)
    v_mfma_f32_32x32x16_bf16 v[32:47], a[20:23], v[20:23], v[32:47]
    ds_read_b128 v[20:23], v9 offset:8192
    s_waitcnt lgkmcnt(3)
    v_mfma_f32_32x32x16_bf16 v[32:47], a[24:27], v[24:27], v[32:47]
    s_add_u32 m0, s59, 12288
    s_add_u32 s54, s96, 384
    buffer_load_dwordx4 v3, s[8:11], s54 offen lds
    ds_read_b128 v[24:27], v10 offset:8192
    s_waitcnt lgkmcnt(3)
    v_mfma_f32_32x32x16_bf16 v[32:47], a[28:31], v[28:31], v[32:47]
    ds_read_b128 v[28:31], v11 offset:8192
    s_waitcnt lgkmcnt(3)
    v_mfma_f32_32x32x16_bf16 v[32:47], a[32:35], v[16:19], v[32:47]
    s_add_u32 m0, s59, 16384
    s_add_u32 s54, s96, 512
    buffer_load_dwordx4 v3, s[8:11], s54 offen lds
    ds_read_b128 v[16:19], v8 offset:12288
    s_waitcnt lgkmcnt(3)
    v_mfma_f32_32x32x16_bf16 v[32:47], a[36:39], v[20:23], v[32:47]
    ds_read_b128 v[20:23], v9 offset:12288
    s_waitcnt lgkmcnt(3)
    v_mfma_f32_32x32x16_bf16 v[32:47], a[40:43], v[24:27], v[32:47]
    s_add_u32 m0, s59, 20480
    s_add_u32 s54, s96, 640
    buffer_load_dwordx4 v3, s[8:11], s54 offen lds
    ds_read_b128 v[24:27], v10 offset:12288
    s_waitcnt lgkmcnt(3)
    v_mfma_f32_32x32x16_bf16 v[32:47], a[44:47], v[28:31], v[32:47]
    ds_read_b128 v[28:31], v11 offset:12288
    s_waitcnt lgkmcnt(3)
    v_mfma_f32_32x32x16_bf16 v[32:47], a[48:51], v[16:19], v[32:47]
    s_add_u32 m0, s59, 24576
    s_add_u32 s54, s96, 768
    buffer_load_dwordx4 v3, s[8:11], s54 offen lds
    ds_read_b128 v[16:19], v8 offset:16384
    s_waitcnt lgkmcnt(3)
    v_mfma_f32_32x32x16_bf16 v[32:47], a[52:55], v[20:23], v[32:47]
    ds_read_b128 v[20:23], v9 offset:16384
    s_waitcnt lgkmcnt(3)
    v_mfma_f32_32x32x16_bf16 v[32:47], a[56:59], v[24:27], v[32:47]
    s_add_u32 m0, s59, 28672
    s_add_u32 s54, s96, 896
    buffer_load_dwordx4 v3, s[8:11], s54 offen lds
    ds_read_b128 v[24:27], v10 offset:16384
    s_waitcnt lgkmcnt(3)
    v_mfma_f32_32x32x16_bf16 v[32:47], a[60:63], v[28:31], v[32:47]
    ds_read_b128 v[28:31], v11 offset:16384
    s_waitcnt lgkmcnt(3)
    v_mfma_f32_32x32x16_bf16 v[32:47], a[64:67], v[16:19], v[32:47]
    s_add_u32 m0, s59, 32768
    s_add_u32 s54, s96, 1024
    buffer_load_dwordx4 v3, s[8:11], s54 offen lds
    ds_read_b128 v[16:19], v8 offset:20480
    s_waitcnt lgkmcnt(3)
    v_mfma_f32_32x32x16_bf16 v[32:47], a[68:71], v[20:23], v[32:47]
    ds_read_b128 v[20:23], v9 offset:20480
    s_waitcnt lgkmcnt(3)
    v_mfma_f32_32x32x16_bf16 v[32:47], a[72:75], v[24:27], v[32:47]
    ds_read_b128 v[24:27], v10 offset:20480
    s_waitcnt lgkmcnt(3)
    v_mfma_f32_32x32x16_bf16 v[32:47], a[76:79], v[28:31], v[32:47]
    ds_read_b128 v[28:31], v11 offset:20480
    s_waitcnt lgkmcnt(3)
    v_mfma_f32_32x32x16_bf16 v[32:47], a[80:83], v[16:19], v[32:47]
    ds_read_b128 v[16:19], v8 offset:24576
    s_waitcnt lgkmcnt(3)
    v_mfma_f32_32x32x16_bf16 v[32:47], a[84:87], v[20:23], v[32:47]
    ds_read_b128 v[20:23], v9 offset:24576
    s_waitcnt lgkmcnt(3)
    v_mfma_f32_32x32x16_bf16 v[32:47], a[88:91], v[24:27], v[32:47]
    ds_read_b128 v[24:27], v10 offset:24576
    s_waitcnt lgkmcnt(3)
    v_mfma_f32_32x32x16_bf16 v[32:47], a[92:95], v[28:31], v[32:47]
    ds_read_b128 v[28:31], v11 offset:24576
    s_waitcnt lgkmcnt(3)
    v_mfma_f32_32x32x16_bf16 v[32:47], a[96:99], v[16:19], v[32:47]
    ds_read_b128 v[16:19], v8 offset:28672
    s_waitcnt lgkmcnt(3)
    v_mfma_f32_32x32x16_bf16 v[32:47], a[100:103], v[20:23], v[32:47]
    ds_read_b128 v[20:23], v9 offset:28672
    s_waitcnt lgkmcnt(3)
    v_mfma_f32_32x32x16_bf16 v[32:47], a[104:107], v[24:27], v[32:47]
    ds_read_b128 v[24:27], v10 offset:28672
    s_waitcnt lgkmcnt(3)
    v_mfma_f32_32x32x16_bf16 v[32:47], a[108:111], v[28:31], v[32:47]
    ds_read_b128 v[28:31], v11 offset:28672
    s_waitcnt lgkmcnt(3)
    v_mfma_f32_32x32x16_bf16 v[32:47], a[112:115], v[16:19], v[32:47]
    ds_read_b128 v[16:19], v8 offset:32768
    s_waitcnt lgkmcnt(3)
    v_mfma_f32_32x32x16_bf16 v[32:47], a[116:119], v[20:23], v[32:47]
    ds_read_b128 v[20:23], v9 offset:32768
    s_waitcnt lgkmcnt(3)
    v_mfma_f32_32x32x16_bf16 v[32:47], a[120:123], v[24:27], v[32:47]
    ds_read_b128 v[24:27], v10 offset:32768
    s_waitcnt lgkmcnt(3)
    v_mfma_f32_32x32x16_bf16 v[32:47], a[124:127], v[28:31], v[32:47]
    ds_read_b128 v[28:31], v11 offset:32768
    s_waitcnt lgkmcnt(3)
    v_mfma_f32_32x32x16_bf16 v[32:47], a[128:131], v[16:19], v[32:47]
    s_waitcnt lgkmcnt(2)
    v_mfma_f32_32x32x16_bf16 v[32:47], a[132:135], v[20:23], v[32:47]
    s_waitcnt lgkmcnt(1)
    v_mfma_f32_32x32x16_bf16 v[32:47], a[136:139], v[24:27], v[32:47]
    s_waitcnt lgkmcnt(0)
    v_mfma_f32_32x32x16_bf16 v[32:47], a[140:143], v[28:31], v[32:47]
    s_add_u32 s96, s96, 36864
    s_add_u32 s59, s59, 36864
    s_cmp_ge_u32 s59, 110592
    s_cselect_b32 s54, 110592, 0
    s_sub_u32 s59, s59, s54
    s_add_u32 s56, s56, 36864
    s_cmp_ge_u32 s56, 110592
    s_cselect_b32 s56, 0, s56
    s_nop 3
    v_cvt_pk_bf16_f32 v48, v32, v33
    v_cvt_pk_bf16_f32 v49, v34, v35
    v_cvt_pk_bf16_f32 v50, v36, v37
    v_cvt_pk_bf16_f32 v51, v38, v39
    v_cvt_pk_bf16_f32 v52, v40, v41
    v_cvt_pk_bf16_f32 v53, v42, v43
    v_cvt_pk_bf16_f32 v54, v44, v45
    v_cvt_pk_bf16_f32 v55, v46, v47
    ds_write_b128 v2, v[48:51] offset:16384
    ds_write_b128 v2, v[52:55] offset:17408
    s_waitcnt vmcnt(9)
    s_barrier
    v_add_u32 v8, s56, v4
    v_add_u32 v9, s56, v5
    v_add_u32 v10, s56, v6
    v_add_u32 v11, s56, v7
    ds_read_b128 v[16:19], v8 offset:0
    ds_read_b128 v[20:23], v9 offset:0
    ds_read_b128 v[24:27], v10 offset:0
    ds_read_b128 v[28:31], v11 offset:0
    s_waitcnt lgkmcnt(3)
    v_mfma_f32_32x32x16_bf16 v[32:47], a[0:3], v[16:19], 0
    s_add_u32 m0, s59, 0
    s_add_u32 s54, s96, 0
    buffer_load_dwordx4 v3, s[8:11], s54 offen lds
    ds_read_b128 v[16:19], v8 offset:4096
    s_waitcnt lgkmcnt(3)
    v_mfma_f32_32x32x16_bf16 v[32:47], a[4:7], v[20:23], v[32:47]
    ds_read_b128 v[20:23], v9 offset:4096
    s_waitcnt lgkmcnt(3)
    v_mfma_f32_32x32x16_bf16 v[32:47], a[8:11], v[24:27], v[32:47]
    s_add_u32 m0, s59, 4096
    s_add_u32 s54, s96, 128
    buffer_load_dwordx4 v3, s[8:11], s54 offen lds
    ds_read_b128 v[24:27], v10 offset:4096
    s_waitcnt lgkmcnt(3)
    v_mfma_f32_32x32x16_bf16 v[32:47], a[12:15], v[28:31], v[32:47]
    ds_read_b128 v[28:31], v11 offset:4096
    s_waitcnt lgkmcnt(3)
    v_mfma_f32_32x32x16_bf16 v[32:47], a[16:19], v[16:19], v[32:47]
    s_add_u32 m0, s59, 8192
    s_add_u32 s54, s96, 256
    buffer_load_dwordx4 v3, s[8:11], s54 offen lds
    ds_read_b128 v[16:19], v8 offset:8192
    s_waitcnt lgkmcnt(3)
    v_mfma_f32_32x32x16_bf16 v[32:47], a[20:23], v[20:23], v[32:47]
    ds_read_b128 v[20:23], v9 offset:8192
    s_waitcnt lgkmcnt(3)
    v_mfma_f32_32x32x16_bf16 v[32:47], a[24:27], v[24:27], v[32:47]
    s_add_u32 m0, s59, 12288
    s_add_u32 s54, s96, 384
    buffer_load_dwordx4 v3, s[8:11], s54 offen lds
    ds_read_b128 v[24:27], v10 offset:8192
    s_waitcnt lgkmcnt(3)
    v_mfma_f32_32x32x16_bf16 v[32:47], a[28:31], v[28:31], v[32:47]
    ds_read_b128 v[28:31], v11 offset:8192
    s_waitcnt lgkmcnt(3)
    v_mfma_f32_32x32x16_bf16 v[32:47], a[32:35], v[16:19], v[32:47]
    s_add_u32 m0, s59, 16384
    s_add_u32 s54, s96, 512
    buffer_load_dwordx4 v3, s[8:11], s54 offen lds
    ds_read_b128 v[16:19], v8 offset:12288
    s_waitcnt lgkmcnt(3)
    v_mfma_f32_32x32x16_bf16 v[32:47], a[36:39], v[20:23], v[32:47]
    ds_read_b128 v[20:23], v9 offset:12288
    s_waitcnt lgkmcnt(3)
    v_mfma_f32_32x32x16_bf16 v[32:47], a[40:43], v[24:27], v[32:47]
    s_add_u32 m0, s59, 20480
    s_add_u32 s54, s96, 640
    buffer_load_dwordx4 v3, s[8:11], s54 offen lds
    ds_read_b128 v[24:27], v10 offset:12288
    s_waitcnt lgkmcnt(3)
    v_mfma_f32_32x32x16_bf16 v[32:47], a[44:47], v[28:31], v[32:47]
    ds_read_b128 v[28:31], v11 offset:12288
    s_waitcnt lgkmcnt(3)
    v_mfma_f32_32x32x16_bf16 v[32:47], a[48:51], v[16:19], v[32:47]
    s_add_u32 m0, s59, 24576
    s_add_u32 s54, s96, 768
    buffer_load_dwordx4 v3, s[8:11], s54 offen lds
    ds_read_b128 v[16:19], v8 offset:16384
    s_waitcnt lgkmcnt(3)
    v_mfma_f32_32x32x16_bf16 v[32:47], a[52:55], v[20:23], v[32:47]
    ds_read_b128 v[20:23], v9 offset:16384
    s_waitcnt lgkmcnt(3)
    v_mfma_f32_32x32x16_bf16 v[32:47], a[56:59], v[24:27], v[32:47]
    s_add_u32 m0, s59, 28672
    s_add_u32 s54, s96, 896
    buffer_load_dwordx4 v3, s[8:11], s54 offen lds
    ds_read_b128 v[24:27], v10 offset:16384
    s_waitcnt lgkmcnt(3)
    v_mfma_f32_32x32x16_bf16 v[32:47], a[60:63], v[28:31], v[32:47]
    ds_read_b128 v[28:31], v11 offset:16384
    s_waitcnt lgkmcnt(3)
    v_mfma_f32_32x32x16_bf16 v[32:47], a[64:67], v[16:19], v[32:47]
    s_add_u32 m0, s59, 32768
    s_add_u32 s54, s96, 1024
    buffer_load_dwordx4 v3, s[8:11], s54 offen lds
    ds_read_b128 v[16:19], v8 offset:20480
    s_waitcnt lgkmcnt(3)
    v_mfma_f32_32x32x16_bf16 v[32:47], a[68:71], v[20:23], v[32:47]
    ds_read_b128 v[20:23], v9 offset:20480
    s_waitcnt lgkmcnt(3)
    v_mfma_f32_32x32x16_bf16 v[32:47], a[72:75], v[24:27], v[32:47]
    ds_read_b128 v[24:27], v10 offset:20480
    s_waitcnt lgkmcnt(3)
    v_mfma_f32_32x32x16_bf16 v[32:47], a[76:79], v[28:31], v[32:47]
    ds_read_b128 v[28:31], v11 offset:20480
    s_waitcnt lgkmcnt(3)
    v_mfma_f32_32x32x16_bf16 v[32:47], a[80:83], v[16:19], v[32:47]
    ds_read_b128 v[16:19], v8 offset:24576
    s_waitcnt lgkmcnt(3)
    v_mfma_f32_32x32x16_bf16 v[32:47], a[84:87], v[20:23], v[32:47]
    ds_read_b128 v[20:23], v9 offset:24576
    s_waitcnt lgkmcnt(3)
    v_mfma_f32_32x32x16_bf16 v[32:47], a[88:91], v[24:27], v[32:47]
    ds_read_b128 v[24:27], v10 offset:24576
    s_waitcnt lgkmcnt(3)
    v_mfma_f32_32x32x16_bf16 v[32:47], a[92:95], v[28:31], v[32:47]
    ds_read_b128 v[28:31], v11 offset:24576
    s_waitcnt lgkmcnt(3)
    v_mfma_f32_32x32x16_bf16 v[32:47], a[96:99], v[16:19], v[32:47]
    ds_read_b128 v[16:19], v8 offset:28672
    s_waitcnt lgkmcnt(3)
    v_mfma_f32_32x32x16_bf16 v[32:47], a[100:103], v[20:23], v[32:47]
    ds_read_b128 v[20:23], v9 offset:28672
    s_waitcnt lgkmcnt(3)
    v_mfma_f32_32x32x16_bf16 v[32:47], a[104:107], v[24:27], v[32:47]
    ds_read_b128 v[24:27], v10 offset:28672
    s_waitcnt lgkmcnt(3)
    v_mfma_f32_32x32x16_bf16 v[32:47], a[108:111], v[28:31], v[32:47]
    ds_read_b128 v[28:31], v11 offset:28672
    s_waitcnt lgkmcnt(3)
    v_mfma_f32_32x32x16_bf16 v[32:47], a[112:115], v[16:19], v[32:47]
    ds_read_b128 v[16:19], v8 offset:32768
    s_waitcnt lgkmcnt(3)
    v_mfma_f32_32x32x16_bf16 v[32:47], a[116:119], v[20:23], v[32:47]
    ds_read_b128 v[20:23], v9 offset:32768
    s_waitcnt lgkmcnt(3)
    v_mfma_f32_32x32x16_bf16 v[32:47], a[120:123], v[24:27], v[32:47]
    ds_read_b128 v[24:27], v10 offset:32768
    s_waitcnt lgkmcnt(3)
    v_mfma_f32_32x32x16_bf16 v[32:47], a[124:127], v[28:31], v[32:47]
    ds_read_b128 v[28:31], v11 offset:32768
    s_waitcnt lgkmcnt(3)
    v_mfma_f32_32x32x16_bf16 v[32:47], a[128:131], v[16:19], v[32:47]
    s_waitcnt lgkmcnt(2)
    v_mfma_f32_32x32x16_bf16 v[32:47], a[132:135], v[20:23], v[32:47]
    s_waitcnt lgkmcnt(1)
    v_mfma_f32_32x32x16_bf16 v[32:47], a[136:139], v[24:27], v[32:47]
    s_waitcnt lgkmcnt(0)
    v_mfma_f32_32x32x16_bf16 v[32:47], a[140:143], v[28:31], v[32:47]
    s_add_u32 s96, s96, 36864
    s_add_u32 s59, s59, 36864
    s_cmp_ge_u32 s59, 110592
    s_cselect_b32 s54, 110592, 0
    s_sub_u32 s59, s59, s54
    s_add_u32 s56, s56, 36864
    s_cmp_ge_u32 s56, 110592
    s_cselect_b32 s56, 0, s56
    s_nop 3
    v_cvt_pk_bf16_f32 v48, v32, v33
    v_cvt_pk_bf16_f32 v49, v34, v35
    v_cvt_pk_bf16_f32 v50, v36, v37
    v_cvt_pk_bf16_f32 v51, v38, v39
    v_cvt_pk_bf16_f32 v52, v40, v41
    v_cvt_pk_bf16_f32 v53, v42, v43
    v_cvt_pk_bf16_f32 v54, v44, v45
    v_cvt_pk_bf16_f32 v55, v46, v47
    ds_write_b128 v2, v[48:51] offset:24576
    ds_write_b128 v2, v[52:55] offset:25600
    s_waitcnt lgkmcnt(0)
    s_barrier
L_b_loop_137:
    s_lshl_b32 s57, s92, 2
    s_add_u32 s57, s57, s51
    s_lshl_b32 s52, s47, 6
    s_add_u32 s52, s52, s57
    s_lshl_b32 s97, s52, 14
    s_lshl_b32 s94, s52, 13
    s_add_u32 s94, s94, 67108864
    s_lshl_b32 s93, s57, 6
    s_add_u32 s93, s93, s47
    s_lshl_b32 s93, s93, 13
    s_add_u32 s93, s93, 100663296
    s_lshl_b32 s95, s57, 7
    s_add_u32 s95, s95, 139460608
    s_lshl_b32 s52, s51, 13
    s_add_u32 s52, s52, 110592
    v_add_u32 v48, s52, v12
    ds_read_b128 v[56:59], v48 offset:0
    ds_read_b128 v[60:63], v48 offset:1024
    ds_read_b128 v[64:67], v48 offset:2048
    ds_read_b128 v[68:71], v48 offset:3072
    ds_read_b128 v[72:75], v48 offset:4096
    ds_read_b128 v[76:79], v48 offset:5120
    ds_read_b128 v[80:83], v48 offset:6144
    ds_read_b128 v[84:87], v48 offset:7168
    s_cmp_gt_u32 s7, s57
    s_cbranch_scc1 L_b_kvok_140
L_sw_141:
    s_buffer_load_dword s7, s[28:31], s6 glc
    s_waitcnt lgkmcnt(0)
    s_cmp_gt_u32 s7, s57
    s_cbranch_scc1 L_sw_ok_142
    s_sleep 2
    s_sub_u32 s99, s99, 1
    s_cmp_lg_u32 s99, 0
    s_cbranch_scc1 L_sw_141
    s_branch L_exit
L_sw_ok_142:
L_b_kvok_140:
    s_waitcnt lgkmcnt(0)
    s_cmp_ge_u32 s92, 15
    s_cbranch_scc1 L_b_lastb_138
    s_waitcnt vmcnt(9)
    s_barrier
    v_add_u32 v8, s56, v4
    v_add_u32 v9, s56, v5
    v_add_u32 v10, s56, v6
    v_add_u32 v11, s56, v7
    ds_read_b128 v[16:19], v8 offset:0
    ds_read_b128 v[20:23], v9 offset:0
    ds_read_b128 v[24:27], v10 offset:0
    s_add_u32 s55, s97, 0
    ds_read_b128 v[28:31], v11 offset:0
    s_waitcnt lgkmcnt(3)
    v_mfma_f32_32x32x16_bf16 v[32:47], a[0:3], v[16:19], 0
    buffer_load_dwordx4 v[88:91], v12, s[28:31], s55 offen offset:0 sc1
    ds_read_b128 v[16:19], v8 offset:4096
    s_waitcnt lgkmcnt(3)
    v_mfma_f32_32x32x16_bf16 v[32:47], a[4:7], v[20:23], v[32:47]
    ds_read_b128 v[20:23], v9 offset:4096
    s_waitcnt lgkmcnt(3)
    v_mfma_f32_32x32x16_bf16 v[32:47], a[8:11], v[24:27], v[32:47]
    ds_read_b128 v[24:27], v10 offset:4096
    s_waitcnt lgkmcnt(3)
    v_mfma_f32_32x32x16_bf16 v[32:47], a[12:15], v[28:31], v[32:47]
    ds_read_b128 v[28:31], v11 offset:4096
    s_waitcnt lgkmcnt(3)
    v_mfma_f32_32x32x16_bf16 v[32:47], a[16:19], v[16:19], v[32:47]
    buffer_load_dwordx4 v[92:95], v12, s[28:31], s55 offen offset:1024 sc1
    ds_read_b128 v[16:19], v8 offset:8192
    s_waitcnt lgkmcnt(3)
    v_mfma_f32_32x32x16_bf16 v[32:47], a[20:23], v[20:23], v[32:47]
    ds_read_b128 v[20:23], v9 offset:8192
    s_waitcnt lgkmcnt(3)
    v_mfma_f32_32x32x16_bf16 v[32:47], a[24:27], v[24:27], v[32:47]
    ds_read_b128 v[24:27], v10 offset:8192
    s_waitcnt lgkmcnt(3)
    v_mfma_f32_32x32x16_bf16 v[32:47], a[28:31], v[28:31], v[32:47]
    ds_read_b128 v[28:31], v11 offset:8192
    s_waitcnt lgkmcnt(3)
    v_mfma_f32_32x32x16_bf16 v[32:47], a[32:35], v[16:19], v[32:47]
    buffer_load_dwordx4 v[96:99], v12, s[28:31], s55 offen offset:2048 sc1
    ds_read_b128 v[16:19], v8 offset:12288
    s_waitcnt lgkmcnt(3)
    v_mfma_f32_32x32x16_bf16 v[32:47], a[36:39], v[20:23], v[32:47]
    ds_read_b128 v[20:23], v9 offset:12288
    s_waitcnt lgkmcnt(3)
    v_mfma_f32_32x32x16_bf16 v[32:47], a[40:43], v[24:27], v[32:47]
    ds_read_b128 v[24:27], v10 offset:12288
    s_waitcnt lgkmcnt(3)
    v_mfma_f32_32x32x16_bf16 v[32:47], a[44:47], v[28:31], v[32:47]
    ds_read_b128 v[28:31], v11 offset:12288
    s_waitcnt lgkmcnt(3)
    v_mfma_f32_32x32x16_bf16 v[32:47], a[48:51], v[16:19], v[32:47]
    buffer_load_dwordx4 v[100:103], v12, s[28:31], s55 offen offset:3072 sc1
    ds_read_b128 v[16:19], v8 offset:16384
    s_waitcnt lgkmcnt(3)
    v_mfma_f32_32x32x16_bf16 v[32:47], a[52:55], v[20:23], v[32:47]
    ds_read_b128 v[20:23], v9 offset:16384
    s_waitcnt lgkmcnt(3)
    v_mfma_f32_32x32x16_bf16 v[32:47], a[56:59], v[24:27], v[32:47]
    ds_read_b128 v[24:27], v10 offset:16384
    s_waitcnt lgkmcnt(3)
    v_mfma_f32_32x32x16_bf16 v[32:47], a[60:63], v[28:31], v[32:47]
    ds_read_b128 v[28:31], v11 offset:16384
    s_waitcnt lgkmcnt(3)
    v_mfma_f32_32x32x16_bf16 v[32:47], a[64:67], v[16:19], v[32:47]
    buffer_load_dword v15, v1, s[28:31], s95 offen sc1
    ds_read_b128 v[16:19], v8 offset:20480
    s_waitcnt lgkmcnt(3)
    v_mfma_f32_32x32x16_bf16 v[32:47], a[68:71], v[20:23], v[32:47]
    s_add_u32 m0, s59, 0
    s_add_u32 s54, s96, 0
    buffer_load_dwordx4 v3, s[8:11], s54 offen lds
    ds_read_b128 v[20:23], v9 offset:20480
    s_waitcnt lgkmcnt(3)
    v_mfma_f32_32x32x16_bf16 v[32:47], a[72:75], v[24:27], v[32:47]
    ds_read_b128 v[24:27], v10 offset:20480
    s_waitcnt lgkmcnt(3)
    v_mfma_f32_32x32x16_bf16 v[32:47], a[76:79], v[28:31], v[32:47]
    s_add_u32 m0, s59, 4096
    s_add_u32 s54, s96, 128
    buffer_load_dwordx4 v3, s[8:11], s54 offen lds
    ds_read_b128 v[28:31], v11 offset:20480
    s_waitcnt lgkmcnt(3)
    v_mfma_f32_32x32x16_bf16 v[32:47], a[80:83], v[16:19], v[32:47]
    ds_read_b128 v[16:19], v8 offset:24576
    s_waitcnt lgkmcnt(3)
    v_mfma_f32_32x32x16_bf16 v[32:47], a[84:87], v[20:23], v[32:47]
    s_add_u32 m0, s59, 8192
    s_add_u32 s54, s96, 256
    buffer_load_dwordx4 v3, s[8:11], s54 offen lds
    ds_read_b128 v[20:23], v9 offset:24576
    s_waitcnt lgkmcnt(3)
    v_mfma_f32_32x32x16_bf16 v[32:47], a[88:91], v[24:27], v[32:47]
    ds_read_b128 v[24:27], v10 offset:24576
    s_waitcnt lgkmcnt(3)
    v_mfma_f32_32x32x16_bf16 v[32:47], a[92:95], v[28:31], v[32:47]
    s_add_u32 m0, s59, 12288
    s_add_u32 s54, s96, 384
    buffer_load_dwordx4 v3, s[8:11], s54 offen lds
    ds_read_b128 v[28:31], v11 offset:24576
    s_waitcnt lgkmcnt(3)
    v_mfma_f32_32x32x16_bf16 v[32:47], a[96:99], v[16:19], v[32:47]
    ds_read_b128 v[16:19], v8 offset:28672
    s_waitcnt lgkmcnt(3)
    v_mfma_f32_32x32x16_bf16 v[32:47], a[100:103], v[20:23], v[32:47]
    s_add_u32 m0, s59, 16384
    s_add_u32 s54, s96, 512
    buffer_load_dwordx4 v3, s[8:11], s54 offen lds
    ds_read_b128 v[20:23], v9 offset:28672
    s_waitcnt lgkmcnt(3)
    v_mfma_f32_32x32x16_bf16 v[32:47], a[104:107], v[24:27], v[32:47]
    ds_read_b128 v[24:27], v10 offset:28672
    s_waitcnt lgkmcnt(3)
    v_mfma_f32_32x32x16_bf16 v[32:47], a[108:111], v[28:31], v[32:47]
    s_add_u32 m0, s59, 20480
    s_add_u32 s54, s96, 640
    buffer_load_dwordx4 v3, s[8:11], s54 offen lds
    ds_read_b128 v[28:31], v11 offset:28672
    s_waitcnt lgkmcnt(3)
    v_mfma_f32_32x32x16_bf16 v[32:47], a[112:115], v[16:19], v[32:47]
    ds_read_b128 v[16:19], v8 offset:32768
    s_waitcnt lgkmcnt(3)
    v_mfma_f32_32x32x16_bf16 v[32:47], a[116:119], v[20:23], v[32:47]
    s_add_u32 m0, s59, 24576
    s_add_u32 s54, s96, 768
    buffer_load_dwordx4 v3, s[8:11], s54 offen lds
    ds_read_b128 v[20:23], v9 offset:32768
    s_waitcnt lgkmcnt(3)
    v_mfma_f32_32x32x16_bf16 v[32:47], a[120:123], v[24:27], v[32:47]
    ds_read_b128 v[24:27], v10 offset:32768
    s_waitcnt lgkmcnt(3)
    v_mfma_f32_32x32x16_bf16 v[32:47], a[124:127], v[28:31], v[32:47]
    s_add_u32 m0, s59, 28672
    s_add_u32 s54, s96, 896
    buffer_load_dwordx4 v3, s[8:11], s54 offen lds
    ds_read_b128 v[28:31], v11 offset:32768
    s_waitcnt lgkmcnt(3)
    v_mfma_f32_32x32x16_bf16 v[32:47], a[128:131], v[16:19], v[32:47]
    s_waitcnt lgkmcnt(2)
    v_mfma_f32_32x32x16_bf16 v[32:47], a[132:135], v[20:23], v[32:47]
    s_add_u32 m0, s59, 32768
    s_add_u32 s54, s96, 1024
    buffer_load_dwordx4 v3, s[8:11], s54 offen lds
    s_waitcnt lgkmcnt(1)
    v_mfma_f32_32x32x16_bf16 v[32:47], a[136:139], v[24:27], v[32:47]
    s_waitcnt lgkmcnt(0)
    v_mfma_f32_32x32x16_bf16 v[32:47], a[140:143], v[28:31], v[32:47]
    s_add_u32 s96, s96, 36864
    s_add_u32 s59, s59, 36864
    s_cmp_ge_u32 s59, 110592
    s_cselect_b32 s54, 110592, 0
    s_sub_u32 s59, s59, s54
    s_add_u32 s56, s56, 36864
    s_cmp_ge_u32 s56, 110592
    s_cselect_b32 s56, 0, s56
    s_nop 3
    v_cvt_pk_bf16_f32 v48, v32, v33
    v_cvt_pk_bf16_f32 v49, v34, v35
    v_cvt_pk_bf16_f32 v50, v36, v37
    v_cvt_pk_bf16_f32 v51, v38, v39
    v_cvt_pk_bf16_f32 v52, v40, v41
    v_cvt_pk_bf16_f32 v53, v42, v43
    v_cvt_pk_bf16_f32 v54, v44, v45
    v_cvt_pk_bf16_f32 v55, v46, v47
    ds_write_b128 v2, v[48:51] offset:0
    ds_write_b128 v2, v[52:55] offset:1024
    s_waitcnt vmcnt(9)
    s_barrier
    v_add_u32 v8, s56, v4
    v_add_u32 v9, s56, v5
    v_add_u32 v10, s56, v6
    v_add_u32 v11, s56, v7
    ds_read_b128 v[16:19], v8 offset:0
    ds_read_b128 v[20:23], v9 offset:0
    ds_read_b128 v[24:27], v10 offset:0
    s_add_u32 s55, s97, 4096
    ds_read_b128 v[28:31], v11 offset:0
    s_waitcnt lgkmcnt(3)
    v_mfma_f32_32x32x16_bf16 v[32:47], a[0:3], v[16:19], 0
    buffer_load_dwordx4 v[104:107], v12, s[28:31], s55 offen offset:0 sc1
    ds_read_b128 v[16:19], v8 offset:4096
    s_waitcnt lgkmcnt(3)
    v_mfma_f32_32x32x16_bf16 v[32:47], a[4:7], v[20:23], v[32:47]
    ds_read_b128 v[20:23], v9 offset:4096
    s_waitcnt lgkmcnt(3)
    v_mfma_f32_32x32x16_bf16 v[32:47], a[8:11], v[24:27], v[32:47]
    ds_read_b128 v[24:27], v10 offset:4096
    s_waitcnt lgkmcnt(3)
    v_mfma_f32_32x32x16_bf16 v[32:47], a[12:15], v[28:31], v[32:47]
    ds_read_b128 v[28:31], v11 offset:4096
    s_waitcnt lgkmcnt(3)
    v_mfma_f32_32x32x16_bf16 v[32:47], a[16:19], v[16:19], v[32:47]
    buffer_load_dwordx4 v[108:111], v12, s[28:31], s55 offen offset:1024 sc1
    ds_read_b128 v[16:19], v8 offset:8192
    s_waitcnt lgkmcnt(3)
    v_mfma_f32_32x32x16_bf16 v[32:47], a[20:23], v[20:23], v[32:47]
    ds_read_b128 v[20:23], v9 offset:8192
    s_waitcnt lgkmcnt(3)
    v_mfma_f32_32x32x16_bf16 v[32:47], a[24:27], v[24:27], v[32:47]
    ds_read_b128 v[24:27], v10 offset:8192
    s_waitcnt lgkmcnt(3)
    v_mfma_f32_32x32x16_bf16 v[32:47], a[28:31], v[28:31], v[32:47]
    ds_read_b128 v[28:31], v11 offset:8192
    s_waitcnt lgkmcnt(3)
    v_mfma_f32_32x32x16_bf16 v[32:47], a[32:35], v[16:19], v[32:47]
    buffer_load_dwordx4 v[112:115], v12, s[28:31], s55 offen offset:2048 sc1
    ds_read_b128 v[16:19], v8 offset:12288
    s_waitcnt lgkmcnt(3)
    v_mfma_f32_32x32x16_bf16 v[32:47], a[36:39], v[20:23], v[32:47]
    ds_read_b128 v[20:23], v9 offset:12288
    s_waitcnt lgkmcnt(3)
    v_mfma_f32_32x32x16_bf16 v[32:47], a[40:43], v[24:27], v[32:47]
    ds_read_b128 v[24:27], v10 offset:12288
    s_waitcnt lgkmcnt(3)
    v_mfma_f32_32x32x16_bf16 v[32:47], a[44:47], v[28:31], v[32:47]
    ds_read_b128 v[28:31], v11 offset:12288
    s_waitcnt lgkmcnt(3)
    v_mfma_f32_32x32x16_bf16 v[32:47], a[48:51], v[16:19], v[32:47]
    buffer_load_dwordx4 v[116:119], v12, s[28:31], s55 offen offset:3072 sc1
    ds_read_b128 v[16:19], v8 offset:16384
    s_waitcnt lgkmcnt(3)
    v_mfma_f32_32x32x16_bf16 v[32:47], a[52:55], v[20:23], v[32:47]
    ds_read_b128 v[20:23], v9 offset:16384
    s_waitcnt lgkmcnt(3)
    v_mfma_f32_32x32x16_bf16 v[32:47], a[56:59], v[24:27], v[32:47]
    ds_read_b128 v[24:27], v10 offset:16384
    s_waitcnt lgkmcnt(3)
    v_mfma_f32_32x32x16_bf16 v[32:47], a[60:63], v[28:31], v[32:47]
    ds_read_b128 v[28:31], v11 offset:16384
    s_waitcnt lgkmcnt(3)
    v_mfma_f32_32x32x16_bf16 v[32:47], a[64:67], v[16:19], v[32:47]
    s_add_u32 m0, s59, 0
    s_add_u32 s54, s96, 0
    buffer_load_dwordx4 v3, s[8:11], s54 offen lds
    ds_read_b128 v[16:19], v8 offset:20480
    s_waitcnt lgkmcnt(3)
    v_mfma_f32_32x32x16_bf16 v[32:47], a[68:71], v[20:23], v[32:47]
    ds_read_b128 v[20:23], v9 offset:20480
    s_waitcnt lgkmcnt(3)
    v_mfma_f32_32x32x16_bf16 v[32:47], a[72:75], v[24:27], v[32:47]
    s_add_u32 m0, s59, 4096
    s_add_u32 s54, s96, 128
    buffer_load_dwordx4 v3, s[8:11], s54 offen lds
    ds_read_b128 v[24:27], v10 offset:20480
    s_waitcnt lgkmcnt(3)
    v_mfma_f32_32x32x16_bf16 v[32:47], a[76:79], v[28:31], v[32:47]
    ds_read_b128 v[28:31], v11 offset:20480
    s_waitcnt lgkmcnt(3)
    v_mfma_f32_32x32x16_bf16 v[32:47], a[80:83], v[16:19], v[32:47]
    s_add_u32 m0, s59, 8192
    s_add_u32 s54, s96, 256
    buffer_load_dwordx4 v3, s[8:11], s54 offen lds
    ds_read_b128 v[16:19], v8 offset:24576
    s_waitcnt lgkmcnt(3)
    v_mfma_f32_32x32x16_bf16 v[32:47], a[84:87], v[20:23], v[32:47]
    ds_read_b128 v[20:23], v9 offset:24576
    s_waitcnt lgkmcnt(3)
    v_mfma_f32_32x32x16_bf16 v[32:47], a[88:91], v[24:27], v[32:47]
    s_add_u32 m0, s59, 12288
    s_add_u32 s54, s96, 384
    buffer_load_dwordx4 v3, s[8:11], s54 offen lds
    ds_read_b128 v[24:27], v10 offset:24576
    s_waitcnt lgkmcnt(3)
    v_mfma_f32_32x32x16_bf16 v[32:47], a[92:95], v[28:31], v[32:47]
    ds_read_b128 v[28:31], v11 offset:24576
    s_waitcnt lgkmcnt(3)
    v_mfma_f32_32x32x16_bf16 v[32:47], a[96:99], v[16:19], v[32:47]
    s_add_u32 m0, s59, 16384
    s_add_u32 s54, s96, 512
    buffer_load_dwordx4 v3, s[8:11], s54 offen lds
    ds_read_b128 v[16:19], v8 offset:28672
    s_waitcnt lgkmcnt(3)
    v_mfma_f32_32x32x16_bf16 v[32:47], a[100:103], v[20:23], v[32:47]
    ds_read_b128 v[20:23], v9 offset:28672
    s_waitcnt lgkmcnt(3)
    v_mfma_f32_32x32x16_bf16 v[32:47], a[104:107], v[24:27], v[32:47]
    s_add_u32 m0, s59, 20480
    s_add_u32 s54, s96, 640
    buffer_load_dwordx4 v3, s[8:11], s54 offen lds
    ds_read_b128 v[24:27], v10 offset:28672
    s_waitcnt lgkmcnt(3)
    v_mfma_f32_32x32x16_bf16 v[32:47], a[108:111], v[28:31], v[32:47]
    ds_read_b128 v[28:31], v11 offset:28672
    s_waitcnt lgkmcnt(3)
    v_mfma_f32_32x32x16_bf16 v[32:47], a[112:115], v[16:19], v[32:47]
    s_add_u32 m0, s59, 24576
    s_add_u32 s54, s96, 768
    buffer_load_dwordx4 v3, s[8:11], s54 offen lds
    ds_read_b128 v[16:19], v8 offset:32768
    s_waitcnt lgkmcnt(3)
    v_mfma_f32_32x32x16_bf16 v[32:47], a[116:119], v[20:23], v[32:47]
    ds_read_b128 v[20:23], v9 offset:32768
    s_waitcnt lgkmcnt(3)
    v_mfma_f32_32x32x16_bf16 v[32:47], a[120:123], v[24:27], v[32:47]
    s_add_u32 m0, s59, 28672
    s_add_u32 s54, s96, 896
    buffer_load_dwordx4 v3, s[8:11], s54 offen lds
    ds_read_b128 v[24:27], v10 offset:32768
    s_waitcnt lgkmcnt(3)
    v_mfma_f32_32x32x16_bf16 v[32:47], a[124:127], v[28:31], v[32:47]
    ds_read_b128 v[28:31], v11 offset:32768
    s_waitcnt lgkmcnt(3)
    v_mfma_f32_32x32x16_bf16 v[32:47], a[128:131], v[16:19], v[32:47]
    s_add_u32 m0, s59, 32768
    s_add_u32 s54, s96, 1024
    buffer_load_dwordx4 v3, s[8:11], s54 offen lds
    s_waitcnt lgkmcnt(2)
    v_mfma_f32_32x32x16_bf16 v[32:47], a[132:135], v[20:23], v[32:47]
    s_waitcnt lgkmcnt(1)
    v_mfma_f32_32x32x16_bf16 v[32:47], a[136:139], v[24:27], v[32:47]
    s_waitcnt lgkmcnt(0)
    v_mfma_f32_32x32x16_bf16 v[32:47], a[140:143], v[28:31], v[32:47]
    s_add_u32 s96, s96, 36864
    s_add_u32 s59, s59, 36864
    s_cmp_ge_u32 s59, 110592
    s_cselect_b32 s54, 110592, 0
    s_sub_u32 s59, s59, s54
    s_add_u32 s56, s56, 36864
    s_cmp_ge_u32 s56, 110592
    s_cselect_b32 s56, 0, s56
    s_nop 3
    v_cvt_pk_bf16_f32 v48, v32, v33
    v_cvt_pk_bf16_f32 v49, v34, v35
    v_cvt_pk_bf16_f32 v50, v36, v37
    v_cvt_pk_bf16_f32 v51, v38, v39
    v_cvt_pk_bf16_f32 v52, v40, v41
    v_cvt_pk_bf16_f32 v53, v42, v43
    v_cvt_pk_bf16_f32 v54, v44, v45
    v_cvt_pk_bf16_f32 v55, v46, v47
    ds_write_b128 v2, v[48:51] offset:8192
    ds_write_b128 v2, v[52:55] offset:9216
    s_waitcnt vmcnt(9)
    s_barrier
    v_add_u32 v8, s56, v4
    v_add_u32 v9, s56, v5
    v_add_u32 v10, s56, v6
    v_add_u32 v11, s56, v7
    ds_read_b128 v[16:19], v8 offset:0
    ds_read_b128 v[20:23], v9 offset:0
    ds_read_b128 v[24:27], v10 offset:0
    s_add_u32 s55, s97, 8192
    ds_read_b128 v[28:31], v11 offset:0
    s_waitcnt lgkmcnt(3)
    v_mfma_f32_32x32x16_bf16 v[32:47], a[0:3], v[16:19], 0
    buffer_load_dwordx4 v[120:123], v12, s[28:31], s55 offen offset:0 sc1
    ds_read_b128 v[16:19], v8 offset:4096
    s_waitcnt lgkmcnt(3)
    v_mfma_f32_32x32x16_bf16 v[32:47], a[4:7], v[20:23], v[32:47]
    ds_read_b128 v[20:23], v9 offset:4096
    s_waitcnt lgkmcnt(3)
    v_mfma_f32_32x32x16_bf16 v[32:47], a[8:11], v[24:27], v[32:47]
    ds_read_b128 v[24:27], v10 offset:4096
    s_waitcnt lgkmcnt(3)
    v_mfma_f32_32x32x16_bf16 v[32:47], a[12:15], v[28:31], v[32:47]
    ds_read_b128 v[28:31], v11 offset:4096
    s_waitcnt lgkmcnt(3)
    v_mfma_f32_32x32x16_bf16 v[32:47], a[16:19], v[16:19], v[32:47]
    buffer_load_dwordx4 v[124:127], v12, s[28:31], s55 offen offset:1024 sc1
    ds_read_b128 v[16:19], v8 offset:8192
    s_waitcnt lgkmcnt(3)
    v_mfma_f32_32x32x16_bf16 v[32:47], a[20:23], v[20:23], v[32:47]
    ds_read_b128 v[20:23], v9 offset:8192
    s_waitcnt lgkmcnt(3)
    v_mfma_f32_32x32x16_bf16 v[32:47], a[24:27], v[24:27], v[32:47]
    ds_read_b128 v[24:27], v10 offset:8192
    s_waitcnt lgkmcnt(3)
    v_mfma_f32_32x32x16_bf16 v[32:47], a[28:31], v[28:31], v[32:47]
    ds_read_b128 v[28:31], v11 offset:8192
    s_waitcnt lgkmcnt(3)
    v_mfma_f32_32x32x16_bf16 v[32:47], a[32:35], v[16:19], v[32:47]
    buffer_load_dwordx4 v[128:131], v12, s[28:31], s55 offen offset:2048 sc1
    ds_read_b128 v[16:19], v8 offset:12288
    s_waitcnt lgkmcnt(3)
    v_mfma_f32_32x32x16_bf16 v[32:47], a[36:39], v[20:23], v[32:47]
    ds_read_b128 v[20:23], v9 offset:12288
    s_waitcnt lgkmcnt(3)
    v_mfma_f32_32x32x16_bf16 v[32:47], a[40:43], v[24:27], v[32:47]
    ds_read_b128 v[24:27], v10 offset:12288
    s_waitcnt lgkmcnt(3)
    v_mfma_f32_32x32x16_bf16 v[32:47], a[44:47], v[28:31], v[32:47]
    ds_read_b128 v[28:31], v11 offset:12288
    s_waitcnt lgkmcnt(3)
    v_mfma_f32_32x32x16_bf16 v[32:47], a[48:51], v[16:19], v[32:47]
    buffer_load_dwordx4 v[132:135], v12, s[28:31], s55 offen offset:3072 sc1
    ds_read_b128 v[16:19], v8 offset:16384
    s_waitcnt lgkmcnt(3)
    v_mfma_f32_32x32x16_bf16 v[32:47], a[52:55], v[20:23], v[32:47]
    ds_read_b128 v[20:23], v9 offset:16384
    s_waitcnt lgkmcnt(3)
    v_mfma_f32_32x32x16_bf16 v[32:47], a[56:59], v[24:27], v[32:47]
    ds_read_b128 v[24:27], v10 offset:16384
    s_waitcnt lgkmcnt(3)
    v_mfma_f32_32x32x16_bf16 v[32:47], a[60:63], v[28:31], v[32:47]
    ds_read_b128 v[28:31], v11 offset:16384
    s_waitcnt lgkmcnt(3)
    v_mfma_f32_32x32x16_bf16 v[32:47], a[64:67], v[16:19], v[32:47]
    s_add_u32 m0, s59, 0
    s_add_u32 s54, s96, 0
    buffer_load_dwordx4 v3, s[8:11], s54 offen lds
    ds_read_b128 v[16:19], v8 offset:20480
    s_waitcnt lgkmcnt(3)
    v_mfma_f32_32x32x16_bf16 v[32:47], a[68:71], v[20:23], v[32:47]
    ds_read_b128 v[20:23], v9 offset:20480
    s_waitcnt lgkmcnt(3)
    v_mfma_f32_32x32x16_bf16 v[32:47], a[72:75], v[24:27], v[32:47]
    s_add_u32 m0, s59, 4096
    s_add_u32 s54, s96, 128
    buffer_load_dwordx4 v3, s[8:11], s54 offen lds
    ds_read_b128 v[24:27], v10 offset:20480
    s_waitcnt lgkmcnt(3)
    v_mfma_f32_32x32x16_bf16 v[32:47], a[76:79], v[28:31], v[32:47]
    ds_read_b128 v[28:31], v11 offset:20480
    s_waitcnt lgkmcnt(3)
    v_mfma_f32_32x32x16_bf16 v[32:47], a[80:83], v[16:19], v[32:47]
    s_add_u32 m0, s59, 8192
    s_add_u32 s54, s96, 256
    buffer_load_dwordx4 v3, s[8:11], s54 offen lds
    ds_read_b128 v[16:19], v8 offset:24576
    s_waitcnt lgkmcnt(3)
    v_mfma_f32_32x32x16_bf16 v[32:47], a[84:87], v[20:23], v[32:47]
    ds_read_b128 v[20:23], v9 offset:24576
    s_waitcnt lgkmcnt(3)
    v_mfma_f32_32x32x16_bf16 v[32:47], a[88:91], v[24:27], v[32:47]
    s_add_u32 m0, s59, 12288
    s_add_u32 s54, s96, 384
    buffer_load_dwordx4 v3, s[8:11], s54 offen lds
    ds_read_b128 v[24:27], v10 offset:24576
    s_waitcnt lgkmcnt(3)
    v_mfma_f32_32x32x16_bf16 v[32:47], a[92:95], v[28:31], v[32:47]
    ds_read_b128 v[28:31], v11 offset:24576
    s_waitcnt lgkmcnt(3)
    v_mfma_f32_32x32x16_bf16 v[32:47], a[96:99], v[16:19], v[32:47]
    s_add_u32 m0, s59, 16384
    s_add_u32 s54, s96, 512
    buffer_load_dwordx4 v3, s[8:11], s54 offen lds
    ds_read_b128 v[16:19], v8 offset:28672
    s_waitcnt lgkmcnt(3)
    v_mfma_f32_32x32x16_bf16 v[32:47], a[100:103], v[20:23], v[32:47]
    ds_read_b128 v[20:23], v9 offset:28672
    s_waitcnt lgkmcnt(3)
    v_mfma_f32_32x32x16_bf16 v[32:47], a[104:107], v[24:27], v[32:47]
    s_add_u32 m0, s59, 20480
    s_add_u32 s54, s96, 640
    buffer_load_dwordx4 v3, s[8:11], s54 offen lds
    ds_read_b128 v[24:27], v10 offset:28672
    s_waitcnt lgkmcnt(3)
    v_mfma_f32_32x32x16_bf16 v[32:47], a[108:111], v[28:31], v[32:47]
    ds_read_b128 v[28:31], v11 offset:28672
    s_waitcnt lgkmcnt(3)
    v_mfma_f32_32x32x16_bf16 v[32:47], a[112:115], v[16:19], v[32:47]
    s_add_u32 m0, s59, 24576
    s_add_u32 s54, s96, 768
    buffer_load_dwordx4 v3, s[8:11], s54 offen lds
    ds_read_b128 v[16:19], v8 offset:32768
    s_waitcnt lgkmcnt(3)
    v_mfma_f32_32x32x16_bf16 v[32:47], a[116:119], v[20:23], v[32:47]
    ds_read_b128 v[20:23], v9 offset:32768
    s_waitcnt lgkmcnt(3)
    v_mfma_f32_32x32x16_bf16 v[32:47], a[120:123], v[24:27], v[32:47]
    s_add_u32 m0, s59, 28672
    s_add_u32 s54, s96, 896
    buffer_load_dwordx4 v3, s[8:11], s54 offen lds
    ds_read_b128 v[24:27], v10 offset:32768
    s_waitcnt lgkmcnt(3)
    v_mfma_f32_32x32x16_bf16 v[32:47], a[124:127], v[28:31], v[32:47]
    ds_read_b128 v[28:31], v11 offset:32768
    s_waitcnt lgkmcnt(3)
    v_mfma_f32_32x32x16_bf16 v[32:47], a[128:131], v[16:19], v[32:47]
    s_add_u32 m0, s59, 32768
    s_add_u32 s54, s96, 1024
    buffer_load_dwordx4 v3, s[8:11], s54 offen lds
    s_waitcnt lgkmcnt(2)
    v_mfma_f32_32x32x16_bf16 v[32:47], a[132:135], v[20:23], v[32:47]
    s_waitcnt lgkmcnt(1)
    v_mfma_f32_32x32x16_bf16 v[32:47], a[136:139], v[24:27], v[32:47]
    s_waitcnt lgkmcnt(0)
    v_mfma_f32_32x32x16_bf16 v[32:47], a[140:143], v[28:31], v[32:47]
    s_add_u32 s96, s96, 36864
    s_add_u32 s59, s59, 36864
    s_cmp_ge_u32 s59, 110592
    s_cselect_b32 s54, 110592, 0
    s_sub_u32 s59, s59, s54
    s_add_u32 s56, s56, 36864
    s_cmp_ge_u32 s56, 110592
    s_cselect_b32 s56, 0, s56
    s_nop 3
    v_cvt_pk_bf16_f32 v48, v32, v33
    v_cvt_pk_bf16_f32 v49, v34, v35
    v_cvt_pk_bf16_f32 v50, v36, v37
    v_cvt_pk_bf16_f32 v51, v38, v39
    v_cvt_pk_bf16_f32 v52, v40, v41
    v_cvt_pk_bf16_f32 v53, v42, v43
    v_cvt_pk_bf16_f32 v54, v44, v45
    v_cvt_pk_bf16_f32 v55, v46, v47
    ds_write_b128 v2, v[48:51] offset:16384
    ds_write_b128 v2, v[52:55] offset:17408
    s_waitcnt vmcnt(9)
    s_barrier
    v_add_u32 v8, s56, v4
    v_add_u32 v9, s56, v5
    v_add_u32 v10, s56, v6
    v_add_u32 v11, s56, v7
    ds_read_b128 v[16:19], v8 offset:0
    ds_read_b128 v[20:23], v9 offset:0
    ds_read_b128 v[24:27], v10 offset:0
    s_add_u32 s55, s97, 12288
    ds_read_b128 v[28:31], v11 offset:0
    s_waitcnt lgkmcnt(3)
    v_mfma_f32_32x32x16_bf16 v[32:47], a[0:3], v[16:19], 0
    buffer_load_dwordx4 v[136:139], v12, s[28:31], s55 offen offset:0 sc1
    ds_read_b128 v[16:19], v8 offset:4096
    s_waitcnt lgkmcnt(3)
    v_mfma_f32_32x32x16_bf16 v[32:47], a[4:7], v[20:23], v[32:47]
    ds_read_b128 v[20:23], v9 offset:4096
    s_waitcnt lgkmcnt(3)
    v_mfma_f32_32x32x16_bf16 v[32:47], a[8:11], v[24:27], v[32:47]
    ds_read_b128 v[24:27], v10 offset:4096
    s_waitcnt lgkmcnt(3)
    v_mfma_f32_32x32x16_bf16 v[32:47], a[12:15], v[28:31], v[32:47]
    ds_read_b128 v[28:31], v11 offset:4096
    s_waitcnt lgkmcnt(3)
    v_mfma_f32_32x32x16_bf16 v[32:47], a[16:19], v[16:19], v[32:47]
    buffer_load_dwordx4 v[140:143], v12, s[28:31], s55 offen offset:1024 sc1
    ds_read_b128 v[16:19], v8 offset:8192
    s_waitcnt lgkmcnt(3)
    v_mfma_f32_32x32x16_bf16 v[32:47], a[20:23], v[20:23], v[32:47]
    ds_read_b128 v[20:23], v9 offset:8192
    s_waitcnt lgkmcnt(3)
    v_mfma_f32_32x32x16_bf16 v[32:47], a[24:27], v[24:27], v[32:47]
    ds_read_b128 v[24:27], v10 offset:8192
    s_waitcnt lgkmcnt(3)
    v_mfma_f32_32x32x16_bf16 v[32:47], a[28:31], v[28:31], v[32:47]
    ds_read_b128 v[28:31], v11 offset:8192
    s_waitcnt lgkmcnt(3)
    v_mfma_f32_32x32x16_bf16 v[32:47], a[32:35], v[16:19], v[32:47]
    buffer_load_dwordx4 v[144:147], v12, s[28:31], s55 offen offset:2048 sc1
    ds_read_b128 v[16:19], v8 offset:12288
    s_waitcnt lgkmcnt(3)
    v_mfma_f32_32x32x16_bf16 v[32:47], a[36:39], v[20:23], v[32:47]
    ds_read_b128 v[20:23], v9 offset:12288
    s_waitcnt lgkmcnt(3)
    v_mfma_f32_32x32x16_bf16 v[32:47], a[40:43], v[24:27], v[32:47]
    ds_read_b128 v[24:27], v10 offset:12288
    s_waitcnt lgkmcnt(3)
    v_mfma_f32_32x32x16_bf16 v[32:47], a[44:47], v[28:31], v[32:47]
    ds_read_b128 v[28:31], v11 offset:12288
    s_waitcnt lgkmcnt(3)
    v_mfma_f32_32x32x16_bf16 v[32:47], a[48:51], v[16:19], v[32:47]
    buffer_load_dwordx4 v[148:151], v12, s[28:31], s55 offen offset:3072 sc1
    ds_read_b128 v[16:19], v8 offset:16384
    s_waitcnt lgkmcnt(3)
    v_mfma_f32_32x32x16_bf16 v[32:47], a[52:55], v[20:23], v[32:47]
    ds_read_b128 v[20:23], v9 offset:16384
    s_waitcnt lgkmcnt(3)
    v_mfma_f32_32x32x16_bf16 v[32:47], a[56:59], v[24:27], v[32:47]
    ds_read_b128 v[24:27], v10 offset:16384
    s_waitcnt lgkmcnt(3)
    v_mfma_f32_32x32x16_bf16 v[32:47], a[60:63], v[28:31], v[32:47]
    ds_read_b128 v[28:31], v11 offset:16384
    s_waitcnt lgkmcnt(3)
    v_mfma_f32_32x32x16_bf16 v[32:47], a[64:67], v[16:19], v[32:47]
    s_add_u32 m0, s59, 0
    s_add_u32 s54, s96, 0
    buffer_load_dwordx4 v3, s[8:11], s54 offen lds
    ds_read_b128 v[16:19], v8 offset:20480
    s_waitcnt lgkmcnt(3)
    v_mfma_f32_32x32x16_bf16 v[32:47], a[68:71], v[20:23], v[32:47]
    ds_read_b128 v[20:23], v9 offset:20480
    s_waitcnt lgkmcnt(3)
    v_mfma_f32_32x32x16_bf16 v[32:47], a[72:75], v[24:27], v[32:47]
    s_add_u32 m0, s59, 4096
    s_add_u32 s54, s96, 128
    buffer_load_dwordx4 v3, s[8:11], s54 offen lds
    ds_read_b128 v[24:27], v10 offset:20480
    s_waitcnt lgkmcnt(3)
    v_mfma_f32_32x32x16_bf16 v[32:47], a[76:79], v[28:31], v[32:47]
    ds_read_b128 v[28:31], v11 offset:20480
    s_waitcnt lgkmcnt(3)
    v_mfma_f32_32x32x16_bf16 v[32:47], a[80:83], v[16:19], v[32:47]
    s_add_u32 m0, s59, 8192
    s_add_u32 s54, s96, 256
    buffer_load_dwordx4 v3, s[8:11], s54 offen lds
    ds_read_b128 v[16:19], v8 offset:24576
    s_waitcnt lgkmcnt(3)
    v_mfma_f32_32x32x16_bf16 v[32:47], a[84:87], v[20:23], v[32:47]
    ds_read_b128 v[20:23], v9 offset:24576
    s_waitcnt lgkmcnt(3)
    v_mfma_f32_32x32x16_bf16 v[32:47], a[88:91], v[24:27], v[32:47]
    s_add_u32 m0, s59, 12288
    s_add_u32 s54, s96, 384
    buffer_load_dwordx4 v3, s[8:11], s54 offen lds
    ds_read_b128 v[24:27], v10 offset:24576
    s_waitcnt lgkmcnt(3)
    v_mfma_f32_32x32x16_bf16 v[32:47], a[92:95], v[28:31], v[32:47]
    ds_read_b128 v[28:31], v11 offset:24576
    s_waitcnt lgkmcnt(3)
    v_mfma_f32_32x32x16_bf16 v[32:47], a[96:99], v[16:19], v[32:47]
    s_add_u32 m0, s59, 16384
    s_add_u32 s54, s96, 512
    buffer_load_dwordx4 v3, s[8:11], s54 offen lds
    ds_read_b128 v[16:19], v8 offset:28672
    s_waitcnt lgkmcnt(3)
    v_mfma_f32_32x32x16_bf16 v[32:47], a[100:103], v[20:23], v[32:47]
    ds_read_b128 v[20:23], v9 offset:28672
    s_waitcnt lgkmcnt(3)
    v_mfma_f32_32x32x16_bf16 v[32:47], a[104:107], v[24:27], v[32:47]
    s_add_u32 m0, s59, 20480
    s_add_u32 s54, s96, 640
    buffer_load_dwordx4 v3, s[8:11], s54 offen lds
    ds_read_b128 v[24:27], v10 offset:28672
    s_waitcnt lgkmcnt(3)
    v_mfma_f32_32x32x16_bf16 v[32:47], a[108:111], v[28:31], v[32:47]
    ds_read_b128 v[28:31], v11 offset:28672
    s_waitcnt lgkmcnt(3)
    v_mfma_f32_32x32x16_bf16 v[32:47], a[112:115], v[16:19], v[32:47]
    s_add_u32 m0, s59, 24576
    s_add_u32 s54, s96, 768
    buffer_load_dwordx4 v3, s[8:11], s54 offen lds
    ds_read_b128 v[16:19], v8 offset:32768
    s_waitcnt lgkmcnt(3)
    v_mfma_f32_32x32x16_bf16 v[32:47], a[116:119], v[20:23], v[32:47]
    ds_read_b128 v[20:23], v9 offset:32768
    s_waitcnt lgkmcnt(3)
    v_mfma_f32_32x32x16_bf16 v[32:47], a[120:123], v[24:27], v[32:47]
    s_add_u32 m0, s59, 28672
    s_add_u32 s54, s96, 896
    buffer_load_dwordx4 v3, s[8:11], s54 offen lds
    ds_read_b128 v[24:27], v10 offset:32768
    s_waitcnt lgkmcnt(3)
    v_mfma_f32_32x32x16_bf16 v[32:47], a[124:127], v[28:31], v[32:47]
    ds_read_b128 v[28:31], v11 offset:32768
    s_waitcnt lgkmcnt(3)
    v_mfma_f32_32x32x16_bf16 v[32:47], a[128:131], v[16:19], v[32:47]
    s_add_u32 m0, s59, 32768
    s_add_u32 s54, s96, 1024
    buffer_load_dwordx4 v3, s[8:11], s54 offen lds
    s_waitcnt lgkmcnt(2)
    v_mfma_f32_32x32x16_bf16 v[32:47], a[132:135], v[20:23], v[32:47]
    s_waitcnt lgkmcnt(1)
    v_mfma_f32_32x32x16_bf16 v[32:47], a[136:139], v[24:27], v[32:47]
    s_waitcnt lgkmcnt(0)
    v_mfma_f32_32x32x16_bf16 v[32:47], a[140:143], v[28:31], v[32:47]
    s_add_u32 s96, s96, 36864
    s_add_u32 s59, s59, 36864
    s_cmp_ge_u32 s59, 110592
    s_cselect_b32 s54, 110592, 0
    s_sub_u32 s59, s59, s54
    s_add_u32 s56, s56, 36864
    s_cmp_ge_u32 s56, 110592
    s_cselect_b32 s56, 0, s56
    s_nop 3
    v_cvt_pk_bf16_f32 v48, v32, v33
    v_cvt_pk_bf16_f32 v49, v34, v35
    v_cvt_pk_bf16_f32 v50, v36, v37
    v_cvt_pk_bf16_f32 v51, v38, v39
    v_cvt_pk_bf16_f32 v52, v40, v41
    v_cvt_pk_bf16_f32 v53, v42, v43
    v_cvt_pk_bf16_f32 v54, v44, v45
    v_cvt_pk_bf16_f32 v55, v46, v47
    ds_write_b128 v2, v[48:51] offset:24576
    ds_write_b128 v2, v[52:55] offset:25600
    s_waitcnt lgkmcnt(0)
    s_barrier
    s_waitcnt vmcnt(9)
    s_branch L_b_att_139
L_b_lastb_138:
    s_add_u32 s55, s97, 0
    buffer_load_dwordx4 v[88:91], v12, s[28:31], s55 offen offset:0 sc1
    buffer_load_dwordx4 v[92:95], v12, s[28:31], s55 offen offset:1024 sc1
    buffer_load_dwordx4 v[96:99], v12, s[28:31], s55 offen offset:2048 sc1
    buffer_load_dwordx4 v[100:103], v12, s[28:31], s55 offen offset:3072 sc1
    s_add_u32 s55, s97, 4096
    buffer_load_dwordx4 v[104:107], v12, s[28:31], s55 offen offset:0 sc1
    buffer_load_dwordx4 v[108:111], v12, s[28:31], s55 offen offset:1024 sc1
    buffer_load_dwordx4 v[112:115], v12, s[28:31], s55 offen offset:2048 sc1
    buffer_load_dwordx4 v[116:119], v12, s[28:31], s55 offen offset:3072 sc1
    s_add_u32 s55, s97, 8192
    buffer_load_dwordx4 v[120:123], v12, s[28:31], s55 offen offset:0 sc1
    buffer_load_dwordx4 v[124:127], v12, s[28:31], s55 offen offset:1024 sc1
    buffer_load_dwordx4 v[128:131], v12, s[28:31], s55 offen offset:2048 sc1
    buffer_load_dwordx4 v[132:135], v12, s[28:31], s55 offen offset:3072 sc1
    s_add_u32 s55, s97, 12288
    buffer_load_dwordx4 v[136:139], v12, s[28:31], s55 offen offset:0 sc1
    buffer_load_dwordx4 v[140:143], v12, s[28:31], s55 offen offset:1024 sc1
    buffer_load_dwordx4 v[144:147], v12, s[28:31], s55 offen offset:2048 sc1
    buffer_load_dwordx4 v[148:151], v12, s[28:31], s55 offen offset:3072 sc1
    buffer_load_dword v15, v1, s[28:31], s95 offen sc1
    s_waitcnt vmcnt(0)
L_b_att_139:
    v_mfma_f32_32x32x16_bf16 v[192:207], v[88:91], v[56:59], 0
    v_mfma_f32_32x32x16_bf16 v[192:207], v[92:95], v[60:63], v[192:207]
    v_mfma_f32_32x32x16_bf16 v[192:207], v[96:99], v[64:67], v[192:207]
    v_mfma_f32_32x32x16_bf16 v[192:207], v[100:103], v[68:71], v[192:207]
    v_mfma_f32_32x32x16_bf16 v[192:207], v[104:107], v[72:75], v[192:207]
    v_mfma_f32_32x32x16_bf16 v[192:207], v[108:111], v[76:79], v[192:207]
    v_mfma_f32_32x32x16_bf16 v[192:207], v[112:115], v[80:83], v[192:207]
    v_mfma_f32_32x32x16_bf16 v[192:207], v[116:119], v[84:87], v[192:207]
    v_mov_b32 v48, s101
    s_nop 10
    v_cndmask_b32 v192, v48, v192, s[60:61]
    v_cndmask_b32 v193, v48, v193, s[62:63]
    v_cndmask_b32 v194, v48, v194, s[64:65]
    v_cndmask_b32 v195, v48, v195, s[66:67]
    v_cndmask_b32 v196, v48, v196, s[68:69]
    v_cndmask_b32 v197, v48, v197, s[70:71]
    v_cndmask_b32 v198, v48, v198, s[72:73]
    v_cndmask_b32 v199, v48, v199, s[74:75]
    v_cndmask_b32 v200, v48, v200, s[76:77]
    v_cndmask_b32 v201, v48, v201, s[78:79]
    v_cndmask_b32 v202, v48, v202, s[80:81]
    v_cndmask_b32 v203, v48, v203, s[82:83]
    v_cndmask_b32 v204, v48, v204, s[84:85]
    v_cndmask_b32 v205, v48, v205, s[86:87]
    v_cndmask_b32 v206, v48, v206, s[88:89]
    v_cndmask_b32 v207, v48, v207, s[90:91]
    v_max3_f32 v32, v192, v193, v194
    v_max3_f32 v32, v32, v195, v196
    v_max3_f32 v32, v32, v197, v198
    v_max3_f32 v32, v32, v199, v200
    v_max3_f32 v32, v32, v201, v202
    v_max3_f32 v32, v32, v203, v204
    v_max3_f32 v32, v32, v205, v206
    v_max_f32 v32, v32, v207
    s_lshl_b32 s52, s47, 2
    s_add_u32 s52, s52, s51
    s_lshl_b32 s52, s52, 7
    s_add_u32 s54, s52, 140673024
L_sw_143:
    s_buffer_load_dword s53, s[28:31], s54 glc
    s_waitcnt lgkmcnt(0)
    s_cmp_gt_u32 s53, s57
    s_cbranch_scc1 L_sw_ok_144
    s_sleep 1
    s_sub_u32 s99, s99, 1
    s_cmp_lg_u32 s99, 0
    s_cbranch_scc1 L_sw_143
    s_branch L_exit
L_sw_ok_144:
    buffer_load_dwordx4 v[152:155], v13, s[28:31], s94 offen offset:0 sc1
    buffer_load_dwordx4 v[156:159], v13, s[28:31], s94 offen offset:256 sc1
    buffer_load_dwordx4 v[160:163], v13, s[28:31], s94 offen offset:512 sc1
    buffer_load_dwordx4 v[164:167], v13, s[28:31], s94 offen offset:768 sc1
    buffer_load_dwordx4 v[168:171], v13, s[28:31], s94 offen offset:1024 sc1
    buffer_load_dwordx4 v[172:175], v13, s[28:31], s94 offen offset:1280 sc1
    buffer_load_dwordx4 v[176:179], v13, s[28:31], s94 offen offset:1536 sc1
    buffer_load_dwordx4 v[180:183], v13, s[28:31], s94 offen offset:1792 sc1
    s_add_u32 s52, s94, 4096
    buffer_load_dword v184, v14, s[28:31], s52 offen offset:0 sc1
    buffer_load_dword v185, v14, s[28:31], s52 offen offset:128 sc1
    buffer_load_dword v186, v14, s[28:31], s52 offen offset:512 sc1
    buffer_load_dword v187, v14, s[28:31], s52 offen offset:640 sc1
    buffer_load_dword v188, v14, s[28:31], s52 offen offset:1024 sc1
    buffer_load_dword v189, v14, s[28:31], s52 offen offset:1152 sc1
    buffer_load_dword v190, v14, s[28:31], s52 offen offset:1536 sc1
    buffer_load_dword v191, v14, s[28:31], s52 offen offset:1664 sc1
    s_waitcnt vmcnt(15)
    v_mfma_f32_32x32x16_bf16 v[208:223], v[152:155], v[56:59], 0
    s_waitcnt vmcnt(14)
    v_mfma_f32_32x32x16_bf16 v[208:223], v[156:159], v[60:63], v[208:223]
    s_waitcnt vmcnt(13)
    v_mfma_f32_32x32x16_bf16 v[208:223], v[160:163], v[64:67], v[208:223]
    s_waitcnt vmcnt(12)
    v_mfma_f32_32x32x16_bf16 v[208:223], v[164:167], v[68:71], v[208:223]
    s_waitcnt vmcnt(11)
    v_mfma_f32_32x32x16_bf16 v[208:223], v[168:171], v[72:75], v[208:223]
    s_waitcnt vmcnt(10)
    v_mfma_f32_32x32x16_bf16 v[208:223], v[172:175], v[76:79], v[208:223]
    s_waitcnt vmcnt(9)
    v_mfma_f32_32x32x16_bf16 v[208:223], v[176:179], v[80:83], v[208:223]
    s_waitcnt vmcnt(8)
    v_mfma_f32_32x32x16_bf16 v[208:223], v[180:183], v[84:87], v[208:223]
    s_nop 11
    v_max3_f32 v32, v32, v208, v209
    v_max3_f32 v32, v32, v210, v211
    v_mov_b32 v33, v32
    s_nop 1
    v_permlane32_swap_b32 v32, v33
    v_max_f32 v32, v32, v33
    v_mul_f32 v32, s100, v32
    v_fma_f32 v192, v192, s100, -v32
    v_fma_f32 v193, v193, s100, -v32
    v_fma_f32 v194, v194, s100, -v32
    v_fma_f32 v195, v195, s100, -v32
    v_fma_f32 v196, v196, s100, -v32
    v_fma_f32 v197, v197, s100, -v32
    v_fma_f32 v198, v198, s100, -v32
    v_fma_f32 v199, v199, s100, -v32
    v_fma_f32 v200, v200, s100, -v32
    v_fma_f32 v201, v201, s100, -v32
    v_fma_f32 v202, v202, s100, -v32
    v_fma_f32 v203, v203, s100, -v32
    v_fma_f32 v204, v204, s100, -v32
    v_fma_f32 v205, v205, s100, -v32
    v_fma_f32 v206, v206, s100, -v32
    v_fma_f32 v207, v207, s100, -v32
    v_fma_f32 v208, v208, s100, -v32
    v_fma_f32 v209, v209, s100, -v32
    v_fma_f32 v210, v210, s100, -v32
    v_fma_f32 v211, v211, s100, -v32
    v_exp_f32 v192, v192
    v_exp_f32 v193, v193
    v_exp_f32 v194, v194
    v_exp_f32 v195, v195
    v_exp_f32 v196, v196
    v_exp_f32 v197, v197
    v_exp_f32 v198, v198
    v_exp_f32 v199, v199
    v_exp_f32 v200, v200
    v_exp_f32 v201, v201
    v_exp_f32 v202, v202
    v_exp_f32 v203, v203
    v_exp_f32 v204, v204
    v_exp_f32 v205, v205
    v_exp_f32 v206, v206
    v_exp_f32 v207, v207
    v_exp_f32 v208, v208
    v_exp_f32 v209, v209
    v_exp_f32 v210, v210
    v_exp_f32 v211, v211
    v_cvt_pk_bf16_f32 v36, v192, v193
    v_cvt_pk_bf16_f32 v37, v194, v195
    v_cvt_pk_bf16_f32 v38, v196, v197
    v_cvt_pk_bf16_f32 v39, v198, v199
    v_cvt_pk_bf16_f32 v40, v200, v201
    v_cvt_pk_bf16_f32 v41, v202, v203
    v_cvt_pk_bf16_f32 v42, v204, v205
    v_cvt_pk_bf16_f32 v43, v206, v207
    v_cvt_pk_bf16_f32 v44, v208, v209
    v_cvt_pk_bf16_f32 v45, v210, v211
    s_waitcnt vmcnt(0)
    s_nop 0
    v_mfma_f32_32x32x8_bf16 v[224:239], v[184:185], v[44:45], 0
    v_mfma_f32_32x32x8_bf16 v[240:255], v[186:187], v[44:45], 0
    v_mfma_f32_32x32x8_bf16 v[88:103], v[188:189], v[44:45], 0
    v_mfma_f32_32x32x8_bf16 v[104:119], v[190:191], v[44:45], 0
    v_add_f32 v34, v192, v193
    v_add_f32 v35, v194, v195
    v_add_f32 v34, v34, v196
    v_add_f32 v35, v35, v197
    v_add_f32 v34, v34, v198
    v_add_f32 v35, v35, v199
    v_add_f32 v34, v34, v200
    v_add_f32 v35, v35, v201
    v_add_f32 v34, v34, v202
    v_add_f32 v35, v35, v203
    v_add_f32 v34, v34, v204
    v_add_f32 v35, v35, v205
    v_add_f32 v34, v34, v206
    v_add_f32 v35, v35, v207
    v_add_f32 v34, v34, v208
    v_add_f32 v35, v35, v209
    v_add_f32 v34, v34, v210
    v_add_f32 v35, v35, v211
    v_mfma_f32_32x32x16_bf16 v[224:239], v[120:123], v[36:39], v[224:239]
    v_mfma_f32_32x32x16_bf16 v[224:239], v[124:127], v[40:43], v[224:239]
    v_mfma_f32_32x32x16_bf16 v[240:255], v[128:131], v[36:39], v[240:255]
    v_mfma_f32_32x32x16_bf16 v[240:255], v[132:135], v[40:43], v[240:255]
    v_mfma_f32_32x32x16_bf16 v[88:103], v[136:139], v[36:39], v[88:103]
    v_mfma_f32_32x32x16_bf16 v[88:103], v[140:143], v[40:43], v[88:103]
    v_mfma_f32_32x32x16_bf16 v[104:119], v[144:147], v[36:39], v[104:119]
    v_mfma_f32_32x32x16_bf16 v[104:119], v[148:151], v[40:43], v[104:119]
    v_add_f32 v34, v34, v35
    v_mov_b32 v35, v34
    s_nop 1
    v_permlane32_swap_b32 v34, v35
    v_add_f32 v34, v34, v35
    v_rcp_f32 v34, v34
    v_sub_f32 v35, 1.0, v15
    s_cmp_eq_u32 s49, 0
    s_cselect_b64 vcc, -1, 0
    v_cndmask_b32 v35, v35, v15, vcc
    v_mul_f32 v34, v34, v35
    s_add_u32 s52, s93, 4096
    v_mul_f32 v224, v224, v34
    v_mul_f32 v225, v225, v34
    v_mul_f32 v226, v226, v34
    v_mul_f32 v227, v227, v34
    v_mul_f32 v228, v228, v34
    v_mul_f32 v229, v229, v34
    v_mul_f32 v230, v230, v34
    v_mul_f32 v231, v231, v34
    v_mul_f32 v232, v232, v34
    v_mul_f32 v233, v233, v34
    v_mul_f32 v234, v234, v34
    v_mul_f32 v235, v235, v34
    v_mul_f32 v236, v236, v34
    v_mul_f32 v237, v237, v34
    v_mul_f32 v238, v238, v34
    v_mul_f32 v239, v239, v34
    v_cvt_pk_bf16_f32 v224, v224, v225
    v_cvt_pk_bf16_f32 v225, v226, v227
    v_cvt_pk_bf16_f32 v226, v228, v229
    v_cvt_pk_bf16_f32 v227, v230, v231
    v_cvt_pk_bf16_f32 v228, v232, v233
    v_cvt_pk_bf16_f32 v229, v234, v235
    v_cvt_pk_bf16_f32 v230, v236, v237
    v_cvt_pk_bf16_f32 v231, v238, v239
    buffer_store_dwordx4 v[224:227], v12, s[28:31], s93 offen offset:0 sc1
    buffer_store_dwordx4 v[228:231], v12, s[28:31], s93 offen offset:1024 sc1
    v_mul_f32 v240, v240, v34
    v_mul_f32 v241, v241, v34
    v_mul_f32 v242, v242, v34
    v_mul_f32 v243, v243, v34
    v_mul_f32 v244, v244, v34
    v_mul_f32 v245, v245, v34
    v_mul_f32 v246, v246, v34
    v_mul_f32 v247, v247, v34
    v_mul_f32 v248, v248, v34
    v_mul_f32 v249, v249, v34
    v_mul_f32 v250, v250, v34
    v_mul_f32 v251, v251, v34
    v_mul_f32 v252, v252, v34
    v_mul_f32 v253, v253, v34
    v_mul_f32 v254, v254, v34
    v_mul_f32 v255, v255, v34
    v_cvt_pk_bf16_f32 v240, v240, v241
    v_cvt_pk_bf16_f32 v241, v242, v243
    v_cvt_pk_bf16_f32 v242, v244, v245
    v_cvt_pk_bf16_f32 v243, v246, v247
    v_cvt_pk_bf16_f32 v244, v248, v249
    v_cvt_pk_bf16_f32 v245, v250, v251
    v_cvt_pk_bf16_f32 v246, v252, v253
    v_cvt_pk_bf16_f32 v247, v254, v255
    buffer_store_dwordx4 v[240:243], v12, s[28:31], s93 offen offset:2048 sc1
    buffer_store_dwordx4 v[244:247], v12, s[28:31], s93 offen offset:3072 sc1
    v_mul_f32 v88, v88, v34
    v_mul_f32 v89, v89, v34
    v_mul_f32 v90, v90, v34
    v_mul_f32 v91, v91, v34
    v_mul_f32 v92, v92, v34
    v_mul_f32 v93, v93, v34
    v_mul_f32 v94, v94, v34
    v_mul_f32 v95, v95, v34
    v_mul_f32 v96, v96, v34
    v_mul_f32 v97, v97, v34
    v_mul_f32 v98, v98, v34
    v_mul_f32 v99, v99, v34
    v_mul_f32 v100, v100, v34
    v_mul_f32 v101, v101, v34
    v_mul_f32 v102, v102, v34
    v_mul_f32 v103, v103, v34
    v_cvt_pk_bf16_f32 v88, v88, v89
    v_cvt_pk_bf16_f32 v89, v90, v91
    v_cvt_pk_bf16_f32 v90, v92, v93
    v_cvt_pk_bf16_f32 v91, v94, v95
    v_cvt_pk_bf16_f32 v92, v96, v97
    v_cvt_pk_bf16_f32 v93, v98, v99
    v_cvt_pk_bf16_f32 v94, v100, v101
    v_cvt_pk_bf16_f32 v95, v102, v103
    buffer_store_dwordx4 v[88:91], v12, s[28:31], s52 offen offset:0 sc1
    buffer_store_dwordx4 v[92:95], v12, s[28:31], s52 offen offset:1024 sc1
    v_mul_f32 v104, v104, v34
    v_mul_f32 v105, v105, v34
    v_mul_f32 v106, v106, v34
    v_mul_f32 v107, v107, v34
    v_mul_f32 v108, v108, v34
    v_mul_f32 v109, v109, v34
    v_mul_f32 v110, v110, v34
    v_mul_f32 v111, v111, v34
    v_mul_f32 v112, v112, v34
    v_mul_f32 v113, v113, v34
    v_mul_f32 v114, v114, v34
    v_mul_f32 v115, v115, v34
    v_mul_f32 v116, v116, v34
    v_mul_f32 v117, v117, v34
    v_mul_f32 v118, v118, v34
    v_mul_f32 v119, v119, v34
    v_cvt_pk_bf16_f32 v104, v104, v105
    v_cvt_pk_bf16_f32 v105, v106, v107
    v_cvt_pk_bf16_f32 v106, v108, v109
    v_cvt_pk_bf16_f32 v107, v110, v111
    v_cvt_pk_bf16_f32 v108, v112, v113
    v_cvt_pk_bf16_f32 v109, v114, v115
    v_cvt_pk_bf16_f32 v110, v116, v117
    v_cvt_pk_bf16_f32 v111, v118, v119
    buffer_store_dwordx4 v[104:107], v12, s[28:31], s52 offen offset:2048 sc1
    buffer_store_dwordx4 v[108:111], v12, s[28:31], s52 offen offset:3072 sc1
    s_lshl_b32 s52, s57, 4
    s_lshr_b32 s53, s47, 2
    s_add_u32 s52, s52, s53
    s_lshl_b32 s52, s52, 4
    s_and_b32 s53, s47, 3
    s_add_u32 s52, s52, s53
    s_lshl_b32 s52, s52, 2
    s_add_u32 s52, s52, 140509184
    v_mov_b32 v48, 1
    s_waitcnt vmcnt(0)
    s_mov_b64 exec, 1
    buffer_store_dword v48, off, s[28:31], s52 sc1
    s_mov_b64 exec, -1
    s_add_u32 s92, s92, 1
    s_cmp_lt_u32 s92, 16
    s_cbranch_scc1 L_b_loop_137
    s_waitcnt vmcnt(0)
    s_branch L_exit
L_outproj:
    s_lshr_b32 s52, s46, 5
    s_cmp_ge_u32 s47, 6
    s_cselect_b32 s53, 1, 0
    s_mul_i32 s54, s53, 6
    s_sub_u32 s47, s47, s54
    s_cmp_ge_u32 s52, 4
    s_cbranch_scc1 L_op_two
    s_cmp_eq_u32 s53, 0
    s_cbranch_scc1 L_op_grp
    s_lshl_b32 s52, s52, 2
    s_add_u32 s52, s52, s47
    s_lshr_b32 s48, s52, 3
    s_and_b32 s47, s52, 7
    s_cmp_lt_u32 s47, 6
    s_cbranch_scc1 L_final
    s_branch L_exit
L_op_two:
    s_lshl_b32 s52, s52, 1
    s_sub_u32 s52, s52, 4
    s_add_u32 s52, s52, s53
L_op_grp:
    s_and_b32 s48, s52, 1
    s_lshr_b32 s46, s52, 1
L_op_go:
    s_cmp_lt_u32 s46, 2
    s_cselect_b32 s24, s100, s4
    s_cselect_b32 s25, s101, s5
    s_cmp_lg_u32 s51, 0
    s_cbranch_scc1 L_hold_ok_146
L_wi_147:
    s_sleep 127
    s_load_dword s54, s[44:45], 144 glc
    s_waitcnt lgkmcnt(0)
    s_cmp_ge_u32 s54, 192
    s_cbranch_scc1 L_wi_ok_148
    s_sub_u32 s99, s99, 1
    s_cmp_lg_u32 s99, 0
    s_cbranch_scc1 L_wi_147
    s_branch L_exit
L_wi_ok_148:
L_sw_149:
    s_buffer_load_dword s54, s[28:31], s6 glc
    s_waitcnt lgkmcnt(0)
    s_cmp_ge_u32 s54, 5
    s_cbranch_scc1 L_sw_ok_150
    s_sleep 32
    s_sub_u32 s99, s99, 1
    s_cmp_lg_u32 s99, 0
    s_cbranch_scc1 L_sw_149
    s_branch L_exit
L_sw_ok_150:
L_hold_ok_146:
    s_barrier
    v_lshlrev_b32 v1, 4, v0
    v_lshrrev_b32 v8, 2, v0
    v_mul_u32_u24 v2, 1152, v8
    v_and_b32 v9, 3, v0
    v_lshl_add_u32 v2, v9, 4, v2
    v_lshrrev_b32 v8, 5, v0
    v_lshlrev_b32 v3, 8, v8
    v_bfe_u32 v10, v0, 2, 2
    v_lshl_add_u32 v3, v10, 6, v3
    v_bfe_u32 v10, v0, 4, 1
    v_lshl_add_u32 v3, v10, 5, v3
    v_lshl_add_u32 v3, v9, 3, v3
    s_mul_i32 s53, s51, 36864
    v_add_u32 v3, s53, v3
    s_mul_i32 s52, s51, 12288
    v_add_u32 v4, s52, v1
    s_mul_i32 s52, s51, 3072
    v_add_u32 v5, s52, v1
    v_and_b32 v10, 31, v0
    v_mul_u32_u24 v6, 1152, v10
    v_lshl_add_u32 v6, v8, 3, v6
    s_and_b32 s52, s46, 1
    s_lshl_b32 s52, s52, 2
    s_add_u32 s52, s52, s51
    s_mul_i32 s59, s52, 589824
    s_mul_i32 s52, s47, 192
    s_add_u32 s59, s59, s52
    s_add_u32 m0, s53, 0
    s_add_u32 s54, s59, 0
    buffer_load_dwordx4 v2, s[24:27], s54 offen lds
    s_add_u32 m0, s53, 1024
    s_add_u32 s54, s59, 64
    buffer_load_dwordx4 v2, s[24:27], s54 offen lds
    s_add_u32 m0, s53, 2048
    s_add_u32 s54, s59, 128
    buffer_load_dwordx4 v2, s[24:27], s54 offen lds
    s_add_u32 m0, s53, 3072
    s_add_u32 s54, s59, 18432
    buffer_load_dwordx4 v2, s[24:27], s54 offen lds
    s_add_u32 m0, s53, 4096
    s_add_u32 s54, s59, 18496
    buffer_load_dwordx4 v2, s[24:27], s54 offen lds
    s_add_u32 m0, s53, 5120
    s_add_u32 s54, s59, 18560
    buffer_load_dwordx4 v2, s[24:27], s54 offen lds
    s_add_u32 m0, s53, 6144
    s_add_u32 s54, s59, 36864
    buffer_load_dwordx4 v2, s[24:27], s54 offen lds
    s_add_u32 m0, s53, 7168
    s_add_u32 s54, s59, 36928
    buffer_load_dwordx4 v2, s[24:27], s54 offen lds
    s_add_u32 m0, s53, 8192
    s_add_u32 s54, s59, 36992
    buffer_load_dwordx4 v2, s[24:27], s54 offen lds
    s_add_u32 m0, s53, 9216
    s_add_u32 s54, s59, 55296
    buffer_load_dwordx4 v2, s[24:27], s54 offen lds
    s_add_u32 m0, s53, 10240
    s_add_u32 s54, s59, 55360
    buffer_load_dwordx4 v2, s[24:27], s54 offen lds
    s_add_u32 m0, s53, 11264
    s_add_u32 s54, s59, 55424
    buffer_load_dwordx4 v2, s[24:27], s54 offen lds
    s_add_u32 m0, s53, 12288
    s_add_u32 s54, s59, 73728
    buffer_load_dwordx4 v2, s[24:27], s54 offen lds
    s_add_u32 m0, s53, 13312
    s_add_u32 s54, s59, 73792
    buffer_load_dwordx4 v2, s[24:27], s54 offen lds
    s_add_u32 m0, s53, 14336
    s_add_u32 s54, s59, 73856
    buffer_load_dwordx4 v2, s[24:27], s54 offen lds
    s_add_u32 m0, s53, 15360
    s_add_u32 s54, s59, 92160
    buffer_load_dwordx4 v2, s[24:27], s54 offen lds
    s_add_u32 m0, s53, 16384
    s_add_u32 s54, s59, 92224
    buffer_load_dwordx4 v2, s[24:27], s54 offen lds
    s_add_u32 m0, s53, 17408
    s_add_u32 s54, s59, 92288
    buffer_load_dwordx4 v2, s[24:27], s54 offen lds
    s_add_u32 m0, s53, 18432
    s_add_u32 s54, s59, 110592
    buffer_load_dwordx4 v2, s[24:27], s54 offen lds
    s_add_u32 m0, s53, 19456
    s_add_u32 s54, s59, 110656
    buffer_load_dwordx4 v2, s[24:27], s54 offen lds
    s_add_u32 m0, s53, 20480
    s_add_u32 s54, s59, 110720
    buffer_load_dwordx4 v2, s[24:27], s54 offen lds
    s_add_u32 m0, s53, 21504
    s_add_u32 s54, s59, 129024
    buffer_load_dwordx4 v2, s[24:27], s54 offen lds
    s_add_u32 m0, s53, 22528
    s_add_u32 s54, s59, 129088
    buffer_load_dwordx4 v2, s[24:27], s54 offen lds
    s_add_u32 m0, s53, 23552
    s_add_u32 s54, s59, 129152
    buffer_load_dwordx4 v2, s[24:27], s54 offen lds
    s_add_u32 m0, s53, 24576
    s_add_u32 s54, s59, 147456
    buffer_load_dwordx4 v2, s[24:27], s54 offen lds
    s_add_u32 m0, s53, 25600
    s_add_u32 s54, s59, 147520
    buffer_load_dwordx4 v2, s[24:27], s54 offen lds
    s_add_u32 m0, s53, 26624
    s_add_u32 s54, s59, 147584
    buffer_load_dwordx4 v2, s[24:27], s54 offen lds
    s_add_u32 m0, s53, 27648
    s_add_u32 s54, s59, 165888
    buffer_load_dwordx4 v2, s[24:27], s54 offen lds
    s_add_u32 m0, s53, 28672
    s_add_u32 s54, s59, 165952
    buffer_load_dwordx4 v2, s[24:27], s54 offen lds
    s_add_u32 m0, s53, 29696
    s_add_u32 s54, s59, 166016
    buffer_load_dwordx4 v2, s[24:27], s54 offen lds
    s_add_u32 m0, s53, 30720
    s_add_u32 s54, s59, 184320
    buffer_load_dwordx4 v2, s[24:27], s54 offen lds
    s_add_u32 m0, s53, 31744
    s_add_u32 s54, s59, 184384
    buffer_load_dwordx4 v2, s[24:27], s54 offen lds
    s_add_u32 m0, s53, 32768
    s_add_u32 s54, s59, 184448
    buffer_load_dwordx4 v2, s[24:27], s54 offen lds
    s_add_u32 m0, s53, 33792
    s_add_u32 s54, s59, 202752
    buffer_load_dwordx4 v2, s[24:27], s54 offen lds
    s_add_u32 m0, s53, 34816
    s_add_u32 s54, s59, 202816
    buffer_load_dwordx4 v2, s[24:27], s54 offen lds
    s_add_u32 m0, s53, 35840
    s_add_u32 s54, s59, 202880
    buffer_load_dwordx4 v2, s[24:27], s54 offen lds
    s_waitcnt vmcnt(32)
    ds_read_b64_tr_b16 v[128:129], v3 offset:0
    ds_read_b64_tr_b16 v[130:131], v3 offset:512
    ds_read_b64_tr_b16 v[132:133], v3 offset:1024
    ds_read_b64_tr_b16 v[134:135], v3 offset:1536
    ds_read_b64_tr_b16 v[136:137], v3 offset:2048
    ds_read_b64_tr_b16 v[138:139], v3 offset:2560
    ds_read_b64_tr_b16 v[140:141], v3 offset:3072
    ds_read_b64_tr_b16 v[142:143], v3 offset:3584
    s_waitcnt lgkmcnt(0)
    s_add_u32 m0, s53, 0
    s_add_u32 s54, s59, 221184
    buffer_load_dwordx4 v2, s[24:27], s54 offen lds
    s_add_u32 m0, s53, 1024
    s_add_u32 s54, s59, 221248
    buffer_load_dwordx4 v2, s[24:27], s54 offen lds
    s_add_u32 m0, s53, 2048
    s_add_u32 s54, s59, 221312
    buffer_load_dwordx4 v2, s[24:27], s54 offen lds
    s_add_u32 m0, s53, 3072
    s_add_u32 s54, s59, 239616
    buffer_load_dwordx4 v2, s[24:27], s54 offen lds
    s_waitcnt vmcnt(32)
    ds_read_b64_tr_b16 v[144:145], v3 offset:4096
    ds_read_b64_tr_b16 v[146:147], v3 offset:4608
    ds_read_b64_tr_b16 v[148:149], v3 offset:5120
    ds_read_b64_tr_b16 v[150:151], v3 offset:5632
    ds_read_b64_tr_b16 v[152:153], v3 offset:6144
    ds_read_b64_tr_b16 v[154:155], v3 offset:6656
    ds_read_b64_tr_b16 v[156:157], v3 offset:7168
    ds_read_b64_tr_b16 v[158:159], v3 offset:7680
    s_waitcnt lgkmcnt(0)
    s_add_u32 m0, s53, 4096
    s_add_u32 s54, s59, 239680
    buffer_load_dwordx4 v2, s[24:27], s54 offen lds
    s_add_u32 m0, s53, 5120
    s_add_u32 s54, s59, 239744
    buffer_load_dwordx4 v2, s[24:27], s54 offen lds
    s_add_u32 m0, s53, 6144
    s_add_u32 s54, s59, 258048
    buffer_load_dwordx4 v2, s[24:27], s54 offen lds
    s_add_u32 m0, s53, 7168
    s_add_u32 s54, s59, 258112
    buffer_load_dwordx4 v2, s[24:27], s54 offen lds
    s_waitcnt vmcnt(32)
    ds_read_b64_tr_b16 v[160:161], v3 offset:8192
    ds_read_b64_tr_b16 v[162:163], v3 offset:8704
    ds_read_b64_tr_b16 v[164:165], v3 offset:9216
    ds_read_b64_tr_b16 v[166:167], v3 offset:9728
    ds_read_b64_tr_b16 v[168:169], v3 offset:10240
    ds_read_b64_tr_b16 v[170:171], v3 offset:10752
    ds_read_b64_tr_b16 v[172:173], v3 offset:11264
    ds_read_b64_tr_b16 v[174:175], v3 offset:11776
    s_waitcnt lgkmcnt(0)
    s_add_u32 m0, s53, 8192
    s_add_u32 s54, s59, 258176
    buffer_load_dwordx4 v2, s[24:27], s54 offen lds
    s_add_u32 m0, s53, 9216
    s_add_u32 s54, s59, 276480
    buffer_load_dwordx4 v2, s[24:27], s54 offen lds
    s_add_u32 m0, s53, 10240
    s_add_u32 s54, s59, 276544
    buffer_load_dwordx4 v2, s[24:27], s54 offen lds
    s_add_u32 m0, s53, 11264
    s_add_u32 s54, s59, 276608
    buffer_load_dwordx4 v2, s[24:27], s54 offen lds
    s_waitcnt vmcnt(32)
    ds_read_b64_tr_b16 v[176:177], v3 offset:12288
    ds_read_b64_tr_b16 v[178:179], v3 offset:12800
    ds_read_b64_tr_b16 v[180:181], v3 offset:13312
    ds_read_b64_tr_b16 v[182:183], v3 offset:13824
    ds_read_b64_tr_b16 v[184:185], v3 offset:14336
    ds_read_b64_tr_b16 v[186:187], v3 offset:14848
    ds_read_b64_tr_b16 v[188:189], v3 offset:15360
    ds_read_b64_tr_b16 v[190:191], v3 offset:15872
    s_waitcnt lgkmcnt(0)
    s_add_u32 m0, s53, 12288
    s_add_u32 s54, s59, 294912
    buffer_load_dwordx4 v2, s[24:27], s54 offen lds
    s_add_u32 m0, s53, 13312
    s_add_u32 s54, s59, 294976
    buffer_load_dwordx4 v2, s[24:27], s54 offen lds
    s_add_u32 m0, s53, 14336
    s_add_u32 s54, s59, 295040
    buffer_load_dwordx4 v2, s[24:27], s54 offen lds
    s_add_u32 m0, s53, 15360
    s_add_u32 s54, s59, 313344
    buffer_load_dwordx4 v2, s[24:27], s54 offen lds
    s_waitcnt vmcnt(32)
    ds_read_b64_tr_b16 v[192:193], v3 offset:16384
    ds_read_b64_tr_b16 v[194:195], v3 offset:16896
    ds_read_b64_tr_b16 v[196:197], v3 offset:17408
    ds_read_b64_tr_b16 v[198:199], v3 offset:17920
    ds_read_b64_tr_b16 v[200:201], v3 offset:18432
    ds_read_b64_tr_b16 v[202:203], v3 offset:18944
    ds_read_b64_tr_b16 v[204:205], v3 offset:19456
    ds_read_b64_tr_b16 v[206:207], v3 offset:19968
    s_waitcnt lgkmcnt(0)
    s_add_u32 m0, s53, 16384
    s_add_u32 s54, s59, 313408
    buffer_load_dwordx4 v2, s[24:27], s54 offen lds
    s_add_u32 m0, s53, 17408
    s_add_u32 s54, s59, 313472
    buffer_load_dwordx4 v2, s[24:27], s54 offen lds
    s_add_u32 m0, s53, 18432
    s_add_u32 s54, s59, 331776
    buffer_load_dwordx4 v2, s[24:27], s54 offen lds
    s_add_u32 m0, s53, 19456
    s_add_u32 s54, s59, 331840
    buffer_load_dwordx4 v2, s[24:27], s54 offen lds
    s_waitcnt vmcnt(32)
    ds_read_b64_tr_b16 v[208:209], v3 offset:20480
    ds_read_b64_tr_b16 v[210:211], v3 offset:20992
    ds_read_b64_tr_b16 v[212:213], v3 offset:21504
    ds_read_b64_tr_b16 v[214:215], v3 offset:22016
    ds_read_b64_tr_b16 v[216:217], v3 offset:22528
    ds_read_b64_tr_b16 v[218:219], v3 offset:23040
    ds_read_b64_tr_b16 v[220:221], v3 offset:23552
    ds_read_b64_tr_b16 v[222:223], v3 offset:24064
    s_waitcnt lgkmcnt(0)
    s_add_u32 m0, s53, 20480
    s_add_u32 s54, s59, 331904
    buffer_load_dwordx4 v2, s[24:27], s54 offen lds
    s_add_u32 m0, s53, 21504
    s_add_u32 s54, s59, 350208
    buffer_load_dwordx4 v2, s[24:27], s54 offen lds
    s_add_u32 m0, s53, 22528
    s_add_u32 s54, s59, 350272
    buffer_load_dwordx4 v2, s[24:27], s54 offen lds
    s_add_u32 m0, s53, 23552
    s_add_u32 s54, s59, 350336
    buffer_load_dwordx4 v2, s[24:27], s54 offen lds
    s_waitcnt vmcnt(32)
    ds_read_b64_tr_b16 v[224:225], v3 offset:24576
    ds_read_b64_tr_b16 v[226:227], v3 offset:25088
    ds_read_b64_tr_b16 v[228:229], v3 offset:25600
    ds_read_b64_tr_b16 v[230:231], v3 offset:26112
    ds_read_b64_tr_b16 v[232:233], v3 offset:26624
    ds_read_b64_tr_b16 v[234:235], v3 offset:27136
    ds_read_b64_tr_b16 v[236:237], v3 offset:27648
    ds_read_b64_tr_b16 v[238:239], v3 offset:28160
    s_waitcnt lgkmcnt(0)
    s_add_u32 m0, s53, 24576
    s_add_u32 s54, s59, 368640
    buffer_load_dwordx4 v2, s[24:27], s54 offen lds
    s_add_u32 m0, s53, 25600
    s_add_u32 s54, s59, 368704
    buffer_load_dwordx4 v2, s[24:27], s54 offen lds
    s_add_u32 m0, s53, 26624
    s_add_u32 s54, s59, 368768
    buffer_load_dwordx4 v2, s[24:27], s54 offen lds
    s_add_u32 m0, s53, 27648
    s_add_u32 s54, s59, 387072
    buffer_load_dwordx4 v2, s[24:27], s54 offen lds
    s_waitcnt vmcnt(32)
    ds_read_b64_tr_b16 v[240:241], v3 offset:28672
    ds_read_b64_tr_b16 v[242:243], v3 offset:29184
    ds_read_b64_tr_b16 v[244:245], v3 offset:29696
    ds_read_b64_tr_b16 v[246:247], v3 offset:30208
    ds_read_b64_tr_b16 v[248:249], v3 offset:30720
    ds_read_b64_tr_b16 v[250:251], v3 offset:31232
    ds_read_b64_tr_b16 v[252:253], v3 offset:31744
    ds_read_b64_tr_b16 v[254:255], v3 offset:32256
    s_waitcnt lgkmcnt(0)
    s_add_u32 m0, s53, 28672
    s_add_u32 s54, s59, 387136
    buffer_load_dwordx4 v2, s[24:27], s54 offen lds
    s_add_u32 m0, s53, 29696
    s_add_u32 s54, s59, 387200
    buffer_load_dwordx4 v2, s[24:27], s54 offen lds
    s_add_u32 m0, s53, 30720
    s_add_u32 s54, s59, 405504
    buffer_load_dwordx4 v2, s[24:27], s54 offen lds
    s_add_u32 m0, s53, 31744
    s_add_u32 s54, s59, 405568
    buffer_load_dwordx4 v2, s[24:27], s54 offen lds
    s_waitcnt vmcnt(32)
    ds_read_b64_tr_b16 a[0:1], v3 offset:32768
    ds_read_b64_tr_b16 a[2:3], v3 offset:33280
    ds_read_b64_tr_b16 a[4:5], v3 offset:33792
    ds_read_b64_tr_b16 a[6:7], v3 offset:34304
    ds_read_b64_tr_b16 a[8:9], v3 offset:34816
    ds_read_b64_tr_b16 a[10:11], v3 offset:35328
    ds_read_b64_tr_b16 a[12:13], v3 offset:35840
    ds_read_b64_tr_b16 a[14:15], v3 offset:36352
    s_waitcnt lgkmcnt(0)
    s_add_u32 m0, s53, 32768
    s_add_u32 s54, s59, 405632
    buffer_load_dwordx4 v2, s[24:27], s54 offen lds
    s_add_u32 m0, s53, 33792
    s_add_u32 s54, s59, 423936
    buffer_load_dwordx4 v2, s[24:27], s54 offen lds
    s_add_u32 m0, s53, 34816
    s_add_u32 s54, s59, 424000
    buffer_load_dwordx4 v2, s[24:27], s54 offen lds
    s_add_u32 m0, s53, 35840
    s_add_u32 s54, s59, 424064
    buffer_load_dwordx4 v2, s[24:27], s54 offen lds
    s_waitcnt vmcnt(32)
    ds_read_b64_tr_b16 a[16:17], v3 offset:0
    ds_read_b64_tr_b16 a[18:19], v3 offset:512
    ds_read_b64_tr_b16 a[20:21], v3 offset:1024
    ds_read_b64_tr_b16 a[22:23], v3 offset:1536
    ds_read_b64_tr_b16 a[24:25], v3 offset:2048
    ds_read_b64_tr_b16 a[26:27], v3 offset:2560
    ds_read_b64_tr_b16 a[28:29], v3 offset:3072
    ds_read_b64_tr_b16 a[30:31], v3 offset:3584
    s_waitcnt lgkmcnt(0)
    s_add_u32 m0, s53, 0
    s_add_u32 s54, s59, 442368
    buffer_load_dwordx4 v2, s[24:27], s54 offen lds
    s_add_u32 m0, s53, 1024
    s_add_u32 s54, s59, 442432
    buffer_load_dwordx4 v2, s[24:27], s54 offen lds
    s_add_u32 m0, s53, 2048
    s_add_u32 s54, s59, 442496
    buffer_load_dwordx4 v2, s[24:27], s54 offen lds
    s_add_u32 m0, s53, 3072
    s_add_u32 s54, s59, 460800
    buffer_load_dwordx4 v2, s[24:27], s54 offen lds
    s_waitcnt vmcnt(32)
    ds_read_b64_tr_b16 a[32:33], v3 offset:4096
    ds_read_b64_tr_b16 a[34:35], v3 offset:4608
    ds_read_b64_tr_b16 a[36:37], v3 offset:5120
    ds_read_b64_tr_b16 a[38:39], v3 offset:5632
    ds_read_b64_tr_b16 a[40:41], v3 offset:6144
    ds_read_b64_tr_b16 a[42:43], v3 offset:6656
    ds_read_b64_tr_b16 a[44:45], v3 offset:7168
    ds_read_b64_tr_b16 a[46:47], v3 offset:7680
    s_waitcnt lgkmcnt(0)
    s_add_u32 m0, s53, 4096
    s_add_u32 s54, s59, 460864
    buffer_load_dwordx4 v2, s[24:27], s54 offen lds
    s_add_u32 m0, s53, 5120
    s_add_u32 s54, s59, 460928
    buffer_load_dwordx4 v2, s[24:27], s54 offen lds
    s_add_u32 m0, s53, 6144
    s_add_u32 s54, s59, 479232
    buffer_load_dwordx4 v2, s[24:27], s54 offen lds
    s_add_u32 m0, s53, 7168
    s_add_u32 s54, s59, 479296
    buffer_load_dwordx4 v2, s[24:27], s54 offen lds
    s_waitcnt vmcnt(32)
    ds_read_b64_tr_b16 a[48:49], v3 offset:8192
    ds_read_b64_tr_b16 a[50:51], v3 offset:8704
    ds_read_b64_tr_b16 a[52:53], v3 offset:9216
    ds_read_b64_tr_b16 a[54:55], v3 offset:9728
    ds_read_b64_tr_b16 a[56:57], v3 offset:10240
    ds_read_b64_tr_b16 a[58:59], v3 offset:10752
    ds_read_b64_tr_b16 a[60:61], v3 offset:11264
    ds_read_b64_tr_b16 a[62:63], v3 offset:11776
    s_waitcnt lgkmcnt(0)
    s_add_u32 m0, s53, 8192
    s_add_u32 s54, s59, 479360
    buffer_load_dwordx4 v2, s[24:27], s54 offen lds
    s_add_u32 m0, s53, 9216
    s_add_u32 s54, s59, 497664
    buffer_load_dwordx4 v2, s[24:27], s54 offen lds
    s_add_u32 m0, s53, 10240
    s_add_u32 s54, s59, 497728
    buffer_load_dwordx4 v2, s[24:27], s54 offen lds
    s_add_u32 m0, s53, 11264
    s_add_u32 s54, s59, 497792
    buffer_load_dwordx4 v2, s[24:27], s54 offen lds
    s_waitcnt vmcnt(32)
    ds_read_b64_tr_b16 a[64:65], v3 offset:12288
    ds_read_b64_tr_b16 a[66:67], v3 offset:12800
    ds_read_b64_tr_b16 a[68:69], v3 offset:13312
    ds_read_b64_tr_b16 a[70:71], v3 offset:13824
    ds_read_b64_tr_b16 a[72:73], v3 offset:14336
    ds_read_b64_tr_b16 a[74:75], v3 offset:14848
    ds_read_b64_tr_b16 a[76:77], v3 offset:15360
    ds_read_b64_tr_b16 a[78:79], v3 offset:15872
    s_waitcnt lgkmcnt(0)
    s_add_u32 m0, s53, 12288
    s_add_u32 s54, s59, 516096
    buffer_load_dwordx4 v2, s[24:27], s54 offen lds
    s_add_u32 m0, s53, 13312
    s_add_u32 s54, s59, 516160
    buffer_load_dwordx4 v2, s[24:27], s54 offen lds
    s_add_u32 m0, s53, 14336
    s_add_u32 s54, s59, 516224
    buffer_load_dwordx4 v2, s[24:27], s54 offen lds
    s_add_u32 m0, s53, 15360
    s_add_u32 s54, s59, 534528
    buffer_load_dwordx4 v2, s[24:27], s54 offen lds
    s_waitcnt vmcnt(32)
    ds_read_b64_tr_b16 a[80:81], v3 offset:16384
    ds_read_b64_tr_b16 a[82:83], v3 offset:16896
    ds_read_b64_tr_b16 a[84:85], v3 offset:17408
    ds_read_b64_tr_b16 a[86:87], v3 offset:17920
    ds_read_b64_tr_b16 a[88:89], v3 offset:18432
    ds_read_b64_tr_b16 a[90:91], v3 offset:18944
    ds_read_b64_tr_b16 a[92:93], v3 offset:19456
    ds_read_b64_tr_b16 a[94:95], v3 offset:19968
    s_waitcnt lgkmcnt(0)
    s_add_u32 m0, s53, 16384
    s_add_u32 s54, s59, 534592
    buffer_load_dwordx4 v2, s[24:27], s54 offen lds
    s_add_u32 m0, s53, 17408
    s_add_u32 s54, s59, 534656
    buffer_load_dwordx4 v2, s[24:27], s54 offen lds
    s_add_u32 m0, s53, 18432
    s_add_u32 s54, s59, 552960
    buffer_load_dwordx4 v2, s[24:27], s54 offen lds
    s_add_u32 m0, s53, 19456
    s_add_u32 s54, s59, 553024
    buffer_load_dwordx4 v2, s[24:27], s54 offen lds
    s_waitcnt vmcnt(32)
    ds_read_b64_tr_b16 a[96:97], v3 offset:20480
    ds_read_b64_tr_b16 a[98:99], v3 offset:20992
    ds_read_b64_tr_b16 a[100:101], v3 offset:21504
    ds_read_b64_tr_b16 a[102:103], v3 offset:22016
    ds_read_b64_tr_b16 a[104:105], v3 offset:22528
    ds_read_b64_tr_b16 a[106:107], v3 offset:23040
    ds_read_b64_tr_b16 a[108:109], v3 offset:23552
    ds_read_b64_tr_b16 a[110:111], v3 offset:24064
    s_waitcnt lgkmcnt(0)
    s_add_u32 m0, s53, 20480
    s_add_u32 s54, s59, 553088
    buffer_load_dwordx4 v2, s[24:27], s54 offen lds
    s_add_u32 m0, s53, 21504
    s_add_u32 s54, s59, 571392
    buffer_load_dwordx4 v2, s[24:27], s54 offen lds
    s_add_u32 m0, s53, 22528
    s_add_u32 s54, s59, 571456
    buffer_load_dwordx4 v2, s[24:27], s54 offen lds
    s_add_u32 m0, s53, 23552
    s_add_u32 s54, s59, 571520
    buffer_load_dwordx4 v2, s[24:27], s54 offen lds
    s_waitcnt vmcnt(32)
    ds_read_b64_tr_b16 a[112:113], v3 offset:24576
    ds_read_b64_tr_b16 a[114:115], v3 offset:25088
    ds_read_b64_tr_b16 a[116:117], v3 offset:25600
    ds_read_b64_tr_b16 a[118:119], v3 offset:26112
    ds_read_b64_tr_b16 a[120:121], v3 offset:26624
    ds_read_b64_tr_b16 a[122:123], v3 offset:27136
    ds_read_b64_tr_b16 a[124:125], v3 offset:27648
    ds_read_b64_tr_b16 a[126:127], v3 offset:28160
    s_waitcnt lgkmcnt(0)
    s_waitcnt vmcnt(28)
    ds_read_b64_tr_b16 a[128:129], v3 offset:28672
    ds_read_b64_tr_b16 a[130:131], v3 offset:29184
    ds_read_b64_tr_b16 a[132:133], v3 offset:29696
    ds_read_b64_tr_b16 a[134:135], v3 offset:30208
    ds_read_b64_tr_b16 a[136:137], v3 offset:30720
    ds_read_b64_tr_b16 a[138:139], v3 offset:31232
    ds_read_b64_tr_b16 a[140:141], v3 offset:31744
    ds_read_b64_tr_b16 a[142:143], v3 offset:32256
    s_waitcnt lgkmcnt(0)
    s_waitcnt vmcnt(24)
    ds_read_b64_tr_b16 a[144:145], v3 offset:32768
    ds_read_b64_tr_b16 a[146:147], v3 offset:33280
    ds_read_b64_tr_b16 a[148:149], v3 offset:33792
    ds_read_b64_tr_b16 a[150:151], v3 offset:34304
    ds_read_b64_tr_b16 a[152:153], v3 offset:34816
    ds_read_b64_tr_b16 a[154:155], v3 offset:35328
    ds_read_b64_tr_b16 a[156:157], v3 offset:35840
    ds_read_b64_tr_b16 a[158:159], v3 offset:36352
    s_waitcnt lgkmcnt(0)
    s_waitcnt vmcnt(20)
    ds_read_b64_tr_b16 a[160:161], v3 offset:0
    ds_read_b64_tr_b16 a[162:163], v3 offset:512
    ds_read_b64_tr_b16 a[164:165], v3 offset:1024
    ds_read_b64_tr_b16 a[166:167], v3 offset:1536
    ds_read_b64_tr_b16 a[168:169], v3 offset:2048
    ds_read_b64_tr_b16 a[170:171], v3 offset:2560
    ds_read_b64_tr_b16 a[172:173], v3 offset:3072
    ds_read_b64_tr_b16 a[174:175], v3 offset:3584
    s_waitcnt lgkmcnt(0)
    s_waitcnt vmcnt(16)
    ds_read_b64_tr_b16 a[176:177], v3 offset:4096
    ds_read_b64_tr_b16 a[178:179], v3 offset:4608
    ds_read_b64_tr_b16 a[180:181], v3 offset:5120
    ds_read_b64_tr_b16 a[182:183], v3 offset:5632
    ds_read_b64_tr_b16 a[184:185], v3 offset:6144
    ds_read_b64_tr_b16 a[186:187], v3 offset:6656
    ds_read_b64_tr_b16 a[188:189], v3 offset:7168
    ds_read_b64_tr_b16 a[190:191], v3 offset:7680
    s_waitcnt lgkmcnt(0)
    s_waitcnt vmcnt(12)
    ds_read_b64_tr_b16 a[192:193], v3 offset:8192
    ds_read_b64_tr_b16 a[194:195], v3 offset:8704
    ds_read_b64_tr_b16 a[196:197], v3 offset:9216
    ds_read_b64_tr_b16 a[198:199], v3 offset:9728
    ds_read_b64_tr_b16 a[200:201], v3 offset:10240
    ds_read_b64_tr_b16 a[202:203], v3 offset:10752
    ds_read_b64_tr_b16 a[204:205], v3 offset:11264
    ds_read_b64_tr_b16 a[206:207], v3 offset:11776
    s_waitcnt lgkmcnt(0)
    s_waitcnt vmcnt(8)
    ds_read_b64_tr_b16 a[208:209], v3 offset:12288
    ds_read_b64_tr_b16 a[210:211], v3 offset:12800
    ds_read_b64_tr_b16 a[212:213], v3 offset:13312
    ds_read_b64_tr_b16 a[214:215], v3 offset:13824
    ds_read_b64_tr_b16 a[216:217], v3 offset:14336
    ds_read_b64_tr_b16 a[218:219], v3 offset:14848
    ds_read_b64_tr_b16 a[220:221], v3 offset:15360
    ds_read_b64_tr_b16 a[222:223], v3 offset:15872
    s_waitcnt lgkmcnt(0)
    s_waitcnt vmcnt(4)
    ds_read_b64_tr_b16 a[224:225], v3 offset:16384
    ds_read_b64_tr_b16 a[226:227], v3 offset:16896
    ds_read_b64_tr_b16 a[228:229], v3 offset:17408
    ds_read_b64_tr_b16 a[230:231], v3 offset:17920
    ds_read_b64_tr_b16 a[232:233], v3 offset:18432
    ds_read_b64_tr_b16 a[234:235], v3 offset:18944
    ds_read_b64_tr_b16 a[236:237], v3 offset:19456
    ds_read_b64_tr_b16 a[238:239], v3 offset:19968
    s_waitcnt lgkmcnt(0)
    s_waitcnt vmcnt(0)
    ds_read_b64_tr_b16 a[240:241], v3 offset:20480
    ds_read_b64_tr_b16 a[242:243], v3 offset:20992
    ds_read_b64_tr_b16 a[244:245], v3 offset:21504
    ds_read_b64_tr_b16 a[246:247], v3 offset:22016
    ds_read_b64_tr_b16 a[248:249], v3 offset:22528
    ds_read_b64_tr_b16 a[250:251], v3 offset:23040
    ds_read_b64_tr_b16 a[252:253], v3 offset:23552
    ds_read_b64_tr_b16 a[254:255], v3 offset:24064
    s_waitcnt lgkmcnt(0)
    s_barrier
    v_mov_b32 v10, 1
    v_and_b32 v12, 3, v0
    v_lshlrev_b32 v12, 2, v12
    s_mov_b32 s61, 0x20000000
    s_mov_b32 s62, 0
    s_lshl_b32 s63, s48, 2
    s_add_u32 s63, s63, s46
    s_lshl_b32 s63, s63, 2
    s_add_u32 s63, s63, s51
    s_lshl_b32 s63, s63, 6
    s_add_u32 s63, s63, 140509184
    s_cmp_lt_u32 s48, 48
    s_cbranch_scc1 L_p_loop_151
    s_sub_u32 s54, s63, 2048
L_p_q_158:
    s_sleep 16
    s_sub_u32 s99, s99, 1
    s_cmp_eq_u32 s99, 0
    s_cbranch_scc1 L_exit
    s_buffer_load_dwordx4 s[68:71], s[28:31], s54 glc
    s_waitcnt lgkmcnt(0)
    s_and_b64 s[68:69], s[68:69], s[70:71]
    s_and_b32 s68, s68, s69
    s_cbranch_scc0 L_p_q_158
L_p_loop_151:
    s_cmp_lg_u32 s62, 0
    s_cbranch_scc1 L_p_have_152
    s_waitcnt vmcnt(0)
    s_mov_b64 exec, 1
    buffer_store_dword v10, off, s[28:31], s61 sc1
    s_mov_b64 exec, -1
    s_mov_b32 s61, 0x20000000
    s_lshl_b32 s60, s48, 4
    s_lshl_b32 s52, s46, 2
    s_add_u32 s60, s60, s52
    s_add_u32 s60, s60, s51
    s_lshl_b32 s60, s60, 15
    s_add_u32 s60, s60, 100663296
L_p_rp_153:
    s_buffer_load_dwordx4 s[68:71], s[28:31], s63 glc
    s_waitcnt lgkmcnt(0)
    s_and_b64 s[68:69], s[68:69], s[70:71]
    s_and_b32 s68, s68, s69
    s_cbranch_scc1 L_p_rok_154
    s_sleep 3
    s_sub_u32 s99, s99, 1
    s_cmp_lg_u32 s99, 0
    s_cbranch_scc1 L_p_rp_153
    s_branch L_exit
L_p_rok_154:
L_p_go_156:
    buffer_load_dwordx4 v[16:19], v1, s[28:31], s60 offen offset:0 sc1
    buffer_load_dwordx4 v[20:23], v1, s[28:31], s60 offen offset:1024 sc1
    buffer_load_dwordx4 v[24:27], v1, s[28:31], s60 offen offset:2048 sc1
    buffer_load_dwordx4 v[28:31], v1, s[28:31], s60 offen offset:3072 sc1
    s_add_u32 s60, s60, 4096
    buffer_load_dwordx4 v[32:35], v1, s[28:31], s60 offen offset:0 sc1
    buffer_load_dwordx4 v[36:39], v1, s[28:31], s60 offen offset:1024 sc1
    buffer_load_dwordx4 v[40:43], v1, s[28:31], s60 offen offset:2048 sc1
    buffer_load_dwordx4 v[44:47], v1, s[28:31], s60 offen offset:3072 sc1
    s_add_u32 s60, s60, 4096
    buffer_load_dwordx4 v[48:51], v1, s[28:31], s60 offen offset:0 sc1
    buffer_load_dwordx4 v[52:55], v1, s[28:31], s60 offen offset:1024 sc1
    buffer_load_dwordx4 v[56:59], v1, s[28:31], s60 offen offset:2048 sc1
    buffer_load_dwordx4 v[60:63], v1, s[28:31], s60 offen offset:3072 sc1
    s_add_u32 s60, s60, 4096
    buffer_load_dwordx4 v[64:67], v1, s[28:31], s60 offen offset:0 sc1
    buffer_load_dwordx4 v[68:71], v1, s[28:31], s60 offen offset:1024 sc1
    buffer_load_dwordx4 v[72:75], v1, s[28:31], s60 offen offset:2048 sc1
    buffer_load_dwordx4 v[76:79], v1, s[28:31], s60 offen offset:3072 sc1
L_p_have_152:
    s_mov_b32 s56, s60
    s_cmp_ge_u32 s48, 48
    s_cselect_b32 s66, 4, 2
    s_lshl_b32 s52, s66, 10
    s_add_u32 s63, s63, s52
    s_mul_i32 s58, s48, 6
    s_add_u32 s58, s58, s47
    s_mul_i32 s57, s58, 49152
    s_add_u32 s57, s57, 142606336
    s_mul_i32 s52, s46, 12288
    s_add_u32 s57, s57, s52
    s_add_u32 s48, s48, s66
    s_waitcnt vmcnt(15)
    v_mfma_f32_32x32x16_bf16 v[80:95], v[128:131], v[16:19], 0
    buffer_load_dword v11, v12, s[28:31], s63 offen sc1
    v_mfma_f32_32x32x16_bf16 v[96:111], v[132:135], v[16:19], 0
    v_mfma_f32_32x32x16_bf16 v[112:127], v[136:139], v[16:19], 0
    s_waitcnt vmcnt(15)
    v_mfma_f32_32x32x16_bf16 v[80:95], v[140:143], v[20:23], v[80:95]
    s_add_u32 s56, s56, 4096
    buffer_load_dwordx4 v[16:19], v1, s[28:31], s56 offen offset:0 sc1
    v_mfma_f32_32x32x16_bf16 v[96:111], v[144:147], v[20:23], v[96:111]
    v_mfma_f32_32x32x16_bf16 v[112:127], v[148:151], v[20:23], v[112:127]
    s_waitcnt vmcnt(15)
    v_mfma_f32_32x32x16_bf16 v[80:95], v[152:155], v[24:27], v[80:95]
    buffer_load_dwordx4 v[20:23], v1, s[28:31], s56 offen offset:1024 sc1
    v_mfma_f32_32x32x16_bf16 v[96:111], v[156:159], v[24:27], v[96:111]
    v_mfma_f32_32x32x16_bf16 v[112:127], v[160:163], v[24:27], v[112:127]
    s_waitcnt vmcnt(15)
    v_mfma_f32_32x32x16_bf16 v[80:95], v[164:167], v[28:31], v[80:95]
    buffer_load_dwordx4 v[24:27], v1, s[28:31], s56 offen offset:2048 sc1
    v_mfma_f32_32x32x16_bf16 v[96:111], v[168:171], v[28:31], v[96:111]
    v_mfma_f32_32x32x16_bf16 v[112:127], v[172:175], v[28:31], v[112:127]
    s_waitcnt vmcnt(15)
    v_mfma_f32_32x32x16_bf16 v[80:95], v[176:179], v[32:35], v[80:95]
    buffer_load_dwordx4 v[28:31], v1, s[28:31], s56 offen offset:3072 sc1
    v_mfma_f32_32x32x16_bf16 v[96:111], v[180:183], v[32:35], v[96:111]
    v_mfma_f32_32x32x16_bf16 v[112:127], v[184:187], v[32:35], v[112:127]
    s_waitcnt vmcnt(15)
    v_mfma_f32_32x32x16_bf16 v[80:95], v[188:191], v[36:39], v[80:95]
    s_add_u32 s56, s56, 4096
    buffer_load_dwordx4 v[32:35], v1, s[28:31], s56 offen offset:0 sc1
    v_mfma_f32_32x32x16_bf16 v[96:111], v[192:195], v[36:39], v[96:111]
    v_mfma_f32_32x32x16_bf16 v[112:127], v[196:199], v[36:39], v[112:127]
    s_waitcnt vmcnt(15)
    v_mfma_f32_32x32x16_bf16 v[80:95], v[200:203], v[40:43], v[80:95]
    buffer_load_dwordx4 v[36:39], v1, s[28:31], s56 offen offset:1024 sc1
    v_mfma_f32_32x32x16_bf16 v[96:111], v[204:207], v[40:43], v[96:111]
    v_mfma_f32_32x32x16_bf16 v[112:127], v[208:211], v[40:43], v[112:127]
    s_waitcnt vmcnt(15)
    v_mfma_f32_32x32x16_bf16 v[80:95], v[212:215], v[44:47], v[80:95]
    buffer_load_dwordx4 v[40:43], v1, s[28:31], s56 offen offset:2048 sc1
    v_mfma_f32_32x32x16_bf16 v[96:111], v[216:219], v[44:47], v[96:111]
    v_mfma_f32_32x32x16_bf16 v[112:127], v[220:223], v[44:47], v[112:127]
    s_waitcnt vmcnt(15)
    v_mfma_f32_32x32x16_bf16 v[80:95], v[224:227], v[48:51], v[80:95]
    buffer_load_dwordx4 v[44:47], v1, s[28:31], s56 offen offset:3072 sc1
    v_mfma_f32_32x32x16_bf16 v[96:111], v[228:231], v[48:51], v[96:111]
    v_mfma_f32_32x32x16_bf16 v[112:127], v[232:235], v[48:51], v[112:127]
    s_waitcnt vmcnt(15)
    v_mfma_f32_32x32x16_bf16 v[80:95], v[236:239], v[52:55], v[80:95]
    s_add_u32 s56, s56, 4096
    buffer_load_dwordx4 v[48:51], v1, s[28:31], s56 offen offset:0 sc1
    v_mfma_f32_32x32x16_bf16 v[96:111], v[240:243], v[52:55], v[96:111]
    v_mfma_f32_32x32x16_bf16 v[112:127], v[244:247], v[52:55], v[112:127]
    s_waitcnt vmcnt(15)
    v_mfma_f32_32x32x16_bf16 v[80:95], v[248:251], v[56:59], v[80:95]
    buffer_load_dwordx4 v[52:55], v1, s[28:31], s56 offen offset:1024 sc1
    v_mfma_f32_32x32x16_bf16 v[96:111], v[252:255], v[56:59], v[96:111]
    v_mfma_f32_32x32x16_bf16 v[112:127], a[0:3], v[56:59], v[112:127]
    s_waitcnt vmcnt(15)
    v_mfma_f32_32x32x16_bf16 v[80:95], a[4:7], v[60:63], v[80:95]
    buffer_load_dwordx4 v[56:59], v1, s[28:31], s56 offen offset:2048 sc1
    v_mfma_f32_32x32x16_bf16 v[96:111], a[8:11], v[60:63], v[96:111]
    v_mfma_f32_32x32x16_bf16 v[112:127], a[12:15], v[60:63], v[112:127]
    s_waitcnt vmcnt(15)
    v_mfma_f32_32x32x16_bf16 v[80:95], a[16:19], v[64:67], v[80:95]
    buffer_load_dwordx4 v[60:63], v1, s[28:31], s56 offen offset:3072 sc1
    v_mfma_f32_32x32x16_bf16 v[96:111], a[20:23], v[64:67], v[96:111]
    v_mfma_f32_32x32x16_bf16 v[112:127], a[24:27], v[64:67], v[112:127]
    s_waitcnt vmcnt(15)
    v_mfma_f32_32x32x16_bf16 v[80:95], a[28:31], v[68:71], v[80:95]
    s_add_u32 s56, s56, 4096
    buffer_load_dwordx4 v[64:67], v1, s[28:31], s56 offen offset:0 sc1
    v_mfma_f32_32x32x16_bf16 v[96:111], a[32:35], v[68:71], v[96:111]
    v_mfma_f32_32x32x16_bf16 v[112:127], a[36:39], v[68:71], v[112:127]
    s_waitcnt vmcnt(15)
    v_mfma_f32_32x32x16_bf16 v[80:95], a[40:43], v[72:75], v[80:95]
    buffer_load_dwordx4 v[68:71], v1, s[28:31], s56 offen offset:1024 sc1
    v_mfma_f32_32x32x16_bf16 v[96:111], a[44:47], v[72:75], v[96:111]
    v_mfma_f32_32x32x16_bf16 v[112:127], a[48:51], v[72:75], v[112:127]
    s_waitcnt vmcnt(15)
    v_mfma_f32_32x32x16_bf16 v[80:95], a[52:55], v[76:79], v[80:95]
    buffer_load_dwordx4 v[72:75], v1, s[28:31], s56 offen offset:2048 sc1
    v_mfma_f32_32x32x16_bf16 v[96:111], a[56:59], v[76:79], v[96:111]
    v_mfma_f32_32x32x16_bf16 v[112:127], a[60:63], v[76:79], v[112:127]
    s_waitcnt vmcnt(14)
    v_mfma_f32_32x32x16_bf16 v[80:95], a[64:67], v[16:19], v[80:95]
    buffer_load_dwordx4 v[76:79], v1, s[28:31], s56 offen offset:3072 sc1
    v_mfma_f32_32x32x16_bf16 v[96:111], a[68:71], v[16:19], v[96:111]
    v_cmp_ne_u32 vcc, 1, v11
    s_lshl_b32 s60, s48, 4
    s_lshl_b32 s52, s46, 2
    s_add_u32 s60, s60, s52
    s_add_u32 s60, s60, s51
    s_lshl_b32 s60, s60, 15
    s_add_u32 s60, s60, 100663296
    s_cmp_eq_u64 vcc, 0
    s_cselect_b32 s62, 1, 0
    s_cmp_lt_u32 s48, 64
    s_cselect_b32 s62, s62, 0
    s_cmp_lg_u32 s62, 0
    s_cselect_b32 s60, s60, 0x20000000
    v_mfma_f32_32x32x16_bf16 v[112:127], a[72:75], v[16:19], v[112:127]
    s_waitcnt vmcnt(14)
    v_mfma_f32_32x32x16_bf16 v[80:95], a[76:79], v[20:23], v[80:95]
    s_mov_b64 exec, 1
    buffer_store_dword v10, off, s[28:31], s61 sc1
    s_mov_b64 exec, -1
    s_mov_b32 s61, 0x20000000
    v_mfma_f32_32x32x16_bf16 v[96:111], a[80:83], v[20:23], v[96:111]
    buffer_load_dwordx4 v[16:19], v1, s[28:31], s60 offen offset:0 sc1
    v_mfma_f32_32x32x16_bf16 v[112:127], a[84:87], v[20:23], v[112:127]
    s_waitcnt vmcnt(14)
    v_mfma_f32_32x32x16_bf16 v[80:95], a[88:91], v[24:27], v[80:95]
    v_mfma_f32_32x32x16_bf16 v[96:111], a[92:95], v[24:27], v[96:111]
    buffer_load_dwordx4 v[20:23], v1, s[28:31], s60 offen offset:1024 sc1
    v_mfma_f32_32x32x16_bf16 v[112:127], a[96:99], v[24:27], v[112:127]
    s_waitcnt vmcnt(14)
    v_mfma_f32_32x32x16_bf16 v[80:95], a[100:103], v[28:31], v[80:95]
    v_mfma_f32_32x32x16_bf16 v[96:111], a[104:107], v[28:31], v[96:111]
    buffer_load_dwordx4 v[24:27], v1, s[28:31], s60 offen offset:2048 sc1
    v_mfma_f32_32x32x16_bf16 v[112:127], a[108:111], v[28:31], v[112:127]
    s_waitcnt vmcnt(14)
    v_mfma_f32_32x32x16_bf16 v[80:95], a[112:115], v[32:35], v[80:95]
    v_mfma_f32_32x32x16_bf16 v[96:111], a[116:119], v[32:35], v[96:111]
    buffer_load_dwordx4 v[28:31], v1, s[28:31], s60 offen offset:3072 sc1
    v_mfma_f32_32x32x16_bf16 v[112:127], a[120:123], v[32:35], v[112:127]
    s_waitcnt vmcnt(14)
    v_mfma_f32_32x32x16_bf16 v[80:95], a[124:127], v[36:39], v[80:95]
    v_mfma_f32_32x32x16_bf16 v[96:111], a[128:131], v[36:39], v[96:111]
    s_add_u32 s60, s60, 4096
    buffer_load_dwordx4 v[32:35], v1, s[28:31], s60 offen offset:0 sc1
    v_mfma_f32_32x32x16_bf16 v[112:127], a[132:135], v[36:39], v[112:127]
    s_waitcnt vmcnt(14)
    v_mfma_f32_32x32x16_bf16 v[80:95], a[136:139], v[40:43], v[80:95]
    v_mfma_f32_32x32x16_bf16 v[96:111], a[140:143], v[40:43], v[96:111]
    buffer_load_dwordx4 v[36:39], v1, s[28:31], s60 offen offset:1024 sc1
    v_mfma_f32_32x32x16_bf16 v[112:127], a[144:147], v[40:43], v[112:127]
    s_waitcnt vmcnt(14)
    v_mfma_f32_32x32x16_bf16 v[80:95], a[148:151], v[44:47], v[80:95]
    v_mfma_f32_32x32x16_bf16 v[96:111], a[152:155], v[44:47], v[96:111]
    buffer_load_dwordx4 v[40:43], v1, s[28:31], s60 offen offset:2048 sc1
    v_mfma_f32_32x32x16_bf16 v[112:127], a[156:159], v[44:47], v[112:127]
    s_waitcnt vmcnt(14)
    v_mfma_f32_32x32x16_bf16 v[80:95], a[160:163], v[48:51], v[80:95]
    v_mfma_f32_32x32x16_bf16 v[96:111], a[164:167], v[48:51], v[96:111]
    buffer_load_dwordx4 v[44:47], v1, s[28:31], s60 offen offset:3072 sc1
    v_mfma_f32_32x32x16_bf16 v[112:127], a[168:171], v[48:51], v[112:127]
    s_waitcnt vmcnt(14)
    v_mfma_f32_32x32x16_bf16 v[80:95], a[172:175], v[52:55], v[80:95]
    v_mfma_f32_32x32x16_bf16 v[96:111], a[176:179], v[52:55], v[96:111]
    s_add_u32 s60, s60, 4096
    buffer_load_dwordx4 v[48:51], v1, s[28:31], s60 offen offset:0 sc1
    v_mfma_f32_32x32x16_bf16 v[112:127], a[180:183], v[52:55], v[112:127]
    s_waitcnt vmcnt(14)
    v_mfma_f32_32x32x16_bf16 v[80:95], a[184:187], v[56:59], v[80:95]
    v_mfma_f32_32x32x16_bf16 v[96:111], a[188:191], v[56:59], v[96:111]
    buffer_load_dwordx4 v[52:55], v1, s[28:31], s60 offen offset:1024 sc1
    v_mfma_f32_32x32x16_bf16 v[112:127], a[192:195], v[56:59], v[112:127]
    s_waitcnt vmcnt(14)
    v_mfma_f32_32x32x16_bf16 v[80:95], a[196:199], v[60:63], v[80:95]
    v_mfma_f32_32x32x16_bf16 v[96:111], a[200:203], v[60:63], v[96:111]
    buffer_load_dwordx4 v[56:59], v1, s[28:31], s60 offen offset:2048 sc1
    v_mfma_f32_32x32x16_bf16 v[112:127], a[204:207], v[60:63], v[112:127]
    s_waitcnt vmcnt(14)
    v_mfma_f32_32x32x16_bf16 v[80:95], a[208:211], v[64:67], v[80:95]
    v_mfma_f32_32x32x16_bf16 v[96:111], a[212:215], v[64:67], v[96:111]
    buffer_load_dwordx4 v[60:63], v1, s[28:31], s60 offen offset:3072 sc1
    v_mfma_f32_32x32x16_bf16 v[112:127], a[216:219], v[64:67], v[112:127]
    s_waitcnt vmcnt(14)
    v_mfma_f32_32x32x16_bf16 v[80:95], a[220:223], v[68:71], v[80:95]
    v_mfma_f32_32x32x16_bf16 v[96:111], a[224:227], v[68:71], v[96:111]
    s_add_u32 s60, s60, 4096
    buffer_load_dwordx4 v[64:67], v1, s[28:31], s60 offen offset:0 sc1
    v_mfma_f32_32x32x16_bf16 v[112:127], a[228:231], v[68:71], v[112:127]
    s_waitcnt vmcnt(14)
    v_mfma_f32_32x32x16_bf16 v[80:95], a[232:235], v[72:75], v[80:95]
    v_mfma_f32_32x32x16_bf16 v[96:111], a[236:239], v[72:75], v[96:111]
    buffer_load_dwordx4 v[68:71], v1, s[28:31], s60 offen offset:1024 sc1
    v_mfma_f32_32x32x16_bf16 v[112:127], a[240:243], v[72:75], v[112:127]
    s_waitcnt vmcnt(14)
    v_mfma_f32_32x32x16_bf16 v[80:95], a[244:247], v[76:79], v[80:95]
    v_mfma_f32_32x32x16_bf16 v[96:111], a[248:251], v[76:79], v[96:111]
    buffer_load_dwordx4 v[72:75], v1, s[28:31], s60 offen offset:2048 sc1
    v_mfma_f32_32x32x16_bf16 v[112:127], a[252:255], v[76:79], v[112:127]
    buffer_load_dwordx4 v[76:79], v1, s[28:31], s60 offen offset:3072 sc1
    ds_write_b128 v4, v[80:83] offset:0
    ds_write_b128 v4, v[84:87] offset:1024
    ds_write_b128 v4, v[88:91] offset:2048
    ds_write_b128 v4, v[92:95] offset:3072
    ds_write_b128 v4, v[96:99] offset:4096
    ds_write_b128 v4, v[100:103] offset:5120
    ds_write_b128 v4, v[104:107] offset:6144
    ds_write_b128 v4, v[108:111] offset:7168
    s_nop 2
    ds_write_b128 v4, v[112:115] offset:8192
    ds_write_b128 v4, v[116:119] offset:9216
    ds_write_b128 v4, v[120:123] offset:10240
    ds_write_b128 v4, v[124:127] offset:11264
    s_waitcnt lgkmcnt(0)
    s_barrier
    ds_read_b128 v[80:83], v5 offset:0
    ds_read_b128 v[84:87], v5 offset:1024
    ds_read_b128 v[88:91], v5 offset:2048
    ds_read_b128 v[92:95], v5 offset:12288
    ds_read_b128 v[96:99], v5 offset:13312
    ds_read_b128 v[100:103], v5 offset:14336
    ds_read_b128 v[104:107], v5 offset:24576
    ds_read_b128 v[108:111], v5 offset:25600
    ds_read_b128 v[112:115], v5 offset:26624
    ds_read_b128 v[116:119], v5 offset:36864
    ds_read_b128 v[120:123], v5 offset:37888
    ds_read_b128 v[124:127], v5 offset:38912
    s_waitcnt lgkmcnt(6)
    v_pk_add_f32 v[80:81], v[80:81], v[92:93]
    v_pk_add_f32 v[82:83], v[82:83], v[94:95]
    v_pk_add_f32 v[84:85], v[84:85], v[96:97]
    v_pk_add_f32 v[86:87], v[86:87], v[98:99]
    v_pk_add_f32 v[88:89], v[88:89], v[100:101]
    v_pk_add_f32 v[90:91], v[90:91], v[102:103]
    s_waitcnt lgkmcnt(0)
    s_barrier
    v_pk_add_f32 v[104:105], v[104:105], v[116:117]
    v_pk_add_f32 v[106:107], v[106:107], v[118:119]
    v_pk_add_f32 v[108:109], v[108:109], v[120:121]
    v_pk_add_f32 v[110:111], v[110:111], v[122:123]
    v_pk_add_f32 v[112:113], v[112:113], v[124:125]
    v_pk_add_f32 v[114:115], v[114:115], v[126:127]
    v_pk_add_f32 v[80:81], v[80:81], v[104:105]
    v_pk_add_f32 v[82:83], v[82:83], v[106:107]
    v_pk_add_f32 v[84:85], v[84:85], v[108:109]
    v_pk_add_f32 v[86:87], v[86:87], v[110:111]
    v_pk_add_f32 v[88:89], v[88:89], v[112:113]
    v_pk_add_f32 v[90:91], v[90:91], v[114:115]
    buffer_store_dwordx4 v[80:83], v5, s[28:31], s57 offen offset:0 sc1
    buffer_store_dwordx4 v[84:87], v5, s[28:31], s57 offen offset:1024 sc1
    buffer_store_dwordx4 v[88:91], v5, s[28:31], s57 offen offset:2048 sc1
    s_lshl_b32 s61, s58, 8
    s_lshl_b32 s52, s51, 6
    s_add_u32 s61, s61, s52
    s_lshl_b32 s52, s46, 2
    s_add_u32 s61, s61, s52
    s_add_u32 s61, s61, 140574720
    s_cmp_lt_u32 s48, 64
    s_cbranch_scc1 L_p_loop_151
    s_waitcnt vmcnt(0)
    s_mov_b64 exec, 1
    buffer_store_dword v10, off, s[28:31], s61 sc1
    s_mov_b64 exec, -1
    s_mov_b32 s61, 0x20000000
    s_waitcnt vmcnt(0)
    s_branch L_exit
L_final:
    s_cmp_lg_u32 s51, 0
    s_cbranch_scc1 L_hold_ok_160
L_wi_161:
    s_sleep 127
    s_load_dword s54, s[44:45], 144 glc
    s_waitcnt lgkmcnt(0)
    s_cmp_ge_u32 s54, 192
    s_cbranch_scc1 L_wi_ok_162
    s_sub_u32 s99, s99, 1
    s_cmp_lg_u32 s99, 0
    s_cbranch_scc1 L_wi_161
    s_branch L_exit
L_wi_ok_162:
L_hold_ok_160:
    s_barrier
    v_lshlrev_b32 v1, 4, v0
    s_mul_i32 s52, s51, 3072
    v_add_u32 v5, s52, v1
    v_lshrrev_b32 v8, 5, v0
    v_and_b32 v10, 31, v0
    v_mul_u32_u24 v6, 1152, v10
    v_lshl_add_u32 v6, v8, 3, v6
L_f_loop_163:
    s_mul_i32 s58, s48, 6
    s_add_u32 s58, s58, s47
    s_lshl_b32 s63, s58, 8
    s_lshl_b32 s52, s51, 6
    s_add_u32 s63, s63, s52
    s_add_u32 s63, s63, 140574720
    s_mul_i32 s57, s58, 49152
    s_add_u32 s57, s57, 142606336
    s_mul_i32 s54, s48, 36864
    s_mul_i32 s53, s47, 192
    s_add_u32 s54, s54, s53
    s_mul_i32 s53, s51, 48
    s_add_u32 s54, s54, s53
L_f_p_164:
    s_buffer_load_dwordx4 s[68:71], s[28:31], s63 glc
    s_waitcnt lgkmcnt(0)
    s_and_b64 s[68:69], s[68:69], s[70:71]
    s_and_b32 s68, s68, s69
    s_cbranch_scc1 L_f_ok_165
    s_sleep 2
    s_sub_u32 s99, s99, 1
    s_cmp_lg_u32 s99, 0
    s_cbranch_scc1 L_f_p_164
    s_branch L_exit
L_f_ok_165:
    s_mov_b32 s52, s57
    buffer_load_dwordx4 v[16:19], v5, s[28:31], s52 offen offset:0 sc1
    buffer_load_dwordx4 v[20:23], v5, s[28:31], s52 offen offset:1024 sc1
    buffer_load_dwordx4 v[24:27], v5, s[28:31], s52 offen offset:2048 sc1
    s_add_u32 s52, s52, 12288
    buffer_load_dwordx4 v[28:31], v5, s[28:31], s52 offen offset:0 sc1
    buffer_load_dwordx4 v[32:35], v5, s[28:31], s52 offen offset:1024 sc1
    buffer_load_dwordx4 v[36:39], v5, s[28:31], s52 offen offset:2048 sc1
    s_add_u32 s52, s52, 12288
    buffer_load_dwordx4 v[40:43], v5, s[28:31], s52 offen offset:0 sc1
    buffer_load_dwordx4 v[44:47], v5, s[28:31], s52 offen offset:1024 sc1
    buffer_load_dwordx4 v[48:51], v5, s[28:31], s52 offen offset:2048 sc1
    s_add_u32 s52, s52, 12288
    buffer_load_dwordx4 v[52:55], v5, s[28:31], s52 offen offset:0 sc1
    buffer_load_dwordx4 v[56:59], v5, s[28:31], s52 offen offset:1024 sc1
    buffer_load_dwordx4 v[60:63], v5, s[28:31], s52 offen offset:2048 sc1
    s_add_u32 s52, s52, 12288
    s_waitcnt vmcnt(0)
    v_add_f32 v16, v16, v28
    v_add_f32 v17, v17, v29
    v_add_f32 v18, v18, v30
    v_add_f32 v19, v19, v31
    v_add_f32 v20, v20, v32
    v_add_f32 v21, v21, v33
    v_add_f32 v22, v22, v34
    v_add_f32 v23, v23, v35
    v_add_f32 v24, v24, v36
    v_add_f32 v25, v25, v37
    v_add_f32 v26, v26, v38
    v_add_f32 v27, v27, v39
    v_add_f32 v40, v40, v52
    v_add_f32 v41, v41, v53
    v_add_f32 v42, v42, v54
    v_add_f32 v43, v43, v55
    v_add_f32 v44, v44, v56
    v_add_f32 v45, v45, v57
    v_add_f32 v46, v46, v58
    v_add_f32 v47, v47, v59
    v_add_f32 v48, v48, v60
    v_add_f32 v49, v49, v61
    v_add_f32 v50, v50, v62
    v_add_f32 v51, v51, v63
    v_add_f32 v16, v16, v40
    v_add_f32 v17, v17, v41
    v_add_f32 v18, v18, v42
    v_add_f32 v19, v19, v43
    v_add_f32 v20, v20, v44
    v_add_f32 v21, v21, v45
    v_add_f32 v22, v22, v46
    v_add_f32 v23, v23, v47
    v_add_f32 v24, v24, v48
    v_add_f32 v25, v25, v49
    v_add_f32 v26, v26, v50
    v_add_f32 v27, v27, v51
L_f_st_167:
    v_cvt_pk_bf16_f32 v28, v16, v17
    v_cvt_pk_bf16_f32 v29, v18, v19
    v_cvt_pk_bf16_f32 v30, v20, v21
    v_cvt_pk_bf16_f32 v31, v22, v23
    v_cvt_pk_bf16_f32 v32, v24, v25
    v_cvt_pk_bf16_f32 v33, v26, v27
    buffer_store_dwordx2 v[28:29], v6, s[32:35], s54 offen offset:0
    buffer_store_dwordx2 v[30:31], v6, s[32:35], s54 offen offset:16
    buffer_store_dwordx2 v[32:33], v6, s[32:35], s54 offen offset:32
    s_add_u32 s48, s48, 2
    s_cmp_lt_u32 s48, 64
    s_cbranch_scc1 L_f_loop_163
    s_waitcnt vmcnt(0)
L_exit:
    s_endpgm
.section .rodata,"a"
.p2align 6
.amdhsa_kernel gated_mix__memory_aug_recurrent_mem_tr__memory_aug_recurrent_mem_tr__prompt_kernel
  .amdhsa_next_free_vgpr 512
  .amdhsa_next_free_sgpr 102
  .amdhsa_accum_offset 256
  .amdhsa_group_segment_fixed_size 0
  .amdhsa_kernarg_size 144
  .amdhsa_user_sgpr_count 2
  .amdhsa_user_sgpr_kernarg_segment_ptr 1
  .amdhsa_system_sgpr_workgroup_id_x 1
.end_amdhsa_kernel
```
